```python
import torch

def _softmax(x, axis=-1):
    return torch.softmax(x, dim=axis)

def _gelu(x):
    return torch.nn.functional.gelu(x, approximate='tanh')

def _silu(x):
    return torch.nn.functional.silu(x)

def _sigmoid(x):
    return torch.sigmoid(x)

def _layernorm(x, axis=-1, eps=1e-05):
    m = x.mean(dim=axis, keepdim=True)
    v = x.var(dim=axis, keepdim=True, unbiased=False)
    return (x - m) / torch.sqrt(v + eps)

def _scatter_add(tgt, idx, src, axis=0):
    return tgt.clone().index_add_(axis, idx, src)

def _segment_sum(src, seg, n):
    out = torch.zeros((n,) + src.shape[1:], dtype=src.dtype)
    return out.index_add_(0, seg, src)

def _pad(x, pw):
    flat = tuple((v for pair in reversed(pw) for v in pair))
    return torch.nn.functional.pad(x, flat)
kernel_name = 'standalone__pixart__diffusion'

def setup_inputs():

    _w = lambda a: (lambda t: t.to(torch.bfloat16) if t.is_floating_point() else t)(torch.as_tensor(a))
    B, N, D, M = (2, 1024, 1152, 77)
    return {'x': _w((lambda *s: torch.randn(*s, dtype=torch.bfloat16) * 0.05)(B, N, D)), 'c': _w((lambda *s: torch.randn(*s, dtype=torch.bfloat16) * 0.05)(B, D)), 'y': _w((lambda *s: torch.randn(*s, dtype=torch.bfloat16) * 0.1)(B, M, D)), 'wqkv': _w((lambda *s: torch.randn(*s, dtype=torch.bfloat16) * 0.05)(D, 3 * D)), 'wo': _w((lambda *s: torch.randn(*s, dtype=torch.bfloat16) * 0.05)(D, D)), 'wq_c': _w((lambda *s: torch.randn(*s, dtype=torch.bfloat16) * 0.1)(D, D)), 'wkv_c': _w((lambda *s: torch.randn(*s, dtype=torch.bfloat16) * 0.1)(D, 2 * D)), 'wo_c': _w((lambda *s: torch.randn(*s, dtype=torch.bfloat16) * 0.05)(D, D)), 'w_mod': _w((lambda *s: torch.randn(*s, dtype=torch.bfloat16) * 0.05)(D, 6 * D))}

def reference(x, c, y, wqkv, wo, wq_c, wkv_c, wo_c, w_mod):
    B, N, D = x.shape
    mod = (_silu(c) @ w_mod).reshape(B, 6, 1, D)
    shift_a, scale_a, gate_a, shift_m, scale_m, gate_m = [mod[:, i] for i in range(6)]
    h = _layernorm(x, axis=-1) * (1 + scale_a) + shift_a
    qkv = h @ wqkv
    q, k, v = (qkv[..., :D].clone(), qkv[..., D:2 * D].clone(), qkv[..., 2 * D:].clone())
    p = _softmax(torch.einsum('bqd,bkd->bqk', q, k) * D ** (-0.5), axis=-1)
    x = x + gate_a * (torch.einsum('bqk,bkd->bqd', p, v) @ wo)
    hc = _layernorm(x, axis=-1)
    qc = hc @ wq_c
    kvc = y @ wkv_c
    kc, vc = (kvc[..., :D].clone(), kvc[..., D:].clone())
    pc = _softmax(torch.einsum('bqd,bkd->bqk', qc, kc) * D ** (-0.5), axis=-1)
    return x + torch.einsum('bqk,bkd->bqd', pc, vc) @ wo_c
```

```asm
; @launch grid=(256,1,1) block=(512,1,1) lds=161088
.amdgcn_target "amdgcn-amd-amdhsa--gfx950"
.text
.globl standalone__pixart__diffusion_kernel
.p2align 8
.type standalone__pixart__diffusion_kernel,@function
standalone__pixart__diffusion_kernel:
    s_load_dwordx16 s[36:51], s[0:1], 0
    s_load_dwordx8 s[52:59], s[0:1], 64
    v_lshrrev_b32 v3, 6, v0
    v_and_b32 v0, 63, v0
    v_readfirstlane_b32 s3, v3
    v_and_b32 v1, 15, v0
    v_lshrrev_b32 v2, 4, v0
    s_cmp_ge_u32 s2, 256
    s_cbranch_scc1 L_jP_end
    v_lshlrev_b32 v4, 2, v1
    v_add_u32 v4, 159744, v4
    v_mov_b32 v8, 0
    s_mov_b32 s100, 159744
    s_mov_b32 s101, 0
    s_cmp_lg_u32 s3, 1
    s_cbranch_scc1 L_k8_a
    ds_write_b32 v4, v8
L_k8_a:
    s_and_b32 s76, s2, 7
    s_lshr_b32 s77, s2, 3
    s_cmp_lg_u32 s3, 0
    s_cbranch_scc1 L_k0_nc
    s_getpc_b64 s[72:73]
L_pf1:
    s_add_u32 s72, s72, standalone__pixart__diffusion_kernel-L_pf1
    s_addc_u32 s73, s73, -1
    v_lshlrev_b32 v4, 7, v0
    v_min_u32 v5, L_code_a-standalone__pixart__diffusion_kernel-4, v4
    global_load_dword v3, v5, s[72:73]
    v_add_u32 v4, 8192, v4
    v_min_u32 v5, L_code_a-standalone__pixart__diffusion_kernel-4, v4
    global_load_dword v3, v5, s[72:73]
L_k0_nc:
    s_lshl_b32 s75, s77, 1
    s_add_u32 s75, s75, s76
    s_add_u32 s75, s75, 78
    s_mul_i32 s30, s77, 6
    s_add_u32 s30, s30, s76
    s_cmp_ge_u32 s76, 6
    s_cselect_b32 s75, s75, s30
    s_cmp_lt_u32 s77, 14
    s_cbranch_scc1 L_jmod
    s_sub_u32 s30, s77, 14
    s_cmp_ge_u32 s76, 6
    s_cbranch_scc1 L_k0_kv
    s_mul_hi_u32 s6, s30, 1431655766
    s_mul_i32 s35, s6, 3
    s_sub_u32 s5, s30, s35
    s_mul_i32 s32, s5, 6
    s_mul_i32 s33, s6, 3
    s_add_u32 s32, s32, s33
    s_mul_i32 s33, s76, 1
    s_add_u32 s32, s32, s33
    s_mul_hi_u32 s33, s32, 238609295
    s_mul_i32 s35, s33, 18
    s_sub_u32 s7, s32, s35
    s_mul_hi_u32 s30, s76, 1431655766
    s_mul_i32 s35, s30, 3
    s_sub_u32 s31, s76, s35
    s_mul_i32 s31, s31, 3
    s_add_u32 s5, s5, s31
    s_mul_i32 s30, s30, 6
    s_add_u32 s6, s6, s30
L_jA:
    s_cmp_lt_u32 s3, 4
    s_cbranch_scc1 L_jA_cons
L_jA_ld:
    s_sub_u32 s60, s3, 4
    v_lshrrev_b32 v4, 3, v0
    v_and_b32 v5, 7, v0
    s_and_b32 s29, s60, 1
    s_lshl_b32 s29, s29, 2
    v_add_u32 v6, s29, v2
    v_xor_b32 v5, v5, v6
    v_mul_u32_u24 v4, 6912, v4
    v_lshl_add_u32 v4, v5, 4, v4
    s_mul_i32 s28, s5, 884736
    s_mul_i32 s29, s60, 55296
    s_add_u32 s28, s28, s29
    v_add_u32 v8, s28, v4
    s_lshl_b32 s61, s60, 10
    v_add_u32 v9, 221184, v8
    v_add_u32 v10, 442368, v8
    v_add_u32 v11, 663552, v8
    v_lshrrev_b32 v4, 3, v0
    v_and_b32 v5, 7, v0
    s_and_b32 s29, s60, 1
    s_lshl_b32 s29, s29, 2
    v_add_u32 v6, s29, v2
    v_xor_b32 v5, v5, v6
    v_mul_u32_u24 v4, 6912, v4
    v_lshl_add_u32 v4, v5, 4, v4
    s_mul_i32 s28, s6, 663552
    s_mul_i32 s29, s60, 55296
    s_add_u32 s28, s28, s29
    s_add_u32 s28, s28, 2304
    v_add_u32 v12, s28, v4
    s_lshl_b32 s62, s60, 10
    s_add_u32 s62, s62, 16384
    v_add_u32 v13, 221184, v12
    v_add_u32 v14, 442368, v12
    s_mul_i32 s63, s7, 128
    s_mul_i32 s64, s7, 128
    s_mov_b32 s65, s7
    s_mov_b32 s66, 0
    s_mov_b32 s67, 0
    s_mov_b32 s69, 28672
    s_waitcnt lgkmcnt(0)
    s_mov_b32 s8, s42
    s_mov_b32 s9, s43
    s_mov_b32 s10, 7962624
    s_mov_b32 s11, 0x20000
    s_getpc_b64 s[32:33]
L_tb8_1:
    s_lshl_b32 s34, s2, 4
    s_add_u32 s34, s34, L_tab8-L_tb8_1
    s_load_dwordx4 s[96:99], s[32:33], s34
    s_mov_b32 s70, 0
    s_mov_b32 s71, 2
L_jA_lloop:
    s_add_u32 m0, s61, 0
    s_nop 0
    buffer_load_dwordx4 v8, s[8:11], s63 offen offset:0 lds
    s_add_u32 m0, s61, 4096
    s_nop 0
    buffer_load_dwordx4 v9, s[8:11], s63 offen offset:0 lds
    s_add_u32 m0, s61, 8192
    s_nop 0
    buffer_load_dwordx4 v10, s[8:11], s63 offen offset:0 lds
    s_add_u32 m0, s61, 12288
    s_nop 0
    buffer_load_dwordx4 v11, s[8:11], s63 offen offset:0 lds
    s_add_u32 m0, s62, 0
    s_nop 0
    buffer_load_dwordx4 v12, s[8:11], s64 offen offset:0 lds
    s_add_u32 m0, s62, 4096
    s_nop 0
    buffer_load_dwordx4 v13, s[8:11], s64 offen offset:0 lds
    s_add_u32 m0, s62, 8192
    s_nop 0
    buffer_load_dwordx4 v14, s[8:11], s64 offen offset:0 lds
    s_add_u32 s63, s63, 128
    s_add_u32 s64, s64, 128
    s_add_u32 s65, s65, 1
    s_cmp_eq_u32 s65, 18
    s_cselect_b32 s63, 0, s63
    s_cselect_b32 s64, 0, s64
    s_cselect_b32 s65, 0, s65
    s_add_u32 s66, s66, 1
    s_cmp_eq_u32 s66, 5
    s_cselect_b32 s68, 4294852608, s69
    s_cselect_b32 s66, 0, s66
    s_add_u32 s61, s61, s68
    s_add_u32 s62, s62, s68
    s_add_u32 s67, s67, 1
    s_cmp_eq_u32 s67, 18
    s_cbranch_scc1 L_jA_ltail
    s_cmp_lt_u32 s67, s71
    s_cbranch_scc1 L_jA_lloop
    s_cmp_lg_u32 s70, 0
    s_cbranch_scc1 L_jA_r0
    s_waitcnt vmcnt(7)
    s_add_u32 s71, s71, 1
L_jA_r0:
    s_cmp_lg_u32 s70, 1
    s_cbranch_scc1 L_jA_r1
    s_waitcnt vmcnt(14)
    s_add_u32 s71, s71, 1
L_jA_r1:
    s_waitcnt vmcnt(21)
    s_barrier
    s_add_u32 s70, s70, 1
    s_add_u32 s71, s71, 1
    s_branch L_jA_lloop
L_jA_ltail:
    s_waitcnt vmcnt(21)
    s_barrier
    s_waitcnt vmcnt(14)
    s_barrier
    s_waitcnt vmcnt(7)
    s_barrier
    s_waitcnt vmcnt(0)
    s_barrier
    s_mov_b32 s24, s56
    s_mov_b32 s25, s57
    s_mov_b32 s26, 256
    s_mov_b32 s27, 0x20000
    v_mov_b32 v7, 128
    buffer_load_dword v3, v7, s[24:27], 0 offen sc1
    s_barrier
    s_waitcnt vmcnt(0)
    v_readfirstlane_b32 s101, v3
    s_branch L_st1
L_jA_cons:
    s_and_b32 s60, s3, 1
    s_lshr_b32 s61, s3, 1
    v_lshrrev_b32 v4, 1, v1
    v_lshlrev_b32 v5, 7, v1
    s_mul_i32 s28, s60, 8192
    v_add_u32 v5, s28, v5
    v_xor_b32 v4, v4, v2
    v_lshl_add_u32 v8, v4, 4, v5
    v_xor_b32 v9, 64, v8
    v_lshrrev_b32 v4, 1, v1
    v_lshlrev_b32 v5, 7, v1
    s_mul_i32 s28, s61, 6144
    s_add_u32 s28, s28, 16384
    v_add_u32 v5, s28, v5
    v_xor_b32 v4, v4, v2
    v_lshl_add_u32 v10, v4, 4, v5
    v_xor_b32 v11, 64, v10
    v_mov_b32 v68, 0
    v_mov_b32 v69, 0
    v_mov_b32 v70, 0
    v_mov_b32 v71, 0
    v_mov_b32 v72, 0
    v_mov_b32 v73, 0
    v_mov_b32 v74, 0
    v_mov_b32 v75, 0
    v_mov_b32 v76, 0
    v_mov_b32 v77, 0
    v_mov_b32 v78, 0
    v_mov_b32 v79, 0
    v_mov_b32 v80, 0
    v_mov_b32 v81, 0
    v_mov_b32 v82, 0
    v_mov_b32 v83, 0
    v_mov_b32 v84, 0
    v_mov_b32 v85, 0
    v_mov_b32 v86, 0
    v_mov_b32 v87, 0
    v_mov_b32 v88, 0
    v_mov_b32 v89, 0
    v_mov_b32 v90, 0
    v_mov_b32 v91, 0
    v_mov_b32 v92, 0
    v_mov_b32 v93, 0
    v_mov_b32 v94, 0
    v_mov_b32 v95, 0
    v_mov_b32 v96, 0
    v_mov_b32 v97, 0
    v_mov_b32 v98, 0
    v_mov_b32 v99, 0
    v_mov_b32 v100, 0
    v_mov_b32 v101, 0
    v_mov_b32 v102, 0
    v_mov_b32 v103, 0
    v_mov_b32 v104, 0
    v_mov_b32 v105, 0
    v_mov_b32 v106, 0
    v_mov_b32 v107, 0
    v_mov_b32 v108, 0
    v_mov_b32 v109, 0
    v_mov_b32 v110, 0
    v_mov_b32 v111, 0
    v_mov_b32 v112, 0
    v_mov_b32 v113, 0
    v_mov_b32 v114, 0
    v_mov_b32 v115, 0
    s_mov_b32 s66, 0
    s_mov_b32 s67, 0
    s_mov_b32 s69, 28672
    s_waitcnt lgkmcnt(0)
    s_mov_b32 s16, s58
    s_mov_b32 s17, s59
    s_mov_b32 s18, 50331648
    s_mov_b32 s19, 0x20000
    s_getpc_b64 s[32:33]
L_tb8_2:
    s_lshl_b32 s34, s2, 4
    s_add_u32 s34, s34, L_tab8-L_tb8_2
    s_load_dwordx4 s[96:99], s[32:33], s34
    s_barrier
    ds_read_b128 v[12:15], v8 offset:0
    ds_read_b128 v[28:31], v10 offset:0
    ds_read_b128 v[32:35], v10 offset:2048
    ds_read_b128 v[36:39], v10 offset:4096
    ds_read_b128 v[16:19], v8 offset:2048
    ds_read_b128 v[20:23], v8 offset:4096
    ds_read_b128 v[24:27], v8 offset:6144
L_jA_cloop:
    s_waitcnt lgkmcnt(6)
    s_waitcnt lgkmcnt(5)
    v_mfma_f32_16x16x32_bf16 v[68:71], v[12:15], v[28:31], v[68:71]
    ds_read_b128 v[40:43], v9 offset:0
    s_waitcnt lgkmcnt(5)
    v_mfma_f32_16x16x32_bf16 v[72:75], v[12:15], v[32:35], v[72:75]
    ds_read_b128 v[56:59], v11 offset:0
    s_waitcnt lgkmcnt(5)
    v_mfma_f32_16x16x32_bf16 v[76:79], v[12:15], v[36:39], v[76:79]
    ds_read_b128 v[60:63], v11 offset:2048
    s_waitcnt lgkmcnt(5)
    v_mfma_f32_16x16x32_bf16 v[88:91], v[16:19], v[36:39], v[88:91]
    ds_read_b128 v[64:67], v11 offset:4096
    v_mfma_f32_16x16x32_bf16 v[84:87], v[16:19], v[32:35], v[84:87]
    ds_read_b128 v[44:47], v9 offset:2048
    v_mfma_f32_16x16x32_bf16 v[80:83], v[16:19], v[28:31], v[80:83]
    ds_read_b128 v[48:51], v9 offset:4096
    s_waitcnt lgkmcnt(7)
    v_mfma_f32_16x16x32_bf16 v[92:95], v[20:23], v[28:31], v[92:95]
    ds_read_b128 v[52:55], v9 offset:6144
    v_mfma_f32_16x16x32_bf16 v[96:99], v[20:23], v[32:35], v[96:99]
    s_add_u32 s66, s66, 1
    s_cmp_eq_u32 s66, 5
    s_cselect_b32 s68, 4294852608, s69
    v_mfma_f32_16x16x32_bf16 v[100:103], v[20:23], v[36:39], v[100:103]
    s_cselect_b32 s66, 0, s66
    v_add_u32 v8, s68, v8
    v_add_u32 v9, s68, v9
    s_waitcnt lgkmcnt(7)
    v_mfma_f32_16x16x32_bf16 v[112:115], v[24:27], v[36:39], v[112:115]
    v_add_u32 v10, s68, v10
    v_add_u32 v11, s68, v11
    v_mfma_f32_16x16x32_bf16 v[108:111], v[24:27], v[32:35], v[108:111]
    s_add_u32 s67, s67, 1
    s_cmp_eq_u32 s67, 18
    v_mfma_f32_16x16x32_bf16 v[104:107], v[24:27], v[28:31], v[104:107]
    s_cbranch_scc1 L_jA_ctail
    s_waitcnt lgkmcnt(0)
    s_barrier
    v_mfma_f32_16x16x32_bf16 v[68:71], v[40:43], v[56:59], v[68:71]
    ds_read_b128 v[12:15], v8 offset:0
    v_mfma_f32_16x16x32_bf16 v[72:75], v[40:43], v[60:63], v[72:75]
    ds_read_b128 v[28:31], v10 offset:0
    v_mfma_f32_16x16x32_bf16 v[76:79], v[40:43], v[64:67], v[76:79]
    ds_read_b128 v[32:35], v10 offset:2048
    v_mfma_f32_16x16x32_bf16 v[88:91], v[44:47], v[64:67], v[88:91]
    ds_read_b128 v[36:39], v10 offset:4096
    v_mfma_f32_16x16x32_bf16 v[84:87], v[44:47], v[60:63], v[84:87]
    ds_read_b128 v[16:19], v8 offset:2048
    v_mfma_f32_16x16x32_bf16 v[80:83], v[44:47], v[56:59], v[80:83]
    ds_read_b128 v[20:23], v8 offset:4096
    v_mfma_f32_16x16x32_bf16 v[92:95], v[48:51], v[56:59], v[92:95]
    ds_read_b128 v[24:27], v8 offset:6144
    v_mfma_f32_16x16x32_bf16 v[96:99], v[48:51], v[60:63], v[96:99]
    v_mfma_f32_16x16x32_bf16 v[100:103], v[48:51], v[64:67], v[100:103]
    v_mfma_f32_16x16x32_bf16 v[112:115], v[52:55], v[64:67], v[112:115]
    v_mfma_f32_16x16x32_bf16 v[108:111], v[52:55], v[60:63], v[108:111]
    v_mfma_f32_16x16x32_bf16 v[104:107], v[52:55], v[56:59], v[104:107]
    s_branch L_jA_cloop
L_jA_ctail:
    s_waitcnt lgkmcnt(0)
    s_barrier
    v_mfma_f32_16x16x32_bf16 v[68:71], v[40:43], v[56:59], v[68:71]
    v_mfma_f32_16x16x32_bf16 v[72:75], v[40:43], v[60:63], v[72:75]
    v_mfma_f32_16x16x32_bf16 v[76:79], v[40:43], v[64:67], v[76:79]
    v_mfma_f32_16x16x32_bf16 v[88:91], v[44:47], v[64:67], v[88:91]
    v_mfma_f32_16x16x32_bf16 v[84:87], v[44:47], v[60:63], v[84:87]
    v_mfma_f32_16x16x32_bf16 v[80:83], v[44:47], v[56:59], v[80:83]
    v_mfma_f32_16x16x32_bf16 v[92:95], v[48:51], v[56:59], v[92:95]
    v_mfma_f32_16x16x32_bf16 v[96:99], v[48:51], v[60:63], v[96:99]
    v_mfma_f32_16x16x32_bf16 v[100:103], v[48:51], v[64:67], v[100:103]
    v_mfma_f32_16x16x32_bf16 v[112:115], v[52:55], v[64:67], v[112:115]
    v_mfma_f32_16x16x32_bf16 v[108:111], v[52:55], v[60:63], v[108:111]
    v_mfma_f32_16x16x32_bf16 v[104:107], v[52:55], v[56:59], v[104:107]
    s_mov_b32 s24, s56
    s_mov_b32 s25, s57
    s_mov_b32 s26, 256
    s_mov_b32 s27, 0x20000
    v_mov_b32 v7, 128
    buffer_load_dword v3, v7, s[24:27], 0 offen sc1
    s_mul_i32 s30, s6, 6
    s_lshl_b32 s31, s5, 2
    s_mov_b32 s28, s30
    s_mul_i32 s29, s61, 3
    s_add_u32 s28, s28, s29
    s_lshl_b32 s28, s28, 11
    s_mov_b32 s32, s31
    s_mul_i32 s29, s60, 2
    s_add_u32 s32, s32, s29
    s_lshr_b32 s29, s32, 1
    s_mul_i32 s29, s29, 147456
    s_add_u32 s28, s28, s29
    s_add_u32 s28, s28, 10485760
    v_lshlrev_b32 v4, 4, v0
    s_nop 1
    v_cvt_pk_bf16_f32 v12, v68, v69
    v_cvt_pk_bf16_f32 v13, v70, v71
    v_cvt_pk_bf16_f32 v14, v80, v81
    v_cvt_pk_bf16_f32 v15, v82, v83
    buffer_store_dwordx4 v[12:15], v4, s[16:19], s28 offen offset:0 sc1
    v_cvt_pk_bf16_f32 v16, v92, v93
    v_cvt_pk_bf16_f32 v17, v94, v95
    v_cvt_pk_bf16_f32 v18, v104, v105
    v_cvt_pk_bf16_f32 v19, v106, v107
    buffer_store_dwordx4 v[16:19], v4, s[16:19], s28 offen offset:1024 sc1
    v_cvt_pk_bf16_f32 v20, v72, v73
    v_cvt_pk_bf16_f32 v21, v74, v75
    v_cvt_pk_bf16_f32 v22, v84, v85
    v_cvt_pk_bf16_f32 v23, v86, v87
    buffer_store_dwordx4 v[20:23], v4, s[16:19], s28 offen offset:2048 sc1
    v_cvt_pk_bf16_f32 v24, v96, v97
    v_cvt_pk_bf16_f32 v25, v98, v99
    v_cvt_pk_bf16_f32 v26, v108, v109
    v_cvt_pk_bf16_f32 v27, v110, v111
    buffer_store_dwordx4 v[24:27], v4, s[16:19], s28 offen offset:3072 sc1
    s_add_u32 s28, s28, 4096
    v_cvt_pk_bf16_f32 v28, v76, v77
    v_cvt_pk_bf16_f32 v29, v78, v79
    v_cvt_pk_bf16_f32 v30, v88, v89
    v_cvt_pk_bf16_f32 v31, v90, v91
    buffer_store_dwordx4 v[28:31], v4, s[16:19], s28 offen offset:0 sc1
    v_cvt_pk_bf16_f32 v32, v100, v101
    v_cvt_pk_bf16_f32 v33, v102, v103
    v_cvt_pk_bf16_f32 v34, v112, v113
    v_cvt_pk_bf16_f32 v35, v114, v115
    buffer_store_dwordx4 v[32:35], v4, s[16:19], s28 offen offset:1024 sc1
    s_lshl_b32 s30, s6, 7
    s_lshl_b32 s31, s5, 2
    s_add_u32 s30, s30, s31
    s_add_u32 s30, s30, 24064
    s_mov_b64 exec, 1
    s_lshl_b32 s30, s30, 0
    s_add_u32 s30, s30, 48234496
    v_mov_b32 v5, 2
    s_add_u32 s28, s100, 0
    v_mov_b32 v4, s28
    s_waitcnt vmcnt(0)
    s_mov_b32 s28, 0
    v_mov_b32 v7, 128
L_prjA:
    v_readfirstlane_b32 s29, v3
    s_add_u32 s28, s28, 1
    s_cmp_gt_u32 s28, 0x40000
    s_cbranch_scc1 L_prdjA
    s_cmp_lg_u32 s29, 0
    s_cbranch_scc1 L_prdjA
    buffer_load_dword v3, v7, s[24:27], 0 offen sc1
    s_waitcnt vmcnt(0)
    s_branch L_prjA
L_prdjA:
    v_mov_b32 v7, 0
    ds_add_rtn_u32 v6, v4, v5
    s_waitcnt lgkmcnt(0)
    v_readfirstlane_b32 s29, v6
    s_cmp_lg_u32 s29, 6
    s_cbranch_scc1 L_sejA
    buffer_store_dword v5, v7, s[16:19], s30 offen sc1
    v_mov_b32 v6, 16
    ds_write_b32 v4, v6
L_sejA:
    s_mov_b64 exec, -1
    s_branch L_st1
L_k0_kv:
    s_lshr_b32 s5, s30, 1
    s_and_b32 s6, s30, 1
    s_mul_i32 s32, s6, 9
    s_add_u32 s7, s32, s5
    s_sub_u32 s30, s76, 6
    s_mul_i32 s30, s30, 9
    s_add_u32 s5, s5, s30
L_jkv:
    s_cmp_lt_u32 s3, 4
    s_cbranch_scc1 L_jkv_cons
L_jkv_ld:
    s_cmp_ge_u32 s3, 6
    s_cbranch_scc1 L_jP_end
    s_sub_u32 s60, s3, 4
    v_lshrrev_b32 v4, 4, v0
    v_and_b32 v5, 15, v0
    v_lshlrev_b32 v6, 1, v2
    v_xor_b32 v5, v5, v6
    v_mul_u32_u24 v4, 4608, v4
    v_lshl_add_u32 v4, v5, 4, v4
    s_mul_i32 s28, s5, 256
    s_mul_i32 s29, s60, 18432
    s_add_u32 s28, s28, s29
    v_add_u32 v8, s28, v4
    s_lshl_b32 s61, s60, 10
    v_xor_b32 v4, 128, v8
    v_add_u32 v9, 34816, v4
    v_add_u32 v10, 73728, v8
    v_add_u32 v11, 108544, v4
    v_add_u32 v12, 147456, v8
    v_add_u32 v13, 182272, v4
    v_add_u32 v14, 221184, v8
    v_add_u32 v15, 256000, v4
    v_lshrrev_b32 v4, 3, v0
    v_and_b32 v5, 7, v0
    s_and_b32 s29, s60, 1
    s_lshl_b32 s29, s29, 2
    v_add_u32 v6, s29, v2
    v_xor_b32 v5, v5, v6
    v_mul_u32_u24 v4, 2304, v4
    v_lshl_add_u32 v4, v5, 4, v4
    s_mul_i32 s28, s6, 177408
    s_mul_i32 s29, s60, 18432
    s_add_u32 s28, s28, s29
    v_add_u32 v16, s28, v4
    s_lshl_b32 s62, s60, 10
    s_add_u32 s62, s62, 16384
    v_add_u32 v17, 34816, v16
    v_add_u32 v18, 73728, v16
    v_add_u32 v19, 108544, v16
    v_add_u32 v20, 147456, v16
    s_mul_i32 s63, s7, 294912
    s_mul_i32 s64, s7, 128
    s_mov_b32 s65, s7
    s_mov_b32 s66, 0
    s_mov_b32 s67, 0
    s_mov_b32 s69, 26624
    s_waitcnt lgkmcnt(0)
    s_mov_b32 s8, s48
    s_mov_b32 s9, s49
    s_mov_b32 s10, 5308416
    s_mov_b32 s11, 0x20000
    s_mov_b32 s12, s40
    s_mov_b32 s13, s41
    s_mov_b32 s14, 354816
    s_mov_b32 s15, 0x20000
    s_getpc_b64 s[32:33]
L_tb8_3:
    s_lshl_b32 s34, s2, 4
    s_add_u32 s34, s34, L_tab8-L_tb8_3
    s_load_dwordx4 s[96:99], s[32:33], s34
    s_mov_b32 s70, 0
    s_mov_b32 s71, 2
L_jkv_lloop:
    s_add_u32 m0, s61, 0
    s_nop 0
    buffer_load_dwordx4 v8, s[8:11], s63 offen offset:0 lds
    buffer_load_dwordx4 v9, s[8:11], s63 offen offset:2048 lds
    s_add_u32 m0, s61, 4096
    s_nop 0
    buffer_load_dwordx4 v10, s[8:11], s63 offen offset:0 lds
    buffer_load_dwordx4 v11, s[8:11], s63 offen offset:2048 lds
    s_add_u32 m0, s61, 8192
    s_nop 0
    buffer_load_dwordx4 v12, s[8:11], s63 offen offset:0 lds
    buffer_load_dwordx4 v13, s[8:11], s63 offen offset:2048 lds
    s_add_u32 m0, s61, 12288
    s_nop 0
    buffer_load_dwordx4 v14, s[8:11], s63 offen offset:0 lds
    buffer_load_dwordx4 v15, s[8:11], s63 offen offset:2048 lds
    s_add_u32 m0, s62, 0
    s_nop 0
    buffer_load_dwordx4 v16, s[12:15], s64 offen offset:0 lds
    buffer_load_dwordx4 v17, s[12:15], s64 offen offset:2048 lds
    s_add_u32 m0, s62, 4096
    s_nop 0
    buffer_load_dwordx4 v18, s[12:15], s64 offen offset:0 lds
    buffer_load_dwordx4 v19, s[12:15], s64 offen offset:2048 lds
    s_add_u32 m0, s62, 8192
    s_nop 0
    buffer_load_dwordx4 v20, s[12:15], s64 offen offset:0 lds
    s_add_u32 s63, s63, 294912
    s_add_u32 s64, s64, 128
    s_add_u32 s65, s65, 1
    s_cmp_eq_u32 s65, 18
    s_cselect_b32 s63, 0, s63
    s_cselect_b32 s64, 0, s64
    s_cselect_b32 s65, 0, s65
    s_add_u32 s66, s66, 1
    s_cmp_eq_u32 s66, 5
    s_cselect_b32 s68, 4294860800, s69
    s_cselect_b32 s66, 0, s66
    s_add_u32 s61, s61, s68
    s_add_u32 s62, s62, s68
    s_add_u32 s67, s67, 1
    s_cmp_eq_u32 s67, 18
    s_cbranch_scc1 L_jkv_ltail
    s_cmp_lt_u32 s67, s71
    s_cbranch_scc1 L_jkv_lloop
    s_cmp_lg_u32 s70, 0
    s_cbranch_scc1 L_jkv_r0
    s_waitcnt vmcnt(13)
    s_add_u32 s71, s71, 1
L_jkv_r0:
    s_cmp_lg_u32 s70, 1
    s_cbranch_scc1 L_jkv_r1
    s_waitcnt vmcnt(26)
    s_add_u32 s71, s71, 1
L_jkv_r1:
    s_waitcnt vmcnt(39)
    s_barrier
    s_add_u32 s70, s70, 1
    s_add_u32 s71, s71, 1
    s_branch L_jkv_lloop
L_jkv_ltail:
    s_waitcnt vmcnt(39)
    s_barrier
    s_waitcnt vmcnt(26)
    s_barrier
    s_waitcnt vmcnt(13)
    s_barrier
    s_waitcnt vmcnt(0)
    s_barrier
    s_mov_b32 s24, s56
    s_mov_b32 s25, s57
    s_mov_b32 s26, 256
    s_mov_b32 s27, 0x20000
    v_mov_b32 v7, 128
    buffer_load_dword v3, v7, s[24:27], 0 offen sc1
    s_barrier
    s_waitcnt vmcnt(0)
    v_readfirstlane_b32 s101, v3
    s_branch L_st1
L_jkv_cons:
    v_bfe_u32 v4, v0, 2, 2
    v_and_b32 v5, 1, v2
    v_lshl_add_u32 v5, v5, 2, v4
    v_lshl_add_u32 v4, v2, 3, v4
    v_lshlrev_b32 v4, 8, v4
    v_and_b32 v6, 3, v0
    v_lshl_add_u32 v4, v6, 3, v4
    s_mul_i32 s28, s3, 2
    v_xor_b32 v5, s28, v5
    v_xor_b32 v6, 0, v5
    v_lshl_add_u32 v8, v6, 5, v4
    v_xor_b32 v6, 1, v5
    v_lshl_add_u32 v9, v6, 5, v4
    v_lshrrev_b32 v4, 1, v1
    v_lshlrev_b32 v5, 7, v1
    v_add_u32 v5, 16384, v5
    v_xor_b32 v4, v4, v2
    v_lshl_add_u32 v10, v4, 4, v5
    v_xor_b32 v11, 64, v10
    v_mov_b32 v68, 0
    v_mov_b32 v69, 0
    v_mov_b32 v70, 0
    v_mov_b32 v71, 0
    v_mov_b32 v72, 0
    v_mov_b32 v73, 0
    v_mov_b32 v74, 0
    v_mov_b32 v75, 0
    v_mov_b32 v76, 0
    v_mov_b32 v77, 0
    v_mov_b32 v78, 0
    v_mov_b32 v79, 0
    v_mov_b32 v80, 0
    v_mov_b32 v81, 0
    v_mov_b32 v82, 0
    v_mov_b32 v83, 0
    v_mov_b32 v84, 0
    v_mov_b32 v85, 0
    v_mov_b32 v86, 0
    v_mov_b32 v87, 0
    v_mov_b32 v88, 0
    v_mov_b32 v89, 0
    v_mov_b32 v90, 0
    v_mov_b32 v91, 0
    v_mov_b32 v92, 0
    v_mov_b32 v93, 0
    v_mov_b32 v94, 0
    v_mov_b32 v95, 0
    v_mov_b32 v96, 0
    v_mov_b32 v97, 0
    v_mov_b32 v98, 0
    v_mov_b32 v99, 0
    v_mov_b32 v100, 0
    v_mov_b32 v101, 0
    v_mov_b32 v102, 0
    v_mov_b32 v103, 0
    v_mov_b32 v104, 0
    v_mov_b32 v105, 0
    v_mov_b32 v106, 0
    v_mov_b32 v107, 0
    s_mov_b32 s66, 0
    s_mov_b32 s67, 0
    s_mov_b32 s69, 26624
    s_waitcnt lgkmcnt(0)
    s_mov_b32 s16, s58
    s_mov_b32 s17, s59
    s_mov_b32 s18, 50331648
    s_mov_b32 s19, 0x20000
    s_getpc_b64 s[32:33]
L_tb8_4:
    s_lshl_b32 s34, s2, 4
    s_add_u32 s34, s34, L_tab8-L_tb8_4
    s_load_dwordx4 s[96:99], s[32:33], s34
    s_barrier
    ds_read_b64_tr_b16 v[12:13], v8 offset:0
    ds_read_b64_tr_b16 v[14:15], v8 offset:1024
    ds_read_b128 v[20:23], v10 offset:0
    ds_read_b64_tr_b16 v[16:17], v9 offset:0
    ds_read_b64_tr_b16 v[18:19], v9 offset:1024
    ds_read_b128 v[24:27], v10 offset:2048
    ds_read_b128 v[28:31], v10 offset:4096
    ds_read_b128 v[32:35], v10 offset:6144
    ds_read_b128 v[36:39], v10 offset:8192
L_jkv_cloop:
    s_waitcnt lgkmcnt(7)
    s_waitcnt lgkmcnt(6)
    v_mfma_f32_16x16x32_bf16 v[68:71], v[12:15], v[20:23], v[68:71]
    ds_read_b64_tr_b16 v[40:41], v8 offset:8192
    ds_read_b64_tr_b16 v[42:43], v8 offset:9216
    s_waitcnt lgkmcnt(6)
    v_mfma_f32_16x16x32_bf16 v[88:91], v[16:19], v[20:23], v[88:91]
    ds_read_b128 v[48:51], v11 offset:0
    ds_read_b64_tr_b16 v[44:45], v9 offset:8192
    s_waitcnt lgkmcnt(7)
    v_mfma_f32_16x16x32_bf16 v[92:95], v[16:19], v[24:27], v[92:95]
    ds_read_b64_tr_b16 v[46:47], v9 offset:9216
    ds_read_b128 v[52:55], v11 offset:2048
    v_mfma_f32_16x16x32_bf16 v[72:75], v[12:15], v[24:27], v[72:75]
    ds_read_b128 v[56:59], v11 offset:4096
    ds_read_b128 v[60:63], v11 offset:6144
    s_waitcnt lgkmcnt(10)
    v_mfma_f32_16x16x32_bf16 v[76:79], v[12:15], v[28:31], v[76:79]
    ds_read_b128 v[64:67], v11 offset:8192
    v_mfma_f32_16x16x32_bf16 v[96:99], v[16:19], v[28:31], v[96:99]
    s_add_u32 s66, s66, 1
    s_cmp_eq_u32 s66, 5
    s_cselect_b32 s68, 4294860800, s69
    s_waitcnt lgkmcnt(10)
    v_mfma_f32_16x16x32_bf16 v[100:103], v[16:19], v[32:35], v[100:103]
    s_cselect_b32 s66, 0, s66
    v_add_u32 v8, s68, v8
    v_add_u32 v9, s68, v9
    v_mfma_f32_16x16x32_bf16 v[80:83], v[12:15], v[32:35], v[80:83]
    v_add_u32 v10, s68, v10
    v_add_u32 v11, s68, v11
    s_waitcnt lgkmcnt(9)
    v_mfma_f32_16x16x32_bf16 v[84:87], v[12:15], v[36:39], v[84:87]
    s_add_u32 s67, s67, 1
    s_cmp_eq_u32 s67, 18
    v_mfma_f32_16x16x32_bf16 v[104:107], v[16:19], v[36:39], v[104:107]
    s_cbranch_scc1 L_jkv_ctail
    s_waitcnt lgkmcnt(0)
    s_barrier
    v_mfma_f32_16x16x32_bf16 v[68:71], v[40:43], v[48:51], v[68:71]
    ds_read_b64_tr_b16 v[12:13], v8 offset:0
    ds_read_b64_tr_b16 v[14:15], v8 offset:1024
    v_mfma_f32_16x16x32_bf16 v[88:91], v[44:47], v[48:51], v[88:91]
    ds_read_b128 v[20:23], v10 offset:0
    ds_read_b64_tr_b16 v[16:17], v9 offset:0
    v_mfma_f32_16x16x32_bf16 v[92:95], v[44:47], v[52:55], v[92:95]
    ds_read_b64_tr_b16 v[18:19], v9 offset:1024
    ds_read_b128 v[24:27], v10 offset:2048
    v_mfma_f32_16x16x32_bf16 v[72:75], v[40:43], v[52:55], v[72:75]
    ds_read_b128 v[28:31], v10 offset:4096
    ds_read_b128 v[32:35], v10 offset:6144
    v_mfma_f32_16x16x32_bf16 v[76:79], v[40:43], v[56:59], v[76:79]
    ds_read_b128 v[36:39], v10 offset:8192
    v_mfma_f32_16x16x32_bf16 v[96:99], v[44:47], v[56:59], v[96:99]
    v_mfma_f32_16x16x32_bf16 v[100:103], v[44:47], v[60:63], v[100:103]
    v_mfma_f32_16x16x32_bf16 v[80:83], v[40:43], v[60:63], v[80:83]
    v_mfma_f32_16x16x32_bf16 v[84:87], v[40:43], v[64:67], v[84:87]
    v_mfma_f32_16x16x32_bf16 v[104:107], v[44:47], v[64:67], v[104:107]
    s_branch L_jkv_cloop
L_jkv_ctail:
    s_waitcnt lgkmcnt(0)
    s_barrier
    v_mfma_f32_16x16x32_bf16 v[68:71], v[40:43], v[48:51], v[68:71]
    v_mfma_f32_16x16x32_bf16 v[88:91], v[44:47], v[48:51], v[88:91]
    v_mfma_f32_16x16x32_bf16 v[92:95], v[44:47], v[52:55], v[92:95]
    v_mfma_f32_16x16x32_bf16 v[72:75], v[40:43], v[52:55], v[72:75]
    v_mfma_f32_16x16x32_bf16 v[76:79], v[40:43], v[56:59], v[76:79]
    v_mfma_f32_16x16x32_bf16 v[96:99], v[44:47], v[56:59], v[96:99]
    v_mfma_f32_16x16x32_bf16 v[100:103], v[44:47], v[60:63], v[100:103]
    v_mfma_f32_16x16x32_bf16 v[80:83], v[40:43], v[60:63], v[80:83]
    v_mfma_f32_16x16x32_bf16 v[84:87], v[40:43], v[64:67], v[84:87]
    v_mfma_f32_16x16x32_bf16 v[104:107], v[44:47], v[64:67], v[104:107]
    s_mov_b32 s24, s56
    s_mov_b32 s25, s57
    s_mov_b32 s26, 256
    s_mov_b32 s27, 0x20000
    v_mov_b32 v7, 128
    buffer_load_dword v3, v7, s[24:27], 0 offen sc1
    s_mul_i32 s30, s6, 5
    s_lshl_b32 s31, s5, 2
    s_mov_b32 s28, s30
    s_lshl_b32 s28, s28, 11
    s_mov_b32 s32, s31
    s_mul_i32 s29, s3, 1
    s_add_u32 s32, s32, s29
    s_lshr_b32 s29, s32, 1
    s_mul_i32 s29, s29, 20480
    s_add_u32 s28, s28, s29
    s_and_b32 s29, s32, 1
    s_lshl_b32 s29, s29, 10
    s_add_u32 s28, s28, s29
    s_add_u32 s28, s28, 16777216
    v_lshlrev_b32 v4, 4, v0
    s_nop 1
    v_cvt_pk_bf16_f32 v12, v68, v69
    v_cvt_pk_bf16_f32 v13, v70, v71
    v_cvt_pk_bf16_f32 v14, v88, v89
    v_cvt_pk_bf16_f32 v15, v90, v91
    buffer_store_dwordx4 v[12:15], v4, s[16:19], s28 offen offset:0 sc1
    v_cvt_pk_bf16_f32 v16, v72, v73
    v_cvt_pk_bf16_f32 v17, v74, v75
    v_cvt_pk_bf16_f32 v18, v92, v93
    v_cvt_pk_bf16_f32 v19, v94, v95
    buffer_store_dwordx4 v[16:19], v4, s[16:19], s28 offen offset:2048 sc1
    s_add_u32 s28, s28, 4096
    v_cvt_pk_bf16_f32 v20, v76, v77
    v_cvt_pk_bf16_f32 v21, v78, v79
    v_cvt_pk_bf16_f32 v22, v96, v97
    v_cvt_pk_bf16_f32 v23, v98, v99
    buffer_store_dwordx4 v[20:23], v4, s[16:19], s28 offen offset:0 sc1
    v_cvt_pk_bf16_f32 v24, v80, v81
    v_cvt_pk_bf16_f32 v25, v82, v83
    v_cvt_pk_bf16_f32 v26, v100, v101
    v_cvt_pk_bf16_f32 v27, v102, v103
    buffer_store_dwordx4 v[24:27], v4, s[16:19], s28 offen offset:2048 sc1
    s_add_u32 s28, s28, 4096
    v_cvt_pk_bf16_f32 v28, v84, v85
    v_cvt_pk_bf16_f32 v29, v86, v87
    v_cvt_pk_bf16_f32 v30, v104, v105
    v_cvt_pk_bf16_f32 v31, v106, v107
    buffer_store_dwordx4 v[28:31], v4, s[16:19], s28 offen offset:0 sc1
    s_lshl_b32 s30, s6, 7
    s_lshl_b32 s31, s5, 2
    s_add_u32 s30, s30, s31
    s_add_u32 s30, s30, 27776
    s_mov_b64 exec, 1
    s_lshl_b32 s30, s30, 0
    s_add_u32 s30, s30, 48234496
    v_mov_b32 v5, 2
    s_add_u32 s28, s100, 0
    v_mov_b32 v4, s28
    s_waitcnt vmcnt(0)
    s_mov_b32 s28, 0
    v_mov_b32 v7, 128
L_prjkv:
    v_readfirstlane_b32 s29, v3
    s_add_u32 s28, s28, 1
    s_cmp_gt_u32 s28, 0x40000
    s_cbranch_scc1 L_prdjkv
    s_cmp_lg_u32 s29, 0
    s_cbranch_scc1 L_prdjkv
    buffer_load_dword v3, v7, s[24:27], 0 offen sc1
    s_waitcnt vmcnt(0)
    s_branch L_prjkv
L_prdjkv:
    v_mov_b32 v7, 0
    ds_add_rtn_u32 v6, v4, v5
    s_waitcnt lgkmcnt(0)
    v_readfirstlane_b32 s29, v6
    s_cmp_lg_u32 s29, 6
    s_cbranch_scc1 L_sejkv
    buffer_store_dword v5, v7, s[16:19], s30 offen sc1
    v_mov_b32 v6, 16
    ds_write_b32 v4, v6
L_sejkv:
    s_mov_b64 exec, -1
    s_branch L_st1
L_jmod:
    s_sub_u32 s4, s75, 48
    s_cmp_ge_u32 s75, 108
    s_cbranch_scc1 L_jln0
    s_lshr_b32 s60, s75, 1
    s_and_b32 s61, s75, 1
    v_lshrrev_b32 v4, 3, v0
    v_mul_u32_u24 v4, 13824, v4
    v_and_b32 v5, 7, v0
    v_lshl_add_u32 v4, v5, 4, v4
    s_lshl_b32 s62, s61, 3
    s_add_u32 s62, s62, s3
    v_min_u32 v6, 17, v0
    v_lshlrev_b32 v7, 3, v6
    s_mul_i32 s29, s62, 144
    s_waitcnt lgkmcnt(0)
    s_sub_u32 s28, s75, 56
    s_cmp_ge_u32 s28, 16
    s_cbranch_scc1 L_jmod_nz
    s_mov_b32 s16, s58
    s_mov_b32 s17, s59
    s_mov_b32 s18, 50331648
    s_mov_b32 s19, 0x20000
    s_lshl_b32 s28, s28, 3
    s_add_u32 s28, s28, s3
    s_lshl_b32 s28, s28, 8
    s_add_u32 s28, s28, 48234496
    v_lshlrev_b32 v20, 2, v0
    v_mov_b32 v16, 0
    buffer_store_dword v16, v20, s[16:19], s28 offen sc1
L_jmod_nz:
    s_cmp_lt_u32 s75, 72
    s_cbranch_scc1 L_jmod_nx
    s_lshl_b32 s5, s4, 3
    s_add_u32 s5, s5, s3
    v_and_b32 v21, 1, v2
    v_lshlrev_b32 v21, 1, v21
    v_and_b32 v22, 2, v2
    v_lshl_or_b32 v21, v22, 2, v21
    v_xor_b32 v21, v21, v1
    v_mul_u32_u24 v22, 2304, v2
    v_lshl_add_u32 v21, v21, 4, v22
    s_mul_i32 s6, s5, 9216
    s_mul_i32 s7, s3, 9216
    s_mov_b32 s24, s36
    s_mov_b32 s25, s37
    s_mov_b32 s26, 4718592
    s_mov_b32 s27, 0x20000
    s_add_u32 m0, s7, 0
    s_add_u32 s28, s6, 0
    buffer_load_dwordx4 v21, s[24:27], s28 offen lds
    s_add_u32 m0, s7, 1024
    s_add_u32 s28, s6, 256
    buffer_load_dwordx4 v21, s[24:27], s28 offen lds
    s_add_u32 m0, s7, 2048
    s_add_u32 s28, s6, 512
    buffer_load_dwordx4 v21, s[24:27], s28 offen lds
    s_add_u32 m0, s7, 3072
    s_add_u32 s28, s6, 768
    buffer_load_dwordx4 v21, s[24:27], s28 offen lds
    s_add_u32 m0, s7, 4096
    s_add_u32 s28, s6, 1024
    buffer_load_dwordx4 v21, s[24:27], s28 offen lds
    s_add_u32 m0, s7, 5120
    s_add_u32 s28, s6, 1280
    buffer_load_dwordx4 v21, s[24:27], s28 offen lds
    s_add_u32 m0, s7, 6144
    s_add_u32 s28, s6, 1536
    buffer_load_dwordx4 v21, s[24:27], s28 offen lds
    s_add_u32 m0, s7, 7168
    s_add_u32 s28, s6, 1792
    buffer_load_dwordx4 v21, s[24:27], s28 offen lds
    s_add_u32 m0, s7, 8192
    s_add_u32 s28, s6, 2048
    buffer_load_dwordx4 v21, s[24:27], s28 offen lds
L_jmod_nx:
    s_mov_b32 s12, s38
    s_mov_b32 s13, s39
    s_mov_b32 s14, 4608
    s_mov_b32 s15, 0x20000
    s_mov_b32 s8, s52
    s_mov_b32 s9, s53
    s_mov_b32 s10, 15925248
    s_mov_b32 s11, 0x20000
    buffer_load_dwordx2 v[8:9], v7, s[12:15], s29 offen
    buffer_load_dwordx2 v[10:11], v7, s[12:15], s29 offen offset:2304
    s_mul_i32 s28, s62, 995328
    s_lshl_b32 s29, s60, 7
    s_add_u32 s28, s28, s29
    buffer_load_dwordx4 v[48:51], v4, s[8:11], s28 offen
    s_add_u32 s28, s28, 110592
    buffer_load_dwordx4 v[52:55], v4, s[8:11], s28 offen
    s_add_u32 s28, s28, 110592
    buffer_load_dwordx4 v[56:59], v4, s[8:11], s28 offen
    s_add_u32 s28, s28, 110592
    buffer_load_dwordx4 v[60:63], v4, s[8:11], s28 offen
    s_add_u32 s28, s28, 110592
    buffer_load_dwordx4 v[64:67], v4, s[8:11], s28 offen
    s_add_u32 s28, s28, 110592
    buffer_load_dwordx4 v[68:71], v4, s[8:11], s28 offen
    s_add_u32 s28, s28, 110592
    buffer_load_dwordx4 v[72:75], v4, s[8:11], s28 offen
    s_add_u32 s28, s28, 110592
    buffer_load_dwordx4 v[76:79], v4, s[8:11], s28 offen
    s_add_u32 s28, s28, 110592
    buffer_load_dwordx4 v[80:83], v4, s[8:11], s28 offen
    s_getpc_b64 s[32:33]
L_tb8_5:
    s_lshl_b32 s34, s2, 4
    s_add_u32 s34, s34, L_tab8-L_tb8_5
    s_load_dwordx4 s[96:99], s[32:33], s34
    s_mov_b32 s16, s58
    s_mov_b32 s17, s59
    s_mov_b32 s18, 50331648
    s_mov_b32 s19, 0x20000
    s_mov_b32 s20, s56
    s_mov_b32 s21, s57
    s_mov_b32 s22, 256
    s_mov_b32 s23, 0x20000
    s_mov_b32 s30, 0xffff0000
    s_waitcnt vmcnt(9)
    v_lshlrev_b32 v12, 16, v8
    v_and_b32 v14, s30, v8
    v_lshlrev_b32 v16, 16, v9
    v_and_b32 v18, s30, v9
    v_lshlrev_b32 v13, 16, v10
    v_and_b32 v15, s30, v10
    v_lshlrev_b32 v17, 16, v11
    v_and_b32 v19, s30, v11
    v_mul_f32 v40, -1.4426950408889634, v12
    v_mul_f32 v41, -1.4426950408889634, v13
    v_mul_f32 v42, -1.4426950408889634, v14
    v_mul_f32 v43, -1.4426950408889634, v15
    v_mul_f32 v44, -1.4426950408889634, v16
    v_mul_f32 v45, -1.4426950408889634, v17
    v_mul_f32 v46, -1.4426950408889634, v18
    v_mul_f32 v47, -1.4426950408889634, v19
    v_exp_f32 v40, v40
    v_exp_f32 v41, v41
    v_exp_f32 v42, v42
    v_exp_f32 v43, v43
    v_exp_f32 v44, v44
    v_exp_f32 v45, v45
    v_exp_f32 v46, v46
    v_exp_f32 v47, v47
    v_add_f32 v40, 1.0, v40
    v_add_f32 v41, 1.0, v41
    v_add_f32 v42, 1.0, v42
    v_add_f32 v43, 1.0, v43
    v_add_f32 v44, 1.0, v44
    v_add_f32 v45, 1.0, v45
    v_add_f32 v46, 1.0, v46
    v_add_f32 v47, 1.0, v47
    v_rcp_f32 v40, v40
    v_rcp_f32 v41, v41
    v_rcp_f32 v42, v42
    v_rcp_f32 v43, v43
    v_rcp_f32 v44, v44
    v_rcp_f32 v45, v45
    v_rcp_f32 v46, v46
    v_rcp_f32 v47, v47
    v_mul_f32 v12, v12, v40
    v_mul_f32 v13, v13, v41
    v_mul_f32 v14, v14, v42
    v_mul_f32 v15, v15, v43
    v_mul_f32 v16, v16, v44
    v_mul_f32 v17, v17, v45
    v_mul_f32 v18, v18, v46
    v_mul_f32 v19, v19, v47
    v_cvt_pk_bf16_f32 v20, v12, v13
    v_lshlrev_b32 v12, 16, v20
    v_and_b32 v13, s30, v20
    v_cvt_pk_bf16_f32 v20, v14, v15
    v_lshlrev_b32 v14, 16, v20
    v_and_b32 v15, s30, v20
    v_cvt_pk_bf16_f32 v20, v16, v17
    v_lshlrev_b32 v16, 16, v20
    v_and_b32 v17, s30, v20
    v_cvt_pk_bf16_f32 v20, v18, v19
    v_lshlrev_b32 v18, 16, v20
    v_and_b32 v19, s30, v20
    s_mul_i32 s31, s3, 576
    s_add_u32 s31, s31, 81920
    v_lshl_add_u32 v6, v6, 5, s31
    ds_write_b128 v6, v[12:15]
    ds_write_b128 v6, v[16:19] offset:16
    v_lshrrev_b32 v7, 3, v0
    v_lshl_add_u32 v7, v7, 3, s31
    v_lshlrev_b32 v5, 6, v5
    v_lshl_add_u32 v5, v2, 4, v5
    s_lshl_b32 s31, s3, 9
    s_add_u32 s31, s31, 73728
    v_add_u32 v5, s31, v5
    s_waitcnt lgkmcnt(0)
    ds_read_b64 v[84:85], v7 offset:0
    ds_read_b64 v[86:87], v7 offset:64
    ds_read_b64 v[88:89], v7 offset:128
    ds_read_b64 v[90:91], v7 offset:192
    ds_read_b64 v[92:93], v7 offset:256
    ds_read_b64 v[94:95], v7 offset:320
    ds_read_b64 v[96:97], v7 offset:384
    ds_read_b64 v[98:99], v7 offset:448
    ds_read_b64 v[100:101], v7 offset:512
    s_mov_b32 s63, 0
L_jmod_pass:
    s_waitcnt lgkmcnt(0)
    v_mov_b32 v24, 0
    v_mov_b32 v25, 0
    v_mov_b32 v26, 0
    v_mov_b32 v27, 0
    v_mov_b32 v28, 0
    v_mov_b32 v29, 0
    v_mov_b32 v30, 0
    v_mov_b32 v31, 0
    v_mov_b32 v32, 0
    v_mov_b32 v33, 0
    v_mov_b32 v34, 0
    v_mov_b32 v35, 0
    v_mov_b32 v36, 0
    v_mov_b32 v37, 0
    v_mov_b32 v38, 0
    v_mov_b32 v39, 0
    s_waitcnt vmcnt(8)
    v_lshlrev_b32 v40, 16, v48
    v_and_b32 v41, s30, v48
    v_lshlrev_b32 v42, 16, v49
    v_and_b32 v43, s30, v49
    v_lshlrev_b32 v44, 16, v50
    v_and_b32 v45, s30, v50
    v_lshlrev_b32 v46, 16, v51
    v_and_b32 v47, s30, v51
    v_pk_fma_f32 v[24:25], v[40:41], v[84:85], v[24:25] op_sel:[0,0,0] op_sel_hi:[0,1,1]
    v_pk_fma_f32 v[26:27], v[40:41], v[84:85], v[26:27] op_sel:[1,0,0] op_sel_hi:[1,1,1]
    v_pk_fma_f32 v[28:29], v[42:43], v[84:85], v[28:29] op_sel:[0,0,0] op_sel_hi:[0,1,1]
    v_pk_fma_f32 v[30:31], v[42:43], v[84:85], v[30:31] op_sel:[1,0,0] op_sel_hi:[1,1,1]
    v_pk_fma_f32 v[32:33], v[44:45], v[84:85], v[32:33] op_sel:[0,0,0] op_sel_hi:[0,1,1]
    v_pk_fma_f32 v[34:35], v[44:45], v[84:85], v[34:35] op_sel:[1,0,0] op_sel_hi:[1,1,1]
    v_pk_fma_f32 v[36:37], v[46:47], v[84:85], v[36:37] op_sel:[0,0,0] op_sel_hi:[0,1,1]
    v_pk_fma_f32 v[38:39], v[46:47], v[84:85], v[38:39] op_sel:[1,0,0] op_sel_hi:[1,1,1]
    s_waitcnt vmcnt(7)
    v_lshlrev_b32 v40, 16, v52
    v_and_b32 v41, s30, v52
    v_lshlrev_b32 v42, 16, v53
    v_and_b32 v43, s30, v53
    v_lshlrev_b32 v44, 16, v54
    v_and_b32 v45, s30, v54
    v_lshlrev_b32 v46, 16, v55
    v_and_b32 v47, s30, v55
    v_pk_fma_f32 v[24:25], v[40:41], v[86:87], v[24:25] op_sel:[0,0,0] op_sel_hi:[0,1,1]
    v_pk_fma_f32 v[26:27], v[40:41], v[86:87], v[26:27] op_sel:[1,0,0] op_sel_hi:[1,1,1]
    v_pk_fma_f32 v[28:29], v[42:43], v[86:87], v[28:29] op_sel:[0,0,0] op_sel_hi:[0,1,1]
    v_pk_fma_f32 v[30:31], v[42:43], v[86:87], v[30:31] op_sel:[1,0,0] op_sel_hi:[1,1,1]
    v_pk_fma_f32 v[32:33], v[44:45], v[86:87], v[32:33] op_sel:[0,0,0] op_sel_hi:[0,1,1]
    v_pk_fma_f32 v[34:35], v[44:45], v[86:87], v[34:35] op_sel:[1,0,0] op_sel_hi:[1,1,1]
    v_pk_fma_f32 v[36:37], v[46:47], v[86:87], v[36:37] op_sel:[0,0,0] op_sel_hi:[0,1,1]
    v_pk_fma_f32 v[38:39], v[46:47], v[86:87], v[38:39] op_sel:[1,0,0] op_sel_hi:[1,1,1]
    s_waitcnt vmcnt(6)
    v_lshlrev_b32 v40, 16, v56
    v_and_b32 v41, s30, v56
    v_lshlrev_b32 v42, 16, v57
    v_and_b32 v43, s30, v57
    v_lshlrev_b32 v44, 16, v58
    v_and_b32 v45, s30, v58
    v_lshlrev_b32 v46, 16, v59
    v_and_b32 v47, s30, v59
    v_pk_fma_f32 v[24:25], v[40:41], v[88:89], v[24:25] op_sel:[0,0,0] op_sel_hi:[0,1,1]
    v_pk_fma_f32 v[26:27], v[40:41], v[88:89], v[26:27] op_sel:[1,0,0] op_sel_hi:[1,1,1]
    v_pk_fma_f32 v[28:29], v[42:43], v[88:89], v[28:29] op_sel:[0,0,0] op_sel_hi:[0,1,1]
    v_pk_fma_f32 v[30:31], v[42:43], v[88:89], v[30:31] op_sel:[1,0,0] op_sel_hi:[1,1,1]
    v_pk_fma_f32 v[32:33], v[44:45], v[88:89], v[32:33] op_sel:[0,0,0] op_sel_hi:[0,1,1]
    v_pk_fma_f32 v[34:35], v[44:45], v[88:89], v[34:35] op_sel:[1,0,0] op_sel_hi:[1,1,1]
    v_pk_fma_f32 v[36:37], v[46:47], v[88:89], v[36:37] op_sel:[0,0,0] op_sel_hi:[0,1,1]
    v_pk_fma_f32 v[38:39], v[46:47], v[88:89], v[38:39] op_sel:[1,0,0] op_sel_hi:[1,1,1]
    s_waitcnt vmcnt(5)
    v_lshlrev_b32 v40, 16, v60
    v_and_b32 v41, s30, v60
    v_lshlrev_b32 v42, 16, v61
    v_and_b32 v43, s30, v61
    v_lshlrev_b32 v44, 16, v62
    v_and_b32 v45, s30, v62
    v_lshlrev_b32 v46, 16, v63
    v_and_b32 v47, s30, v63
    v_pk_fma_f32 v[24:25], v[40:41], v[90:91], v[24:25] op_sel:[0,0,0] op_sel_hi:[0,1,1]
    v_pk_fma_f32 v[26:27], v[40:41], v[90:91], v[26:27] op_sel:[1,0,0] op_sel_hi:[1,1,1]
    v_pk_fma_f32 v[28:29], v[42:43], v[90:91], v[28:29] op_sel:[0,0,0] op_sel_hi:[0,1,1]
    v_pk_fma_f32 v[30:31], v[42:43], v[90:91], v[30:31] op_sel:[1,0,0] op_sel_hi:[1,1,1]
    v_pk_fma_f32 v[32:33], v[44:45], v[90:91], v[32:33] op_sel:[0,0,0] op_sel_hi:[0,1,1]
    v_pk_fma_f32 v[34:35], v[44:45], v[90:91], v[34:35] op_sel:[1,0,0] op_sel_hi:[1,1,1]
    v_pk_fma_f32 v[36:37], v[46:47], v[90:91], v[36:37] op_sel:[0,0,0] op_sel_hi:[0,1,1]
    v_pk_fma_f32 v[38:39], v[46:47], v[90:91], v[38:39] op_sel:[1,0,0] op_sel_hi:[1,1,1]
    s_waitcnt vmcnt(4)
    v_lshlrev_b32 v40, 16, v64
    v_and_b32 v41, s30, v64
    v_lshlrev_b32 v42, 16, v65
    v_and_b32 v43, s30, v65
    v_lshlrev_b32 v44, 16, v66
    v_and_b32 v45, s30, v66
    v_lshlrev_b32 v46, 16, v67
    v_and_b32 v47, s30, v67
    v_pk_fma_f32 v[24:25], v[40:41], v[92:93], v[24:25] op_sel:[0,0,0] op_sel_hi:[0,1,1]
    v_pk_fma_f32 v[26:27], v[40:41], v[92:93], v[26:27] op_sel:[1,0,0] op_sel_hi:[1,1,1]
    v_pk_fma_f32 v[28:29], v[42:43], v[92:93], v[28:29] op_sel:[0,0,0] op_sel_hi:[0,1,1]
    v_pk_fma_f32 v[30:31], v[42:43], v[92:93], v[30:31] op_sel:[1,0,0] op_sel_hi:[1,1,1]
    v_pk_fma_f32 v[32:33], v[44:45], v[92:93], v[32:33] op_sel:[0,0,0] op_sel_hi:[0,1,1]
    v_pk_fma_f32 v[34:35], v[44:45], v[92:93], v[34:35] op_sel:[1,0,0] op_sel_hi:[1,1,1]
    v_pk_fma_f32 v[36:37], v[46:47], v[92:93], v[36:37] op_sel:[0,0,0] op_sel_hi:[0,1,1]
    v_pk_fma_f32 v[38:39], v[46:47], v[92:93], v[38:39] op_sel:[1,0,0] op_sel_hi:[1,1,1]
    s_waitcnt vmcnt(3)
    v_lshlrev_b32 v40, 16, v68
    v_and_b32 v41, s30, v68
    v_lshlrev_b32 v42, 16, v69
    v_and_b32 v43, s30, v69
    v_lshlrev_b32 v44, 16, v70
    v_and_b32 v45, s30, v70
    v_lshlrev_b32 v46, 16, v71
    v_and_b32 v47, s30, v71
    v_pk_fma_f32 v[24:25], v[40:41], v[94:95], v[24:25] op_sel:[0,0,0] op_sel_hi:[0,1,1]
    v_pk_fma_f32 v[26:27], v[40:41], v[94:95], v[26:27] op_sel:[1,0,0] op_sel_hi:[1,1,1]
    v_pk_fma_f32 v[28:29], v[42:43], v[94:95], v[28:29] op_sel:[0,0,0] op_sel_hi:[0,1,1]
    v_pk_fma_f32 v[30:31], v[42:43], v[94:95], v[30:31] op_sel:[1,0,0] op_sel_hi:[1,1,1]
    v_pk_fma_f32 v[32:33], v[44:45], v[94:95], v[32:33] op_sel:[0,0,0] op_sel_hi:[0,1,1]
    v_pk_fma_f32 v[34:35], v[44:45], v[94:95], v[34:35] op_sel:[1,0,0] op_sel_hi:[1,1,1]
    v_pk_fma_f32 v[36:37], v[46:47], v[94:95], v[36:37] op_sel:[0,0,0] op_sel_hi:[0,1,1]
    v_pk_fma_f32 v[38:39], v[46:47], v[94:95], v[38:39] op_sel:[1,0,0] op_sel_hi:[1,1,1]
    s_waitcnt vmcnt(2)
    v_lshlrev_b32 v40, 16, v72
    v_and_b32 v41, s30, v72
    v_lshlrev_b32 v42, 16, v73
    v_and_b32 v43, s30, v73
    v_lshlrev_b32 v44, 16, v74
    v_and_b32 v45, s30, v74
    v_lshlrev_b32 v46, 16, v75
    v_and_b32 v47, s30, v75
    v_pk_fma_f32 v[24:25], v[40:41], v[96:97], v[24:25] op_sel:[0,0,0] op_sel_hi:[0,1,1]
    v_pk_fma_f32 v[26:27], v[40:41], v[96:97], v[26:27] op_sel:[1,0,0] op_sel_hi:[1,1,1]
    v_pk_fma_f32 v[28:29], v[42:43], v[96:97], v[28:29] op_sel:[0,0,0] op_sel_hi:[0,1,1]
    v_pk_fma_f32 v[30:31], v[42:43], v[96:97], v[30:31] op_sel:[1,0,0] op_sel_hi:[1,1,1]
    v_pk_fma_f32 v[32:33], v[44:45], v[96:97], v[32:33] op_sel:[0,0,0] op_sel_hi:[0,1,1]
    v_pk_fma_f32 v[34:35], v[44:45], v[96:97], v[34:35] op_sel:[1,0,0] op_sel_hi:[1,1,1]
    v_pk_fma_f32 v[36:37], v[46:47], v[96:97], v[36:37] op_sel:[0,0,0] op_sel_hi:[0,1,1]
    v_pk_fma_f32 v[38:39], v[46:47], v[96:97], v[38:39] op_sel:[1,0,0] op_sel_hi:[1,1,1]
    s_waitcnt vmcnt(1)
    v_lshlrev_b32 v40, 16, v76
    v_and_b32 v41, s30, v76
    v_lshlrev_b32 v42, 16, v77
    v_and_b32 v43, s30, v77
    v_lshlrev_b32 v44, 16, v78
    v_and_b32 v45, s30, v78
    v_lshlrev_b32 v46, 16, v79
    v_and_b32 v47, s30, v79
    v_pk_fma_f32 v[24:25], v[40:41], v[98:99], v[24:25] op_sel:[0,0,0] op_sel_hi:[0,1,1]
    v_pk_fma_f32 v[26:27], v[40:41], v[98:99], v[26:27] op_sel:[1,0,0] op_sel_hi:[1,1,1]
    v_pk_fma_f32 v[28:29], v[42:43], v[98:99], v[28:29] op_sel:[0,0,0] op_sel_hi:[0,1,1]
    v_pk_fma_f32 v[30:31], v[42:43], v[98:99], v[30:31] op_sel:[1,0,0] op_sel_hi:[1,1,1]
    v_pk_fma_f32 v[32:33], v[44:45], v[98:99], v[32:33] op_sel:[0,0,0] op_sel_hi:[0,1,1]
    v_pk_fma_f32 v[34:35], v[44:45], v[98:99], v[34:35] op_sel:[1,0,0] op_sel_hi:[1,1,1]
    v_pk_fma_f32 v[36:37], v[46:47], v[98:99], v[36:37] op_sel:[0,0,0] op_sel_hi:[0,1,1]
    v_pk_fma_f32 v[38:39], v[46:47], v[98:99], v[38:39] op_sel:[1,0,0] op_sel_hi:[1,1,1]
    s_waitcnt vmcnt(0)
    v_lshlrev_b32 v40, 16, v80
    v_and_b32 v41, s30, v80
    v_lshlrev_b32 v42, 16, v81
    v_and_b32 v43, s30, v81
    v_lshlrev_b32 v44, 16, v82
    v_and_b32 v45, s30, v82
    v_lshlrev_b32 v46, 16, v83
    v_and_b32 v47, s30, v83
    v_pk_fma_f32 v[24:25], v[40:41], v[100:101], v[24:25] op_sel:[0,0,0] op_sel_hi:[0,1,1]
    v_pk_fma_f32 v[26:27], v[40:41], v[100:101], v[26:27] op_sel:[1,0,0] op_sel_hi:[1,1,1]
    v_pk_fma_f32 v[28:29], v[42:43], v[100:101], v[28:29] op_sel:[0,0,0] op_sel_hi:[0,1,1]
    v_pk_fma_f32 v[30:31], v[42:43], v[100:101], v[30:31] op_sel:[1,0,0] op_sel_hi:[1,1,1]
    v_pk_fma_f32 v[32:33], v[44:45], v[100:101], v[32:33] op_sel:[0,0,0] op_sel_hi:[0,1,1]
    v_pk_fma_f32 v[34:35], v[44:45], v[100:101], v[34:35] op_sel:[1,0,0] op_sel_hi:[1,1,1]
    v_pk_fma_f32 v[36:37], v[46:47], v[100:101], v[36:37] op_sel:[0,0,0] op_sel_hi:[0,1,1]
    v_pk_fma_f32 v[38:39], v[46:47], v[100:101], v[38:39] op_sel:[1,0,0] op_sel_hi:[1,1,1]
    s_nop 1
    v_permlane32_swap_b32 v24, v32
    v_permlane32_swap_b32 v25, v33
    v_permlane32_swap_b32 v26, v34
    v_permlane32_swap_b32 v27, v35
    v_permlane32_swap_b32 v28, v36
    v_permlane32_swap_b32 v29, v37
    v_permlane32_swap_b32 v30, v38
    v_permlane32_swap_b32 v31, v39
    v_add_f32 v24, v24, v32
    v_add_f32 v25, v25, v33
    v_add_f32 v26, v26, v34
    v_add_f32 v27, v27, v35
    v_add_f32 v28, v28, v36
    v_add_f32 v29, v29, v37
    v_add_f32 v30, v30, v38
    v_add_f32 v31, v31, v39
    s_nop 1
    v_permlane16_swap_b32 v24, v28
    v_permlane16_swap_b32 v25, v29
    v_permlane16_swap_b32 v26, v30
    v_permlane16_swap_b32 v27, v31
    v_add_f32 v24, v24, v28
    v_add_f32 v25, v25, v29
    v_add_f32 v26, v26, v30
    v_add_f32 v27, v27, v31
    v_add_f32_dpp v24, v24, v24 row_ror:8 row_mask:0xf bank_mask:0xf
    v_add_f32_dpp v25, v25, v25 row_ror:8 row_mask:0xf bank_mask:0xf
    v_add_f32_dpp v26, v26, v26 row_ror:8 row_mask:0xf bank_mask:0xf
    v_add_f32_dpp v27, v27, v27 row_ror:8 row_mask:0xf bank_mask:0xf
    ds_write_b128 v5, v[24:27]
    s_waitcnt lgkmcnt(0)
    s_barrier
    s_cmp_lg_u32 s3, 0
    s_cbranch_scc1 L_jmod_nf
    s_lshl_b32 s31, s63, 12
    s_add_u32 s31, s31, 73728
    v_lshl_add_u32 v7, v0, 3, s31
    ds_read_b64 v[48:49], v7 offset:0
    ds_read_b64 v[50:51], v7 offset:512
    ds_read_b64 v[52:53], v7 offset:1024
    ds_read_b64 v[54:55], v7 offset:1536
    ds_read_b64 v[56:57], v7 offset:2048
    ds_read_b64 v[58:59], v7 offset:2560
    ds_read_b64 v[60:61], v7 offset:3072
    ds_read_b64 v[62:63], v7 offset:3584
    v_lshlrev_b32 v6, 2, v0
    s_mul_i32 s28, s61, 27648
    s_lshl_b32 s29, s60, 8
    s_add_u32 s28, s28, s29
    s_add_u32 s28, s28, 35127296
    s_add_u32 s29, s28, 13824
    s_waitcnt lgkmcnt(0)
    v_pk_add_f32 v[8:9], v[48:49], v[50:51]
    v_pk_add_f32 v[8:9], v[8:9], v[52:53]
    v_pk_add_f32 v[8:9], v[8:9], v[54:55]
    v_pk_add_f32 v[8:9], v[8:9], v[56:57]
    v_pk_add_f32 v[8:9], v[8:9], v[58:59]
    v_pk_add_f32 v[8:9], v[8:9], v[60:61]
    v_pk_add_f32 v[8:9], v[8:9], v[62:63]
    buffer_store_dword v8, v6, s[16:19], s28 offen sc1
    buffer_store_dword v9, v6, s[16:19], s29 offen sc1
    s_cmp_ge_u32 s75, 72
    s_cbranch_scc1 L_jln2
    v_mov_b32 v12, 1
    v_mov_b32 v14, 1
    v_mov_b32 v13, 0
    s_mov_b64 exec, 1
    s_waitcnt vmcnt(0)
    buffer_atomic_add v12, v13, s[20:23], 0 offen sc0 sc1
    s_mov_b64 exec, -1
    s_cmp_lt_u32 s75, 48
    s_cbranch_scc1 L_jmod_p0
    s_lshl_b32 s5, s4, 3
    s_add_u32 s5, s5, s3
    v_and_b32 v21, 1, v2
    v_lshlrev_b32 v21, 1, v21
    v_and_b32 v22, 2, v2
    v_lshl_or_b32 v21, v22, 2, v21
    v_xor_b32 v21, v21, v1
    v_mul_u32_u24 v22, 2304, v2
    v_lshl_add_u32 v21, v21, 4, v22
    s_mul_i32 s6, s5, 9216
    s_mul_i32 s7, s3, 9216
    s_mov_b32 s24, s36
    s_mov_b32 s25, s37
    s_mov_b32 s26, 4718592
    s_mov_b32 s27, 0x20000
    s_add_u32 m0, s7, 0
    s_add_u32 s28, s6, 0
    buffer_load_dwordx4 v21, s[24:27], s28 offen lds
    s_add_u32 m0, s7, 1024
    s_add_u32 s28, s6, 256
    buffer_load_dwordx4 v21, s[24:27], s28 offen lds
    s_add_u32 m0, s7, 2048
    s_add_u32 s28, s6, 512
    buffer_load_dwordx4 v21, s[24:27], s28 offen lds
    s_add_u32 m0, s7, 3072
    s_add_u32 s28, s6, 768
    buffer_load_dwordx4 v21, s[24:27], s28 offen lds
    s_add_u32 m0, s7, 4096
    s_add_u32 s28, s6, 1024
    buffer_load_dwordx4 v21, s[24:27], s28 offen lds
    s_add_u32 m0, s7, 5120
    s_add_u32 s28, s6, 1280
    buffer_load_dwordx4 v21, s[24:27], s28 offen lds
    s_add_u32 m0, s7, 6144
    s_add_u32 s28, s6, 1536
    buffer_load_dwordx4 v21, s[24:27], s28 offen lds
    s_add_u32 m0, s7, 7168
    s_add_u32 s28, s6, 1792
    buffer_load_dwordx4 v21, s[24:27], s28 offen lds
    s_add_u32 m0, s7, 8192
    s_add_u32 s28, s6, 2048
    buffer_load_dwordx4 v21, s[24:27], s28 offen lds
    s_waitcnt vmcnt(9)
    v_readfirstlane_b32 s29, v12
    s_cmp_lg_u32 s29, 1
    s_cbranch_scc1 L_jmod_p1
L_jmod_p0:
    s_waitcnt vmcnt(0)
L_jmod_p1:
    s_mov_b64 exec, 1
    v_readfirstlane_b32 s29, v12
    s_cmp_lg_u32 s29, 71
    s_cbranch_scc1 L_jmod_nl
    buffer_store_dword v14, v13, s[20:23], 0 offen offset:128 sc1
    s_waitcnt vmcnt(0)
L_jmod_nl:
    s_mov_b64 exec, -1
    s_cmp_ge_u32 s75, 48
    s_cbranch_scc1 L_jln2
L_jmod_nf:
    s_cmp_ge_u32 s75, 72
    s_cbranch_scc1 L_jln2
    s_cmp_ge_u32 s75, 48
    s_cbranch_scc1 L_jln
    s_lshl_b32 s31, s75, 3
    s_add_u32 s31, s31, s3
    s_mov_b32 s63, 0
    s_sub_u32 s28, s3, 1
    s_cmp_lt_u32 s28, 3
    s_cselect_b32 s64, 1, 0
    s_cbranch_scc1 L_jmod_tl
    s_barrier
L_jmod_tl:
    s_sub_u32 s28, s31, 0
    s_cmp_ge_u32 s28, 324
    s_cbranch_scc1 L_it2_0
    s_lshl_b32 s28, s28, 6
    v_add_u32 v4, s28, v0
    v_lshlrev_b32 v4, 7, v4
    s_mov_b32 s24, s44
    s_mov_b32 s25, s45
    s_mov_b32 s26, 2654208
    s_mov_b32 s27, 0x20000
    s_mov_b32 s29, 0
    buffer_load_dword v3, v4, s[24:27], s29 offen
L_it2_0:
    s_sub_u32 s28, s31, 324
    s_cmp_ge_u32 s28, 324
    s_cbranch_scc1 L_it2_1
    s_lshl_b32 s28, s28, 6
    v_add_u32 v4, s28, v0
    s_mov_b32 s29, 58255
    v_mul_lo_u32 v5, v4, s29
    v_lshrrev_b32 v5, 20, v5
    v_mul_u32_u24 v5, 4608, v5
    v_lshl_add_u32 v4, v4, 7, v5
    s_mov_b32 s24, s42
    s_mov_b32 s25, s43
    s_mov_b32 s26, 7962624
    s_mov_b32 s27, 0x20000
    s_mov_b32 s29, 4608
    buffer_load_dword v3, v4, s[24:27], s29 offen
L_it2_1:
    s_cmp_eq_u32 s64, 0
    s_cbranch_scc1 L_jmod_t2
    s_mov_b32 s64, 0
    s_barrier
L_jmod_t2:
    s_add_u32 s31, s31, 384
    s_add_u32 s63, s63, 1
    s_cmp_lt_u32 s63, 2
    s_cbranch_scc1 L_jmod_tl
L_pure_go:
    v_mov_b32 v4, 159744
    v_mov_b32 v5, 16
    ds_write_b32 v4, v5
    s_waitcnt lgkmcnt(0)
    s_branch L_st1
L_jln0:
    s_getpc_b64 s[32:33]
L_tb8_6:
    s_lshl_b32 s34, s2, 4
    s_add_u32 s34, s34, L_tab8-L_tb8_6
    s_load_dwordx4 s[96:99], s[32:33], s34
L_jln:
    s_waitcnt lgkmcnt(0)
    s_mov_b32 s16, s58
    s_mov_b32 s17, s59
    s_mov_b32 s18, 50331648
    s_mov_b32 s19, 0x20000
    s_lshl_b32 s5, s4, 3
    s_add_u32 s5, s5, s3
    v_and_b32 v21, 1, v2
    v_lshlrev_b32 v21, 1, v21
    v_and_b32 v22, 2, v2
    v_lshl_or_b32 v21, v22, 2, v21
    v_xor_b32 v21, v21, v1
    v_mul_u32_u24 v22, 2304, v2
    v_lshl_add_u32 v21, v21, 4, v22
    s_mul_i32 s6, s5, 9216
    s_mul_i32 s7, s3, 9216
    s_mov_b32 s24, s36
    s_mov_b32 s25, s37
    s_mov_b32 s26, 4718592
    s_mov_b32 s27, 0x20000
    s_add_u32 m0, s7, 0
    s_add_u32 s28, s6, 0
    buffer_load_dwordx4 v21, s[24:27], s28 offen lds
    s_add_u32 m0, s7, 1024
    s_add_u32 s28, s6, 256
    buffer_load_dwordx4 v21, s[24:27], s28 offen lds
    s_add_u32 m0, s7, 2048
    s_add_u32 s28, s6, 512
    buffer_load_dwordx4 v21, s[24:27], s28 offen lds
    s_add_u32 m0, s7, 3072
    s_add_u32 s28, s6, 768
    buffer_load_dwordx4 v21, s[24:27], s28 offen lds
    s_add_u32 m0, s7, 4096
    s_add_u32 s28, s6, 1024
    buffer_load_dwordx4 v21, s[24:27], s28 offen lds
    s_add_u32 m0, s7, 5120
    s_add_u32 s28, s6, 1280
    buffer_load_dwordx4 v21, s[24:27], s28 offen lds
    s_add_u32 m0, s7, 6144
    s_add_u32 s28, s6, 1536
    buffer_load_dwordx4 v21, s[24:27], s28 offen lds
    s_add_u32 m0, s7, 7168
    s_add_u32 s28, s6, 1792
    buffer_load_dwordx4 v21, s[24:27], s28 offen lds
    s_add_u32 m0, s7, 8192
    s_add_u32 s28, s6, 2048
    buffer_load_dwordx4 v21, s[24:27], s28 offen lds
L_jln2:
    v_and_b32 v4, 3, v0
    v_and_b32 v5, 1, v4
    v_lshlrev_b32 v5, 1, v5
    v_and_b32 v6, 2, v4
    v_lshl_or_b32 v5, v6, 2, v5
    v_bfe_u32 v6, v0, 3, 1
    v_lshl_add_u32 v6, v2, 2, v6
    v_xor_b32 v5, v5, v6
    v_lshlrev_b32 v5, 4, v5
    v_lshl_add_u32 v5, v4, 8, v5
    v_bfe_u32 v6, v0, 2, 1
    v_lshl_add_u32 v5, v6, 3, v5
    v_add_u32 v5, s7, v5
    v_xor_b32 v6, 32, v5
    v_bfe_u32 v7, v0, 2, 2
    v_lshl_add_u32 v7, v7, 4, v4
    s_and_b32 s28, s5, 3
    s_lshl_b32 s28, s28, 2
    v_add_u32 v7, s28, v7
    v_lshlrev_b32 v7, 4, v7
    v_and_b32 v8, 1, v2
    v_lshl_add_u32 v7, v8, 10, v7
    v_lshrrev_b32 v8, 1, v2
    v_lshl_add_u32 v7, v8, 18, v7
    s_lshr_b32 s28, s5, 2
    s_lshl_b32 s28, s28, 11
    s_add_u32 s28, s28, 5242880
    s_mov_b32 s30, 0xffff0000
    s_mov_b32 s20, s56
    s_mov_b32 s21, s57
    s_mov_b32 s22, 256
    s_mov_b32 s23, 0x20000
    v_mov_b32 v136, 128
    s_lshr_b32 s62, s4, 5
    s_mul_i32 s62, s62, 13824
    s_add_u32 s62, s62, 35127296
    s_add_u32 s63, s62, 27648
    s_mul_i32 s31, s3, 1152
    v_lshl_add_u32 v137, v0, 4, s31
    v_min_u32 v138, 7, v0
    v_lshl_add_u32 v138, v138, 4, s31
    v_add_u32 v138, 1024, v138
    s_waitcnt vmcnt(8)
    ds_read_b64 v[84:85], v5 offset:0
    ds_read_b64 v[86:87], v6 offset:0
    s_waitcnt vmcnt(7)
    ds_read_b64 v[88:89], v5 offset:1024
    ds_read_b64 v[90:91], v6 offset:1024
    s_waitcnt vmcnt(6)
    ds_read_b64 v[92:93], v5 offset:2048
    ds_read_b64 v[94:95], v6 offset:2048
    s_waitcnt vmcnt(5)
    ds_read_b64 v[96:97], v5 offset:3072
    ds_read_b64 v[98:99], v6 offset:3072
    s_waitcnt vmcnt(4)
    ds_read_b64 v[100:101], v5 offset:4096
    ds_read_b64 v[102:103], v6 offset:4096
    s_waitcnt vmcnt(3)
    ds_read_b64 v[104:105], v5 offset:5120
    ds_read_b64 v[106:107], v6 offset:5120
    buffer_load_dword v139, v136, s[20:23], 0 offen sc1
    s_waitcnt vmcnt(3)
    ds_read_b64 v[108:109], v5 offset:6144
    ds_read_b64 v[110:111], v6 offset:6144
    s_waitcnt vmcnt(2)
    ds_read_b64 v[112:113], v5 offset:7168
    ds_read_b64 v[114:115], v6 offset:7168
    s_waitcnt vmcnt(1)
    ds_read_b64 v[116:117], v5 offset:8192
    ds_read_b64 v[118:119], v6 offset:8192
    v_mov_b32 v8, 0
    v_mov_b32 v9, 0
    s_waitcnt lgkmcnt(15)
    v_lshlrev_b32 v12, 16, v84
    v_and_b32 v13, s30, v84
    v_pk_add_f32 v[8:9], v[8:9], v[12:13]
    v_lshlrev_b32 v14, 16, v85
    v_and_b32 v15, s30, v85
    v_pk_add_f32 v[8:9], v[8:9], v[14:15]
    v_lshlrev_b32 v16, 16, v86
    v_and_b32 v17, s30, v86
    v_pk_add_f32 v[8:9], v[8:9], v[16:17]
    v_lshlrev_b32 v18, 16, v87
    v_and_b32 v19, s30, v87
    v_pk_add_f32 v[8:9], v[8:9], v[18:19]
    s_waitcnt lgkmcnt(14)
    v_lshlrev_b32 v20, 16, v88
    v_and_b32 v21, s30, v88
    v_pk_add_f32 v[8:9], v[8:9], v[20:21]
    v_lshlrev_b32 v22, 16, v89
    v_and_b32 v23, s30, v89
    v_pk_add_f32 v[8:9], v[8:9], v[22:23]
    v_lshlrev_b32 v24, 16, v90
    v_and_b32 v25, s30, v90
    v_pk_add_f32 v[8:9], v[8:9], v[24:25]
    v_lshlrev_b32 v26, 16, v91
    v_and_b32 v27, s30, v91
    v_pk_add_f32 v[8:9], v[8:9], v[26:27]
    s_waitcnt lgkmcnt(12)
    v_lshlrev_b32 v28, 16, v92
    v_and_b32 v29, s30, v92
    v_pk_add_f32 v[8:9], v[8:9], v[28:29]
    v_lshlrev_b32 v30, 16, v93
    v_and_b32 v31, s30, v93
    v_pk_add_f32 v[8:9], v[8:9], v[30:31]
    v_lshlrev_b32 v32, 16, v94
    v_and_b32 v33, s30, v94
    v_pk_add_f32 v[8:9], v[8:9], v[32:33]
    v_lshlrev_b32 v34, 16, v95
    v_and_b32 v35, s30, v95
    v_pk_add_f32 v[8:9], v[8:9], v[34:35]
    s_waitcnt lgkmcnt(10)
    v_lshlrev_b32 v36, 16, v96
    v_and_b32 v37, s30, v96
    v_pk_add_f32 v[8:9], v[8:9], v[36:37]
    v_lshlrev_b32 v38, 16, v97
    v_and_b32 v39, s30, v97
    v_pk_add_f32 v[8:9], v[8:9], v[38:39]
    v_lshlrev_b32 v40, 16, v98
    v_and_b32 v41, s30, v98
    v_pk_add_f32 v[8:9], v[8:9], v[40:41]
    v_lshlrev_b32 v42, 16, v99
    v_and_b32 v43, s30, v99
    v_pk_add_f32 v[8:9], v[8:9], v[42:43]
    s_waitcnt lgkmcnt(8)
    v_lshlrev_b32 v44, 16, v100
    v_and_b32 v45, s30, v100
    v_pk_add_f32 v[8:9], v[8:9], v[44:45]
    v_lshlrev_b32 v46, 16, v101
    v_and_b32 v47, s30, v101
    v_pk_add_f32 v[8:9], v[8:9], v[46:47]
    v_lshlrev_b32 v48, 16, v102
    v_and_b32 v49, s30, v102
    v_pk_add_f32 v[8:9], v[8:9], v[48:49]
    v_lshlrev_b32 v50, 16, v103
    v_and_b32 v51, s30, v103
    v_pk_add_f32 v[8:9], v[8:9], v[50:51]
    s_waitcnt lgkmcnt(6)
    v_lshlrev_b32 v52, 16, v104
    v_and_b32 v53, s30, v104
    v_pk_add_f32 v[8:9], v[8:9], v[52:53]
    v_lshlrev_b32 v54, 16, v105
    v_and_b32 v55, s30, v105
    v_pk_add_f32 v[8:9], v[8:9], v[54:55]
    v_lshlrev_b32 v56, 16, v106
    v_and_b32 v57, s30, v106
    v_pk_add_f32 v[8:9], v[8:9], v[56:57]
    v_lshlrev_b32 v58, 16, v107
    v_and_b32 v59, s30, v107
    v_pk_add_f32 v[8:9], v[8:9], v[58:59]
    s_waitcnt lgkmcnt(4)
    v_lshlrev_b32 v60, 16, v108
    v_and_b32 v61, s30, v108
    v_pk_add_f32 v[8:9], v[8:9], v[60:61]
    v_lshlrev_b32 v62, 16, v109
    v_and_b32 v63, s30, v109
    v_pk_add_f32 v[8:9], v[8:9], v[62:63]
    v_lshlrev_b32 v64, 16, v110
    v_and_b32 v65, s30, v110
    v_pk_add_f32 v[8:9], v[8:9], v[64:65]
    v_lshlrev_b32 v66, 16, v111
    v_and_b32 v67, s30, v111
    v_pk_add_f32 v[8:9], v[8:9], v[66:67]
    s_waitcnt lgkmcnt(2)
    v_lshlrev_b32 v68, 16, v112
    v_and_b32 v69, s30, v112
    v_pk_add_f32 v[8:9], v[8:9], v[68:69]
    v_lshlrev_b32 v70, 16, v113
    v_and_b32 v71, s30, v113
    v_pk_add_f32 v[8:9], v[8:9], v[70:71]
    v_lshlrev_b32 v72, 16, v114
    v_and_b32 v73, s30, v114
    v_pk_add_f32 v[8:9], v[8:9], v[72:73]
    v_lshlrev_b32 v74, 16, v115
    v_and_b32 v75, s30, v115
    v_pk_add_f32 v[8:9], v[8:9], v[74:75]
    s_waitcnt lgkmcnt(0)
    v_lshlrev_b32 v76, 16, v116
    v_and_b32 v77, s30, v116
    v_pk_add_f32 v[8:9], v[8:9], v[76:77]
    v_lshlrev_b32 v78, 16, v117
    v_and_b32 v79, s30, v117
    v_pk_add_f32 v[8:9], v[8:9], v[78:79]
    v_lshlrev_b32 v80, 16, v118
    v_and_b32 v81, s30, v118
    v_pk_add_f32 v[8:9], v[8:9], v[80:81]
    v_lshlrev_b32 v82, 16, v119
    v_and_b32 v83, s30, v119
    v_pk_add_f32 v[8:9], v[8:9], v[82:83]
    s_waitcnt vmcnt(0)
    v_readfirstlane_b32 s64, v139
    v_add_f32 v8, v8, v9
    s_cmp_eq_u32 s64, 0
    s_cbranch_scc1 L_jln_notyet
    buffer_load_dwordx4 v[120:123], v137, s[16:19], s62 offen sc1
    buffer_load_dwordx4 v[124:127], v138, s[16:19], s62 offen sc1
    buffer_load_dwordx4 v[128:131], v137, s[16:19], s63 offen sc1
    buffer_load_dwordx4 v[132:135], v138, s[16:19], s63 offen sc1
L_jln_notyet:
    s_nop 1
    v_add_f32_dpp v8, v8, v8 row_ror:4 row_mask:0xf bank_mask:0xf
    s_nop 1
    v_add_f32_dpp v8, v8, v8 row_ror:8 row_mask:0xf bank_mask:0xf
    v_mov_b32 v9, v8
    s_nop 1
    v_permlane16_swap_b32 v8, v9
    v_add_f32 v8, v8, v9
    v_mov_b32 v9, v8
    s_nop 1
    v_permlane32_swap_b32 v8, v9
    v_add_f32 v8, v8, v9
    v_mul_f32 v8, -0.0008680555555555555, v8
    v_mov_b32 v9, v8
    v_mov_b32 v10, 0
    v_mov_b32 v11, 0
    v_pk_add_f32 v[12:13], v[12:13], v[8:9]
    v_pk_fma_f32 v[10:11], v[12:13], v[12:13], v[10:11]
    v_pk_add_f32 v[14:15], v[14:15], v[8:9]
    v_pk_fma_f32 v[10:11], v[14:15], v[14:15], v[10:11]
    v_pk_add_f32 v[16:17], v[16:17], v[8:9]
    v_pk_fma_f32 v[10:11], v[16:17], v[16:17], v[10:11]
    v_pk_add_f32 v[18:19], v[18:19], v[8:9]
    v_pk_fma_f32 v[10:11], v[18:19], v[18:19], v[10:11]
    v_pk_add_f32 v[20:21], v[20:21], v[8:9]
    v_pk_fma_f32 v[10:11], v[20:21], v[20:21], v[10:11]
    v_pk_add_f32 v[22:23], v[22:23], v[8:9]
    v_pk_fma_f32 v[10:11], v[22:23], v[22:23], v[10:11]
    v_pk_add_f32 v[24:25], v[24:25], v[8:9]
    v_pk_fma_f32 v[10:11], v[24:25], v[24:25], v[10:11]
    v_pk_add_f32 v[26:27], v[26:27], v[8:9]
    v_pk_fma_f32 v[10:11], v[26:27], v[26:27], v[10:11]
    v_pk_add_f32 v[28:29], v[28:29], v[8:9]
    v_pk_fma_f32 v[10:11], v[28:29], v[28:29], v[10:11]
    v_pk_add_f32 v[30:31], v[30:31], v[8:9]
    v_pk_fma_f32 v[10:11], v[30:31], v[30:31], v[10:11]
    v_pk_add_f32 v[32:33], v[32:33], v[8:9]
    v_pk_fma_f32 v[10:11], v[32:33], v[32:33], v[10:11]
    v_pk_add_f32 v[34:35], v[34:35], v[8:9]
    v_pk_fma_f32 v[10:11], v[34:35], v[34:35], v[10:11]
    v_pk_add_f32 v[36:37], v[36:37], v[8:9]
    v_pk_fma_f32 v[10:11], v[36:37], v[36:37], v[10:11]
    v_pk_add_f32 v[38:39], v[38:39], v[8:9]
    v_pk_fma_f32 v[10:11], v[38:39], v[38:39], v[10:11]
    v_pk_add_f32 v[40:41], v[40:41], v[8:9]
    v_pk_fma_f32 v[10:11], v[40:41], v[40:41], v[10:11]
    v_pk_add_f32 v[42:43], v[42:43], v[8:9]
    v_pk_fma_f32 v[10:11], v[42:43], v[42:43], v[10:11]
    v_pk_add_f32 v[44:45], v[44:45], v[8:9]
    v_pk_fma_f32 v[10:11], v[44:45], v[44:45], v[10:11]
    v_pk_add_f32 v[46:47], v[46:47], v[8:9]
    v_pk_fma_f32 v[10:11], v[46:47], v[46:47], v[10:11]
    v_pk_add_f32 v[48:49], v[48:49], v[8:9]
    v_pk_fma_f32 v[10:11], v[48:49], v[48:49], v[10:11]
    v_pk_add_f32 v[50:51], v[50:51], v[8:9]
    v_pk_fma_f32 v[10:11], v[50:51], v[50:51], v[10:11]
    v_pk_add_f32 v[52:53], v[52:53], v[8:9]
    v_pk_fma_f32 v[10:11], v[52:53], v[52:53], v[10:11]
    v_pk_add_f32 v[54:55], v[54:55], v[8:9]
    v_pk_fma_f32 v[10:11], v[54:55], v[54:55], v[10:11]
    v_pk_add_f32 v[56:57], v[56:57], v[8:9]
    v_pk_fma_f32 v[10:11], v[56:57], v[56:57], v[10:11]
    v_pk_add_f32 v[58:59], v[58:59], v[8:9]
    v_pk_fma_f32 v[10:11], v[58:59], v[58:59], v[10:11]
    v_pk_add_f32 v[60:61], v[60:61], v[8:9]
    v_pk_fma_f32 v[10:11], v[60:61], v[60:61], v[10:11]
    v_pk_add_f32 v[62:63], v[62:63], v[8:9]
    v_pk_fma_f32 v[10:11], v[62:63], v[62:63], v[10:11]
    v_pk_add_f32 v[64:65], v[64:65], v[8:9]
    v_pk_fma_f32 v[10:11], v[64:65], v[64:65], v[10:11]
    v_pk_add_f32 v[66:67], v[66:67], v[8:9]
    v_pk_fma_f32 v[10:11], v[66:67], v[66:67], v[10:11]
    v_pk_add_f32 v[68:69], v[68:69], v[8:9]
    v_pk_fma_f32 v[10:11], v[68:69], v[68:69], v[10:11]
    v_pk_add_f32 v[70:71], v[70:71], v[8:9]
    v_pk_fma_f32 v[10:11], v[70:71], v[70:71], v[10:11]
    v_pk_add_f32 v[72:73], v[72:73], v[8:9]
    v_pk_fma_f32 v[10:11], v[72:73], v[72:73], v[10:11]
    v_pk_add_f32 v[74:75], v[74:75], v[8:9]
    v_pk_fma_f32 v[10:11], v[74:75], v[74:75], v[10:11]
    v_pk_add_f32 v[76:77], v[76:77], v[8:9]
    v_pk_fma_f32 v[10:11], v[76:77], v[76:77], v[10:11]
    v_pk_add_f32 v[78:79], v[78:79], v[8:9]
    v_pk_fma_f32 v[10:11], v[78:79], v[78:79], v[10:11]
    v_pk_add_f32 v[80:81], v[80:81], v[8:9]
    v_pk_fma_f32 v[10:11], v[80:81], v[80:81], v[10:11]
    v_pk_add_f32 v[82:83], v[82:83], v[8:9]
    v_pk_fma_f32 v[10:11], v[82:83], v[82:83], v[10:11]
    v_add_f32 v10, v10, v11
    s_nop 1
    v_add_f32_dpp v10, v10, v10 row_ror:4 row_mask:0xf bank_mask:0xf
    s_nop 1
    v_add_f32_dpp v10, v10, v10 row_ror:8 row_mask:0xf bank_mask:0xf
    v_mov_b32 v11, v10
    s_nop 1
    v_permlane16_swap_b32 v10, v11
    v_add_f32 v10, v10, v11
    v_mov_b32 v11, v10
    s_nop 1
    v_permlane32_swap_b32 v10, v11
    v_add_f32 v10, v10, v11
    v_mov_b32 v11, 0x3727c5ac
    v_fmac_f32 v11, 0.0008680555555555555, v10
    v_rsq_f32 v10, v11
    s_nop 0
    v_mov_b32 v11, v10
    v_pk_mul_f32 v[12:13], v[12:13], v[10:11]
    v_pk_mul_f32 v[14:15], v[14:15], v[10:11]
    v_pk_mul_f32 v[16:17], v[16:17], v[10:11]
    v_pk_mul_f32 v[18:19], v[18:19], v[10:11]
    v_pk_mul_f32 v[20:21], v[20:21], v[10:11]
    v_pk_mul_f32 v[22:23], v[22:23], v[10:11]
    v_pk_mul_f32 v[24:25], v[24:25], v[10:11]
    v_pk_mul_f32 v[26:27], v[26:27], v[10:11]
    v_pk_mul_f32 v[28:29], v[28:29], v[10:11]
    v_pk_mul_f32 v[30:31], v[30:31], v[10:11]
    v_pk_mul_f32 v[32:33], v[32:33], v[10:11]
    v_pk_mul_f32 v[34:35], v[34:35], v[10:11]
    v_pk_mul_f32 v[36:37], v[36:37], v[10:11]
    v_pk_mul_f32 v[38:39], v[38:39], v[10:11]
    v_pk_mul_f32 v[40:41], v[40:41], v[10:11]
    v_pk_mul_f32 v[42:43], v[42:43], v[10:11]
    v_pk_mul_f32 v[44:45], v[44:45], v[10:11]
    v_pk_mul_f32 v[46:47], v[46:47], v[10:11]
    v_pk_mul_f32 v[48:49], v[48:49], v[10:11]
    v_pk_mul_f32 v[50:51], v[50:51], v[10:11]
    v_pk_mul_f32 v[52:53], v[52:53], v[10:11]
    v_pk_mul_f32 v[54:55], v[54:55], v[10:11]
    v_pk_mul_f32 v[56:57], v[56:57], v[10:11]
    v_pk_mul_f32 v[58:59], v[58:59], v[10:11]
    v_pk_mul_f32 v[60:61], v[60:61], v[10:11]
    v_pk_mul_f32 v[62:63], v[62:63], v[10:11]
    v_pk_mul_f32 v[64:65], v[64:65], v[10:11]
    v_pk_mul_f32 v[66:67], v[66:67], v[10:11]
    v_pk_mul_f32 v[68:69], v[68:69], v[10:11]
    v_pk_mul_f32 v[70:71], v[70:71], v[10:11]
    v_pk_mul_f32 v[72:73], v[72:73], v[10:11]
    v_pk_mul_f32 v[74:75], v[74:75], v[10:11]
    v_pk_mul_f32 v[76:77], v[76:77], v[10:11]
    v_pk_mul_f32 v[78:79], v[78:79], v[10:11]
    v_pk_mul_f32 v[80:81], v[80:81], v[10:11]
    v_pk_mul_f32 v[82:83], v[82:83], v[10:11]
    s_cmp_lg_u32 s64, 0
    s_cbranch_scc1 L_jln_have
    s_mov_b32 s31, 0
L_jln_poll:
    buffer_load_dword v139, v136, s[20:23], 0 offen sc1
    s_add_u32 s31, s31, 1
    s_waitcnt vmcnt(0)
    v_cmp_eq_u32 vcc, 0, v139
    s_cmp_gt_u32 s31, 0x100000
    s_cbranch_scc1 L_jln_got
    s_cbranch_vccz L_jln_got
    s_sleep 8
    s_branch L_jln_poll
L_jln_got:
    buffer_load_dwordx4 v[120:123], v137, s[16:19], s62 offen sc1
    buffer_load_dwordx4 v[124:127], v138, s[16:19], s62 offen sc1
    buffer_load_dwordx4 v[128:131], v137, s[16:19], s63 offen sc1
    buffer_load_dwordx4 v[132:135], v138, s[16:19], s63 offen sc1
L_jln_have:
    s_cmp_ge_u32 s3, 4
    s_cselect_b32 s31, 1.0, 0
    v_add_u32 v137, 86528, v137
    v_add_u32 v138, 86528, v138
    s_waitcnt vmcnt(0)
    v_pk_add_f32 v[120:121], v[120:121], v[128:129]
    v_pk_add_f32 v[122:123], v[122:123], v[130:131]
    v_pk_add_f32 v[124:125], v[124:125], v[132:133]
    v_pk_add_f32 v[126:127], v[126:127], v[134:135]
    v_cvt_pk_bf16_f32 v128, v120, v121
    v_cvt_pk_bf16_f32 v129, v122, v123
    v_cvt_pk_bf16_f32 v130, v124, v125
    v_cvt_pk_bf16_f32 v131, v126, v127
    v_lshlrev_b32 v120, 16, v128
    v_and_b32 v121, s30, v128
    v_lshlrev_b32 v122, 16, v129
    v_and_b32 v123, s30, v129
    v_lshlrev_b32 v124, 16, v130
    v_and_b32 v125, s30, v130
    v_lshlrev_b32 v126, 16, v131
    v_and_b32 v127, s30, v131
    v_add_f32 v120, s31, v120
    v_add_f32 v121, s31, v121
    v_add_f32 v122, s31, v122
    v_add_f32 v123, s31, v123
    v_add_f32 v124, s31, v124
    v_add_f32 v125, s31, v125
    v_add_f32 v126, s31, v126
    v_add_f32 v127, s31, v127
    v_cvt_pk_bf16_f32 v128, v120, v121
    v_cvt_pk_bf16_f32 v129, v122, v123
    v_cvt_pk_bf16_f32 v130, v124, v125
    v_cvt_pk_bf16_f32 v131, v126, v127
    v_lshlrev_b32 v120, 16, v128
    v_and_b32 v121, s30, v128
    v_lshlrev_b32 v122, 16, v129
    v_and_b32 v123, s30, v129
    v_lshlrev_b32 v124, 16, v130
    v_and_b32 v125, s30, v130
    v_lshlrev_b32 v126, 16, v131
    v_and_b32 v127, s30, v131
    ds_write_b128 v137, v[120:123]
    ds_write_b128 v138, v[124:127]
    v_bfe_u32 v6, v0, 2, 2
    v_lshlrev_b32 v6, 4, v6
    v_lshl_add_u32 v6, v2, 7, v6
    v_add_u32 v6, 86528, v6
    s_waitcnt lgkmcnt(0)
    s_barrier
    ds_read_b128 v[84:87], v6 offset:4608
    ds_read_b128 v[88:91], v6 offset:4672
    ds_read_b128 v[92:95], v6 offset:0
    ds_read_b128 v[96:99], v6 offset:64
    ds_read_b128 v[100:103], v6 offset:5120
    ds_read_b128 v[104:107], v6 offset:5184
    ds_read_b128 v[108:111], v6 offset:512
    ds_read_b128 v[112:115], v6 offset:576
    s_waitcnt lgkmcnt(4)
    v_pk_fma_f32 v[12:13], v[12:13], v[84:85], v[92:93]
    v_pk_fma_f32 v[14:15], v[14:15], v[86:87], v[94:95]
    v_pk_fma_f32 v[16:17], v[16:17], v[88:89], v[96:97]
    v_pk_fma_f32 v[18:19], v[18:19], v[90:91], v[98:99]
    v_cvt_pk_bf16_f32 v12, v12, v13
    v_cvt_pk_bf16_f32 v13, v14, v15
    v_cvt_pk_bf16_f32 v14, v16, v17
    v_cvt_pk_bf16_f32 v15, v18, v19
    buffer_store_dwordx4 v[12:15], v7, s[16:19], s28 offen sc1
    s_add_u32 s28, s28, 524288
    ds_read_b128 v[84:87], v6 offset:5632
    ds_read_b128 v[88:91], v6 offset:5696
    ds_read_b128 v[92:95], v6 offset:1024
    ds_read_b128 v[96:99], v6 offset:1088
    s_waitcnt lgkmcnt(4)
    v_pk_fma_f32 v[20:21], v[20:21], v[100:101], v[108:109]
    v_pk_fma_f32 v[22:23], v[22:23], v[102:103], v[110:111]
    v_pk_fma_f32 v[24:25], v[24:25], v[104:105], v[112:113]
    v_pk_fma_f32 v[26:27], v[26:27], v[106:107], v[114:115]
    v_cvt_pk_bf16_f32 v20, v20, v21
    v_cvt_pk_bf16_f32 v21, v22, v23
    v_cvt_pk_bf16_f32 v22, v24, v25
    v_cvt_pk_bf16_f32 v23, v26, v27
    buffer_store_dwordx4 v[20:23], v7, s[16:19], s28 offen sc1
    s_add_u32 s28, s28, 524288
    ds_read_b128 v[100:103], v6 offset:6144
    ds_read_b128 v[104:107], v6 offset:6208
    ds_read_b128 v[108:111], v6 offset:1536
    ds_read_b128 v[112:115], v6 offset:1600
    s_waitcnt lgkmcnt(4)
    v_pk_fma_f32 v[28:29], v[28:29], v[84:85], v[92:93]
    v_pk_fma_f32 v[30:31], v[30:31], v[86:87], v[94:95]
    v_pk_fma_f32 v[32:33], v[32:33], v[88:89], v[96:97]
    v_pk_fma_f32 v[34:35], v[34:35], v[90:91], v[98:99]
    v_cvt_pk_bf16_f32 v28, v28, v29
    v_cvt_pk_bf16_f32 v29, v30, v31
    v_cvt_pk_bf16_f32 v30, v32, v33
    v_cvt_pk_bf16_f32 v31, v34, v35
    buffer_store_dwordx4 v[28:31], v7, s[16:19], s28 offen sc1
    s_add_u32 s28, s28, 524288
    ds_read_b128 v[84:87], v6 offset:6656
    ds_read_b128 v[88:91], v6 offset:6720
    ds_read_b128 v[92:95], v6 offset:2048
    ds_read_b128 v[96:99], v6 offset:2112
    s_waitcnt lgkmcnt(4)
    v_pk_fma_f32 v[36:37], v[36:37], v[100:101], v[108:109]
    v_pk_fma_f32 v[38:39], v[38:39], v[102:103], v[110:111]
    v_pk_fma_f32 v[40:41], v[40:41], v[104:105], v[112:113]
    v_pk_fma_f32 v[42:43], v[42:43], v[106:107], v[114:115]
    v_cvt_pk_bf16_f32 v36, v36, v37
    v_cvt_pk_bf16_f32 v37, v38, v39
    v_cvt_pk_bf16_f32 v38, v40, v41
    v_cvt_pk_bf16_f32 v39, v42, v43
    buffer_store_dwordx4 v[36:39], v7, s[16:19], s28 offen sc1
    s_add_u32 s28, s28, 524288
    ds_read_b128 v[100:103], v6 offset:7168
    ds_read_b128 v[104:107], v6 offset:7232
    ds_read_b128 v[108:111], v6 offset:2560
    ds_read_b128 v[112:115], v6 offset:2624
    s_waitcnt lgkmcnt(4)
    v_pk_fma_f32 v[44:45], v[44:45], v[84:85], v[92:93]
    v_pk_fma_f32 v[46:47], v[46:47], v[86:87], v[94:95]
    v_pk_fma_f32 v[48:49], v[48:49], v[88:89], v[96:97]
    v_pk_fma_f32 v[50:51], v[50:51], v[90:91], v[98:99]
    v_cvt_pk_bf16_f32 v44, v44, v45
    v_cvt_pk_bf16_f32 v45, v46, v47
    v_cvt_pk_bf16_f32 v46, v48, v49
    v_cvt_pk_bf16_f32 v47, v50, v51
    buffer_store_dwordx4 v[44:47], v7, s[16:19], s28 offen sc1
    s_add_u32 s28, s28, 524288
    ds_read_b128 v[84:87], v6 offset:7680
    ds_read_b128 v[88:91], v6 offset:7744
    ds_read_b128 v[92:95], v6 offset:3072
    ds_read_b128 v[96:99], v6 offset:3136
    s_waitcnt lgkmcnt(4)
    v_pk_fma_f32 v[52:53], v[52:53], v[100:101], v[108:109]
    v_pk_fma_f32 v[54:55], v[54:55], v[102:103], v[110:111]
    v_pk_fma_f32 v[56:57], v[56:57], v[104:105], v[112:113]
    v_pk_fma_f32 v[58:59], v[58:59], v[106:107], v[114:115]
    v_cvt_pk_bf16_f32 v52, v52, v53
    v_cvt_pk_bf16_f32 v53, v54, v55
    v_cvt_pk_bf16_f32 v54, v56, v57
    v_cvt_pk_bf16_f32 v55, v58, v59
    buffer_store_dwordx4 v[52:55], v7, s[16:19], s28 offen sc1
    s_add_u32 s28, s28, 524288
    ds_read_b128 v[100:103], v6 offset:8192
    ds_read_b128 v[104:107], v6 offset:8256
    ds_read_b128 v[108:111], v6 offset:3584
    ds_read_b128 v[112:115], v6 offset:3648
    s_waitcnt lgkmcnt(4)
    v_pk_fma_f32 v[60:61], v[60:61], v[84:85], v[92:93]
    v_pk_fma_f32 v[62:63], v[62:63], v[86:87], v[94:95]
    v_pk_fma_f32 v[64:65], v[64:65], v[88:89], v[96:97]
    v_pk_fma_f32 v[66:67], v[66:67], v[90:91], v[98:99]
    v_cvt_pk_bf16_f32 v60, v60, v61
    v_cvt_pk_bf16_f32 v61, v62, v63
    v_cvt_pk_bf16_f32 v62, v64, v65
    v_cvt_pk_bf16_f32 v63, v66, v67
    buffer_store_dwordx4 v[60:63], v7, s[16:19], s28 offen sc1
    s_add_u32 s28, s28, 524288
    ds_read_b128 v[84:87], v6 offset:8704
    ds_read_b128 v[88:91], v6 offset:8768
    ds_read_b128 v[92:95], v6 offset:4096
    ds_read_b128 v[96:99], v6 offset:4160
    s_waitcnt lgkmcnt(4)
    v_pk_fma_f32 v[68:69], v[68:69], v[100:101], v[108:109]
    v_pk_fma_f32 v[70:71], v[70:71], v[102:103], v[110:111]
    v_pk_fma_f32 v[72:73], v[72:73], v[104:105], v[112:113]
    v_pk_fma_f32 v[74:75], v[74:75], v[106:107], v[114:115]
    v_cvt_pk_bf16_f32 v68, v68, v69
    v_cvt_pk_bf16_f32 v69, v70, v71
    v_cvt_pk_bf16_f32 v70, v72, v73
    v_cvt_pk_bf16_f32 v71, v74, v75
    buffer_store_dwordx4 v[68:71], v7, s[16:19], s28 offen sc1
    s_add_u32 s28, s28, 524288
    s_waitcnt lgkmcnt(0)
    v_pk_fma_f32 v[76:77], v[76:77], v[84:85], v[92:93]
    v_pk_fma_f32 v[78:79], v[78:79], v[86:87], v[94:95]
    v_pk_fma_f32 v[80:81], v[80:81], v[88:89], v[96:97]
    v_pk_fma_f32 v[82:83], v[82:83], v[90:91], v[98:99]
    v_cvt_pk_bf16_f32 v76, v76, v77
    v_cvt_pk_bf16_f32 v77, v78, v79
    v_cvt_pk_bf16_f32 v78, v80, v81
    v_cvt_pk_bf16_f32 v79, v82, v83
    buffer_store_dwordx4 v[76:79], v7, s[16:19], s28 offen sc1
    s_lshr_b32 s30, s4, 2
    s_lshl_b32 s30, s30, 7
    s_and_b32 s31, s4, 3
    s_lshl_b32 s31, s31, 2
    s_add_u32 s30, s30, s31
    s_add_u32 s30, s30, 25728
    s_sub_u32 s28, s75, 72
    s_cmp_ge_u32 s28, 36
    s_cbranch_scc1 L_ln_ng
    s_cmp_lg_u32 s3, 0
    s_cbranch_scc1 L_ln_ng
    s_mov_b64 exec, 1
    v_mov_b32 v4, 64
    v_mov_b32 v5, 1
    buffer_atomic_add v5, v4, s[20:23], 0 offen sc1
L_ln_ng:
    s_mov_b64 exec, 1
    s_lshl_b32 s30, s30, 0
    s_add_u32 s30, s30, 48234496
    v_mov_b32 v5, 1
    s_add_u32 s28, s100, 0
    v_mov_b32 v4, s28
    s_waitcnt vmcnt(0)
    v_mov_b32 v7, 0
    ds_add_rtn_u32 v6, v4, v5
    s_waitcnt lgkmcnt(0)
    v_readfirstlane_b32 s29, v6
    s_cmp_lg_u32 s29, 7
    s_cbranch_scc1 L_seln
    buffer_store_dword v5, v7, s[16:19], s30 offen sc1
    v_mov_b32 v6, 16
    ds_write_b32 v4, v6
L_seln:
    s_mov_b64 exec, -1
    s_branch L_st1
L_st1:
    s_cmp_ge_u32 s3, 6
    s_cbranch_scc1 L_jP_end
    s_waitcnt lgkmcnt(0)
    s_branch L_disp
L_next:
    s_add_u32 s100, s100, 8
L_next2:
    s_mov_b32 s96, s97
    s_mov_b32 s97, s98
    s_mov_b32 s98, s99
    s_mov_b32 s99, 8
L_disp:
    s_bfe_u32 s5, s96, 0x80008
    s_bfe_u32 s6, s96, 0x80010
    s_lshr_b32 s7, s96, 24
    s_and_b32 s4, s96, 0xff
    s_cmp_eq_u32 s4, 0
    s_cbranch_scc1 L_jT
    s_cmp_eq_u32 s4, 1
    s_cbranch_scc1 L_jB
    s_cmp_eq_u32 s4, 2
    s_cbranch_scc1 L_jBh
    s_cmp_eq_u32 s4, 3
    s_cbranch_scc1 L_jW
    s_cmp_eq_u32 s4, 4
    s_cbranch_scc1 L_jV
    s_cmp_eq_u32 s4, 5
    s_cbranch_scc1 L_jS
    s_cmp_eq_u32 s4, 6
    s_cbranch_scc1 L_jU
    s_cmp_lg_u32 s4, 7
    s_cbranch_scc1 L_st3
    s_cmp_ge_u32 s3, 4
    s_cbranch_scc1 L_next2
    s_add_u32 s28, s100, 0
    v_mov_b32 v4, s28
    s_mov_b32 s29, 0
L_lwotch:
    ds_read_b32 v6, v4
    s_add_u32 s29, s29, 1
    s_waitcnt lgkmcnt(0)
    v_readfirstlane_b32 s28, v6
    s_cmp_gt_u32 s29, 0x400000
    s_cbranch_scc1 L_lgotch
    s_cmp_ge_u32 s28, 16
    s_cbranch_scc1 L_lgotch
    s_sleep 1
    s_branch L_lwotch
L_lgotch:
    s_lshl_b32 s31, s6, 8
    s_add_u32 s31, s31, s5
    s_lshl_b32 s31, s31, 2
    s_add_u32 s31, s31, s3
    s_lshr_b32 s32, s7, 4
    s_mul_i32 s32, s32, 648
    s_add_u32 s31, s31, s32
    s_and_b32 s33, s7, 15
L_tch:
    s_sub_u32 s28, s31, 0
    s_cmp_ge_u32 s28, 324
    s_cbranch_scc1 L_it3_0
    s_lshl_b32 s28, s28, 6
    v_add_u32 v4, s28, v0
    v_lshlrev_b32 v4, 7, v4
    s_mov_b32 s24, s46
    s_mov_b32 s25, s47
    s_mov_b32 s26, 2654208
    s_mov_b32 s27, 0x20000
    s_mov_b32 s29, 0
    buffer_load_dword v3, v4, s[24:27], s29 offen
L_it3_0:
    s_sub_u32 s28, s31, 324
    s_cmp_ge_u32 s28, 324
    s_cbranch_scc1 L_it3_1
    s_lshl_b32 s28, s28, 6
    v_add_u32 v4, s28, v0
    v_lshlrev_b32 v4, 7, v4
    s_mov_b32 s24, s50
    s_mov_b32 s25, s51
    s_mov_b32 s26, 2654208
    s_mov_b32 s27, 0x20000
    s_mov_b32 s29, 0
    buffer_load_dword v3, v4, s[24:27], s29 offen
L_it3_1:
    s_sub_u32 s28, s31, 648
    s_cmp_ge_u32 s28, 108
    s_cbranch_scc1 L_it3_2
    s_lshl_b32 s28, s28, 6
    v_add_u32 v4, s28, v0
    s_mov_b32 s29, 43691
    v_mul_lo_u32 v5, v4, s29
    v_lshrrev_b32 v5, 18, v5
    v_mul_u32_u24 v5, 3840, v5
    v_lshl_add_u32 v4, v4, 7, v5
    s_mov_b32 s24, s48
    s_mov_b32 s25, s49
    s_mov_b32 s26, 5308416
    s_mov_b32 s27, 0x20000
    s_mov_b32 s29, 0
    buffer_load_dword v3, v4, s[24:27], s29 offen
L_it3_2:
    s_add_u32 s31, s31, 4
    s_sub_u32 s33, s33, 1
    s_cmp_lg_u32 s33, 0
    s_cbranch_scc1 L_tch
    s_branch L_next2
L_jBh:
    s_cmp_ge_u32 s3, 4
    s_cbranch_scc1 L_jBh_ld
    s_and_b32 s60, s3, 1
    s_lshr_b32 s61, s3, 1
    v_lshrrev_b32 v4, 1, v1
    v_lshlrev_b32 v5, 7, v1
    s_mul_i32 s28, s60, 12288
    v_add_u32 v5, s28, v5
    v_xor_b32 v4, v4, v2
    v_lshl_add_u32 v8, v4, 4, v5
    v_xor_b32 v9, 64, v8
    v_bfe_u32 v4, v0, 2, 2
    v_and_b32 v5, 1, v2
    v_lshl_add_u32 v5, v5, 2, v4
    v_lshl_add_u32 v4, v2, 3, v4
    v_lshlrev_b32 v4, 8, v4
    v_and_b32 v6, 3, v0
    v_lshl_add_u32 v4, v6, 3, v4
    v_add_u32 v4, 24576, v4
    s_mul_i32 s28, s61, 4
    v_xor_b32 v5, s28, v5
    v_xor_b32 v6, 0, v5
    v_lshl_add_u32 v10, v6, 5, v4
    v_xor_b32 v6, 1, v5
    v_lshl_add_u32 v11, v6, 5, v4
    v_xor_b32 v6, 2, v5
    v_lshl_add_u32 v12, v6, 5, v4
    v_xor_b32 v6, 3, v5
    v_lshl_add_u32 v13, v6, 5, v4
    v_mov_b32 v96, 0
    v_mov_b32 v97, 0
    v_mov_b32 v98, 0
    v_mov_b32 v99, 0
    v_mov_b32 v100, 0
    v_mov_b32 v101, 0
    v_mov_b32 v102, 0
    v_mov_b32 v103, 0
    v_mov_b32 v104, 0
    v_mov_b32 v105, 0
    v_mov_b32 v106, 0
    v_mov_b32 v107, 0
    v_mov_b32 v108, 0
    v_mov_b32 v109, 0
    v_mov_b32 v110, 0
    v_mov_b32 v111, 0
    v_mov_b32 v112, 0
    v_mov_b32 v113, 0
    v_mov_b32 v114, 0
    v_mov_b32 v115, 0
    v_mov_b32 v116, 0
    v_mov_b32 v117, 0
    v_mov_b32 v118, 0
    v_mov_b32 v119, 0
    v_mov_b32 v120, 0
    v_mov_b32 v121, 0
    v_mov_b32 v122, 0
    v_mov_b32 v123, 0
    v_mov_b32 v124, 0
    v_mov_b32 v125, 0
    v_mov_b32 v126, 0
    v_mov_b32 v127, 0
    v_mov_b32 v128, 0
    v_mov_b32 v129, 0
    v_mov_b32 v130, 0
    v_mov_b32 v131, 0
    v_mov_b32 v132, 0
    v_mov_b32 v133, 0
    v_mov_b32 v134, 0
    v_mov_b32 v135, 0
    v_mov_b32 v136, 0
    v_mov_b32 v137, 0
    v_mov_b32 v138, 0
    v_mov_b32 v139, 0
    v_mov_b32 v140, 0
    v_mov_b32 v141, 0
    v_mov_b32 v142, 0
    v_mov_b32 v143, 0
    v_mov_b32 v144, 0
    v_mov_b32 v145, 0
    v_mov_b32 v146, 0
    v_mov_b32 v147, 0
    v_mov_b32 v148, 0
    v_mov_b32 v149, 0
    v_mov_b32 v150, 0
    v_mov_b32 v151, 0
    v_mov_b32 v152, 0
    v_mov_b32 v153, 0
    v_mov_b32 v154, 0
    v_mov_b32 v155, 0
    v_mov_b32 v156, 0
    v_mov_b32 v157, 0
    v_mov_b32 v158, 0
    v_mov_b32 v159, 0
    v_mov_b32 v160, 0
    v_mov_b32 v161, 0
    v_mov_b32 v162, 0
    v_mov_b32 v163, 0
    v_mov_b32 v164, 0
    v_mov_b32 v165, 0
    v_mov_b32 v166, 0
    v_mov_b32 v167, 0
    v_mov_b32 v168, 0
    v_mov_b32 v169, 0
    v_mov_b32 v170, 0
    v_mov_b32 v171, 0
    v_mov_b32 v172, 0
    v_mov_b32 v173, 0
    v_mov_b32 v174, 0
    v_mov_b32 v175, 0
    v_mov_b32 v176, 0
    v_mov_b32 v177, 0
    v_mov_b32 v178, 0
    v_mov_b32 v179, 0
    v_mov_b32 v180, 0
    v_mov_b32 v181, 0
    v_mov_b32 v182, 0
    v_mov_b32 v183, 0
    v_mov_b32 v184, 0
    v_mov_b32 v185, 0
    v_mov_b32 v186, 0
    v_mov_b32 v187, 0
    v_mov_b32 v188, 0
    v_mov_b32 v189, 0
    v_mov_b32 v190, 0
    v_mov_b32 v191, 0
    s_mov_b32 s66, 0
    s_mov_b32 s67, 0
    s_mov_b32 s69, 40960
    s_waitcnt lgkmcnt(0)
    s_mov_b32 s16, s58
    s_mov_b32 s17, s59
    s_mov_b32 s18, 50331648
    s_mov_b32 s19, 0x20000
    s_barrier
    ds_read_b128 v[16:19], v8 offset:0
    ds_read_b64_tr_b16 v[40:41], v10 offset:0
    ds_read_b64_tr_b16 v[42:43], v10 offset:1024
    ds_read_b64_tr_b16 v[44:45], v11 offset:0
    ds_read_b64_tr_b16 v[46:47], v11 offset:1024
    ds_read_b64_tr_b16 v[48:49], v12 offset:0
    ds_read_b64_tr_b16 v[50:51], v12 offset:1024
    ds_read_b64_tr_b16 v[52:53], v13 offset:0
    ds_read_b64_tr_b16 v[54:55], v13 offset:1024
    ds_read_b128 v[20:23], v8 offset:2048
    ds_read_b128 v[24:27], v8 offset:4096
    ds_read_b128 v[28:31], v8 offset:6144
    ds_read_b128 v[32:35], v8 offset:8192
    ds_read_b128 v[36:39], v8 offset:10240
L_jBh_cloop:
    s_waitcnt lgkmcnt(13)
    s_waitcnt lgkmcnt(11)
    v_mfma_f32_16x16x32_bf16 v[96:99], v[16:19], v[40:43], v[96:99]
    ds_read_b128 v[56:59], v9 offset:0
    s_waitcnt lgkmcnt(10)
    v_mfma_f32_16x16x32_bf16 v[100:103], v[16:19], v[44:47], v[100:103]
    ds_read_b64_tr_b16 v[80:81], v10 offset:8192
    s_waitcnt lgkmcnt(9)
    v_mfma_f32_16x16x32_bf16 v[104:107], v[16:19], v[48:51], v[104:107]
    ds_read_b64_tr_b16 v[82:83], v10 offset:9216
    s_waitcnt lgkmcnt(8)
    v_mfma_f32_16x16x32_bf16 v[108:111], v[16:19], v[52:55], v[108:111]
    ds_read_b64_tr_b16 v[84:85], v11 offset:8192
    s_waitcnt lgkmcnt(8)
    v_mfma_f32_16x16x32_bf16 v[124:127], v[20:23], v[52:55], v[124:127]
    ds_read_b64_tr_b16 v[86:87], v11 offset:9216
    v_mfma_f32_16x16x32_bf16 v[120:123], v[20:23], v[48:51], v[120:123]
    ds_read_b64_tr_b16 v[88:89], v12 offset:8192
    v_mfma_f32_16x16x32_bf16 v[116:119], v[20:23], v[44:47], v[116:119]
    ds_read_b64_tr_b16 v[90:91], v12 offset:9216
    v_mfma_f32_16x16x32_bf16 v[112:115], v[20:23], v[40:43], v[112:115]
    ds_read_b64_tr_b16 v[92:93], v13 offset:8192
    s_waitcnt lgkmcnt(11)
    v_mfma_f32_16x16x32_bf16 v[128:131], v[24:27], v[40:43], v[128:131]
    ds_read_b64_tr_b16 v[94:95], v13 offset:9216
    v_mfma_f32_16x16x32_bf16 v[132:135], v[24:27], v[44:47], v[132:135]
    ds_read_b128 v[60:63], v9 offset:2048
    v_mfma_f32_16x16x32_bf16 v[136:139], v[24:27], v[48:51], v[136:139]
    ds_read_b128 v[64:67], v9 offset:4096
    v_mfma_f32_16x16x32_bf16 v[140:143], v[24:27], v[52:55], v[140:143]
    ds_read_b128 v[68:71], v9 offset:6144
    s_waitcnt lgkmcnt(14)
    v_mfma_f32_16x16x32_bf16 v[156:159], v[28:31], v[52:55], v[156:159]
    ds_read_b128 v[72:75], v9 offset:8192
    v_mfma_f32_16x16x32_bf16 v[152:155], v[28:31], v[48:51], v[152:155]
    ds_read_b128 v[76:79], v9 offset:10240
    v_mfma_f32_16x16x32_bf16 v[148:151], v[28:31], v[44:47], v[148:151]
    s_add_u32 s66, s66, 1
    s_cmp_eq_u32 s66, 3
    v_mfma_f32_16x16x32_bf16 v[144:147], v[28:31], v[40:43], v[144:147]
    s_cselect_b32 s68, 4294885376, s69
    s_cselect_b32 s66, 0, s66
    s_waitcnt lgkmcnt(15)
    v_mfma_f32_16x16x32_bf16 v[160:163], v[32:35], v[40:43], v[160:163]
    v_add_u32 v8, s68, v8
    v_add_u32 v9, s68, v9
    v_mfma_f32_16x16x32_bf16 v[164:167], v[32:35], v[44:47], v[164:167]
    v_add_u32 v10, s68, v10
    v_mfma_f32_16x16x32_bf16 v[168:171], v[32:35], v[48:51], v[168:171]
    v_add_u32 v11, s68, v11
    v_mfma_f32_16x16x32_bf16 v[172:175], v[32:35], v[52:55], v[172:175]
    v_add_u32 v12, s68, v12
    s_waitcnt lgkmcnt(14)
    v_mfma_f32_16x16x32_bf16 v[188:191], v[36:39], v[52:55], v[188:191]
    v_add_u32 v13, s68, v13
    v_mfma_f32_16x16x32_bf16 v[184:187], v[36:39], v[48:51], v[184:187]
    s_add_u32 s67, s67, 1
    v_mfma_f32_16x16x32_bf16 v[180:183], v[36:39], v[44:47], v[180:183]
    s_cmp_eq_u32 s67, 18
    v_mfma_f32_16x16x32_bf16 v[176:179], v[36:39], v[40:43], v[176:179]
    s_cbranch_scc1 L_jBh_ctail
    s_waitcnt lgkmcnt(0)
    s_barrier
    v_mfma_f32_16x16x32_bf16 v[96:99], v[56:59], v[80:83], v[96:99]
    ds_read_b128 v[16:19], v8 offset:0
    v_mfma_f32_16x16x32_bf16 v[100:103], v[56:59], v[84:87], v[100:103]
    ds_read_b64_tr_b16 v[40:41], v10 offset:0
    v_mfma_f32_16x16x32_bf16 v[104:107], v[56:59], v[88:91], v[104:107]
    ds_read_b64_tr_b16 v[42:43], v10 offset:1024
    v_mfma_f32_16x16x32_bf16 v[108:111], v[56:59], v[92:95], v[108:111]
    ds_read_b64_tr_b16 v[44:45], v11 offset:0
    v_mfma_f32_16x16x32_bf16 v[124:127], v[60:63], v[92:95], v[124:127]
    ds_read_b64_tr_b16 v[46:47], v11 offset:1024
    v_mfma_f32_16x16x32_bf16 v[120:123], v[60:63], v[88:91], v[120:123]
    ds_read_b64_tr_b16 v[48:49], v12 offset:0
    v_mfma_f32_16x16x32_bf16 v[116:119], v[60:63], v[84:87], v[116:119]
    ds_read_b64_tr_b16 v[50:51], v12 offset:1024
    v_mfma_f32_16x16x32_bf16 v[112:115], v[60:63], v[80:83], v[112:115]
    ds_read_b64_tr_b16 v[52:53], v13 offset:0
    v_mfma_f32_16x16x32_bf16 v[128:131], v[64:67], v[80:83], v[128:131]
    ds_read_b64_tr_b16 v[54:55], v13 offset:1024
    v_mfma_f32_16x16x32_bf16 v[132:135], v[64:67], v[84:87], v[132:135]
    ds_read_b128 v[20:23], v8 offset:2048
    v_mfma_f32_16x16x32_bf16 v[136:139], v[64:67], v[88:91], v[136:139]
    ds_read_b128 v[24:27], v8 offset:4096
    v_mfma_f32_16x16x32_bf16 v[140:143], v[64:67], v[92:95], v[140:143]
    ds_read_b128 v[28:31], v8 offset:6144
    v_mfma_f32_16x16x32_bf16 v[156:159], v[68:71], v[92:95], v[156:159]
    ds_read_b128 v[32:35], v8 offset:8192
    v_mfma_f32_16x16x32_bf16 v[152:155], v[68:71], v[88:91], v[152:155]
    ds_read_b128 v[36:39], v8 offset:10240
    v_mfma_f32_16x16x32_bf16 v[148:151], v[68:71], v[84:87], v[148:151]
    v_mfma_f32_16x16x32_bf16 v[144:147], v[68:71], v[80:83], v[144:147]
    v_mfma_f32_16x16x32_bf16 v[160:163], v[72:75], v[80:83], v[160:163]
    v_mfma_f32_16x16x32_bf16 v[164:167], v[72:75], v[84:87], v[164:167]
    v_mfma_f32_16x16x32_bf16 v[168:171], v[72:75], v[88:91], v[168:171]
    v_mfma_f32_16x16x32_bf16 v[172:175], v[72:75], v[92:95], v[172:175]
    v_mfma_f32_16x16x32_bf16 v[188:191], v[76:79], v[92:95], v[188:191]
    v_mfma_f32_16x16x32_bf16 v[184:187], v[76:79], v[88:91], v[184:187]
    v_mfma_f32_16x16x32_bf16 v[180:183], v[76:79], v[84:87], v[180:183]
    v_mfma_f32_16x16x32_bf16 v[176:179], v[76:79], v[80:83], v[176:179]
    s_branch L_jBh_cloop
L_jBh_ctail:
    s_waitcnt lgkmcnt(0)
    s_barrier
    v_mfma_f32_16x16x32_bf16 v[96:99], v[56:59], v[80:83], v[96:99]
    v_mfma_f32_16x16x32_bf16 v[100:103], v[56:59], v[84:87], v[100:103]
    v_mfma_f32_16x16x32_bf16 v[104:107], v[56:59], v[88:91], v[104:107]
    v_mfma_f32_16x16x32_bf16 v[108:111], v[56:59], v[92:95], v[108:111]
    v_mfma_f32_16x16x32_bf16 v[124:127], v[60:63], v[92:95], v[124:127]
    v_mfma_f32_16x16x32_bf16 v[120:123], v[60:63], v[88:91], v[120:123]
    v_mfma_f32_16x16x32_bf16 v[116:119], v[60:63], v[84:87], v[116:119]
    v_mfma_f32_16x16x32_bf16 v[112:115], v[60:63], v[80:83], v[112:115]
    v_mfma_f32_16x16x32_bf16 v[128:131], v[64:67], v[80:83], v[128:131]
    v_mfma_f32_16x16x32_bf16 v[132:135], v[64:67], v[84:87], v[132:135]
    v_mfma_f32_16x16x32_bf16 v[136:139], v[64:67], v[88:91], v[136:139]
    v_mfma_f32_16x16x32_bf16 v[140:143], v[64:67], v[92:95], v[140:143]
    v_mfma_f32_16x16x32_bf16 v[156:159], v[68:71], v[92:95], v[156:159]
    v_mfma_f32_16x16x32_bf16 v[152:155], v[68:71], v[88:91], v[152:155]
    v_mfma_f32_16x16x32_bf16 v[148:151], v[68:71], v[84:87], v[148:151]
    v_mfma_f32_16x16x32_bf16 v[144:147], v[68:71], v[80:83], v[144:147]
    v_mfma_f32_16x16x32_bf16 v[160:163], v[72:75], v[80:83], v[160:163]
    v_mfma_f32_16x16x32_bf16 v[164:167], v[72:75], v[84:87], v[164:167]
    v_mfma_f32_16x16x32_bf16 v[168:171], v[72:75], v[88:91], v[168:171]
    v_mfma_f32_16x16x32_bf16 v[172:175], v[72:75], v[92:95], v[172:175]
    v_mfma_f32_16x16x32_bf16 v[188:191], v[76:79], v[92:95], v[188:191]
    v_mfma_f32_16x16x32_bf16 v[184:187], v[76:79], v[88:91], v[184:187]
    v_mfma_f32_16x16x32_bf16 v[180:183], v[76:79], v[84:87], v[180:183]
    v_mfma_f32_16x16x32_bf16 v[176:179], v[76:79], v[80:83], v[176:179]
    s_mov_b32 s24, s56
    s_mov_b32 s25, s57
    s_mov_b32 s26, 256
    s_mov_b32 s27, 0x20000
    v_mov_b32 v7, 128
    buffer_load_dword v3, v7, s[24:27], 0 offen sc1
    s_lshl_b32 s30, s6, 3
    s_mul_i32 s31, s5, 6
    s_mov_b32 s33, s30
    s_mul_i32 s29, s61, 4
    s_add_u32 s33, s33, s29
    s_lshl_b32 s33, s33, 11
    s_add_u32 s33, s33, 13631488
    s_mov_b32 s32, s31
    s_mul_i32 s29, s60, 3
    s_add_u32 s32, s32, s29
    v_lshlrev_b32 v4, 4, v0
    s_lshr_b32 s28, s32, 1
    s_mul_i32 s28, s28, 147456
    s_and_b32 s29, s32, 1
    s_lshl_b32 s29, s29, 10
    s_add_u32 s28, s28, s29
    s_add_u32 s28, s28, s33
    s_add_u32 s32, s32, 1
    v_cvt_pk_bf16_f32 v16, v96, v97
    v_cvt_pk_bf16_f32 v17, v98, v99
    v_cvt_pk_bf16_f32 v18, v112, v113
    v_cvt_pk_bf16_f32 v19, v114, v115
    buffer_store_dwordx4 v[16:19], v4, s[16:19], s28 offen offset:0 sc1
    v_cvt_pk_bf16_f32 v20, v100, v101
    v_cvt_pk_bf16_f32 v21, v102, v103
    v_cvt_pk_bf16_f32 v22, v116, v117
    v_cvt_pk_bf16_f32 v23, v118, v119
    buffer_store_dwordx4 v[20:23], v4, s[16:19], s28 offen offset:2048 sc1
    s_add_u32 s28, s28, 4096
    v_cvt_pk_bf16_f32 v24, v104, v105
    v_cvt_pk_bf16_f32 v25, v106, v107
    v_cvt_pk_bf16_f32 v26, v120, v121
    v_cvt_pk_bf16_f32 v27, v122, v123
    buffer_store_dwordx4 v[24:27], v4, s[16:19], s28 offen offset:0 sc1
    v_cvt_pk_bf16_f32 v28, v108, v109
    v_cvt_pk_bf16_f32 v29, v110, v111
    v_cvt_pk_bf16_f32 v30, v124, v125
    v_cvt_pk_bf16_f32 v31, v126, v127
    buffer_store_dwordx4 v[28:31], v4, s[16:19], s28 offen offset:2048 sc1
    s_lshr_b32 s28, s32, 1
    s_mul_i32 s28, s28, 147456
    s_and_b32 s29, s32, 1
    s_lshl_b32 s29, s29, 10
    s_add_u32 s28, s28, s29
    s_add_u32 s28, s28, s33
    s_add_u32 s32, s32, 1
    v_cvt_pk_bf16_f32 v32, v128, v129
    v_cvt_pk_bf16_f32 v33, v130, v131
    v_cvt_pk_bf16_f32 v34, v144, v145
    v_cvt_pk_bf16_f32 v35, v146, v147
    buffer_store_dwordx4 v[32:35], v4, s[16:19], s28 offen offset:0 sc1
    v_cvt_pk_bf16_f32 v36, v132, v133
    v_cvt_pk_bf16_f32 v37, v134, v135
    v_cvt_pk_bf16_f32 v38, v148, v149
    v_cvt_pk_bf16_f32 v39, v150, v151
    buffer_store_dwordx4 v[36:39], v4, s[16:19], s28 offen offset:2048 sc1
    s_add_u32 s28, s28, 4096
    v_cvt_pk_bf16_f32 v40, v136, v137
    v_cvt_pk_bf16_f32 v41, v138, v139
    v_cvt_pk_bf16_f32 v42, v152, v153
    v_cvt_pk_bf16_f32 v43, v154, v155
    buffer_store_dwordx4 v[40:43], v4, s[16:19], s28 offen offset:0 sc1
    v_cvt_pk_bf16_f32 v44, v140, v141
    v_cvt_pk_bf16_f32 v45, v142, v143
    v_cvt_pk_bf16_f32 v46, v156, v157
    v_cvt_pk_bf16_f32 v47, v158, v159
    buffer_store_dwordx4 v[44:47], v4, s[16:19], s28 offen offset:2048 sc1
    s_lshr_b32 s28, s32, 1
    s_mul_i32 s28, s28, 147456
    s_and_b32 s29, s32, 1
    s_lshl_b32 s29, s29, 10
    s_add_u32 s28, s28, s29
    s_add_u32 s28, s28, s33
    s_add_u32 s32, s32, 1
    v_cvt_pk_bf16_f32 v48, v160, v161
    v_cvt_pk_bf16_f32 v49, v162, v163
    v_cvt_pk_bf16_f32 v50, v176, v177
    v_cvt_pk_bf16_f32 v51, v178, v179
    buffer_store_dwordx4 v[48:51], v4, s[16:19], s28 offen offset:0 sc1
    v_cvt_pk_bf16_f32 v52, v164, v165
    v_cvt_pk_bf16_f32 v53, v166, v167
    v_cvt_pk_bf16_f32 v54, v180, v181
    v_cvt_pk_bf16_f32 v55, v182, v183
    buffer_store_dwordx4 v[52:55], v4, s[16:19], s28 offen offset:2048 sc1
    s_add_u32 s28, s28, 4096
    v_cvt_pk_bf16_f32 v56, v168, v169
    v_cvt_pk_bf16_f32 v57, v170, v171
    v_cvt_pk_bf16_f32 v58, v184, v185
    v_cvt_pk_bf16_f32 v59, v186, v187
    buffer_store_dwordx4 v[56:59], v4, s[16:19], s28 offen offset:0 sc1
    v_cvt_pk_bf16_f32 v60, v172, v173
    v_cvt_pk_bf16_f32 v61, v174, v175
    v_cvt_pk_bf16_f32 v62, v188, v189
    v_cvt_pk_bf16_f32 v63, v190, v191
    buffer_store_dwordx4 v[60:63], v4, s[16:19], s28 offen offset:2048 sc1
    s_lshl_b32 s30, s6, 7
    s_lshl_b32 s31, s5, 2
    s_add_u32 s30, s30, s31
    s_add_u32 s30, s30, 18432
    s_mov_b64 exec, 1
    s_lshl_b32 s30, s30, 0
    s_add_u32 s30, s30, 48234496
    v_mov_b32 v5, 2
    s_add_u32 s28, s100, 8
    v_mov_b32 v4, s28
    s_waitcnt vmcnt(0)
    s_mov_b32 s28, 0
    v_mov_b32 v7, 128
L_prjBh:
    v_readfirstlane_b32 s29, v3
    s_add_u32 s28, s28, 1
    s_cmp_gt_u32 s28, 0x40000
    s_cbranch_scc1 L_prdjBh
    s_cmp_lg_u32 s29, 0
    s_cbranch_scc1 L_prdjBh
    buffer_load_dword v3, v7, s[24:27], 0 offen sc1
    s_waitcnt vmcnt(0)
    s_branch L_prjBh
L_prdjBh:
    v_mov_b32 v7, 0
    ds_add_rtn_u32 v6, v4, v5
    s_waitcnt lgkmcnt(0)
    v_readfirstlane_b32 s29, v6
    s_cmp_lg_u32 s29, 6
    s_cbranch_scc1 L_sejBh
    buffer_store_dword v5, v7, s[16:19], s30 offen sc1
    v_mov_b32 v6, 16
    ds_write_b32 v4, v6
L_sejBh:
    s_mov_b64 exec, -1
    s_branch L_next
L_jBh_ld:
    s_sub_u32 s60, s3, 4
    v_lshrrev_b32 v4, 3, v0
    v_and_b32 v5, 7, v0
    s_and_b32 s29, s60, 1
    s_lshl_b32 s29, s29, 2
    v_add_u32 v6, s29, v2
    v_xor_b32 v5, v5, v6
    v_mul_u32_u24 v4, 6912, v4
    v_lshl_add_u32 v4, v5, 4, v4
    s_mul_i32 s28, s5, 1327104
    s_mul_i32 s29, s60, 55296
    s_add_u32 s28, s28, s29
    s_add_u32 s28, s28, 4608
    v_add_u32 v8, s28, v4
    s_lshl_b32 s61, s60, 10
    v_add_u32 v9, 108544, v8
    v_add_u32 v10, 221184, v8
    v_add_u32 v11, 329728, v8
    v_add_u32 v12, 442368, v8
    v_add_u32 v13, 550912, v8
    v_add_u32 v14, 663552, v8
    v_add_u32 v15, 772096, v8
    v_add_u32 v16, 884736, v8
    v_add_u32 v17, 993280, v8
    v_add_u32 v18, 1105920, v8
    v_add_u32 v19, 1214464, v8
    v_lshrrev_b32 v4, 4, v0
    v_and_b32 v5, 15, v0
    v_lshlrev_b32 v6, 1, v2
    v_xor_b32 v5, v5, v6
    v_mul_u32_u24 v4, 2304, v4
    v_lshl_add_u32 v4, v5, 4, v4
    s_mul_i32 s28, s6, 256
    s_mul_i32 s29, s60, 9216
    s_add_u32 s28, s28, s29
    v_add_u32 v20, s28, v4
    s_lshl_b32 s62, s60, 10
    s_add_u32 s62, s62, 24576
    v_xor_b32 v4, 128, v20
    v_add_u32 v21, 16384, v4
    v_add_u32 v22, 36864, v20
    v_add_u32 v23, 53248, v4
    v_add_u32 v24, 73728, v20
    v_add_u32 v25, 90112, v4
    v_add_u32 v26, 110592, v20
    v_add_u32 v27, 126976, v4
    s_mul_i32 s63, s7, 128
    s_mul_i32 s64, s7, 147456
    s_mov_b32 s65, s7
    s_mov_b32 s66, 0
    s_mov_b32 s67, 0
    s_mov_b32 s69, 40960
    s_waitcnt lgkmcnt(0)
    s_mov_b32 s8, s42
    s_mov_b32 s9, s43
    s_mov_b32 s10, 7962624
    s_mov_b32 s11, 0x20000
    s_mov_b32 s12, s44
    s_mov_b32 s13, s45
    s_mov_b32 s14, 2654208
    s_mov_b32 s15, 0x20000
    s_add_u32 s28, s100, 0
    v_mov_b32 v4, s28
    s_mov_b32 s29, 0
L_lwoBh:
    ds_read_b32 v6, v4
    s_add_u32 s29, s29, 1
    s_waitcnt lgkmcnt(0)
    v_readfirstlane_b32 s28, v6
    s_cmp_gt_u32 s29, 0x400000
    s_cbranch_scc1 L_lgoBh
    s_cmp_ge_u32 s28, 16
    s_cbranch_scc1 L_lgoBh
    s_sleep 1
    s_branch L_lwoBh
L_lgoBh:
    s_mov_b32 s70, 0
    s_mov_b32 s71, 2
L_jBh_lloop:
    s_add_u32 m0, s61, 0
    s_nop 0
    buffer_load_dwordx4 v8, s[8:11], s63 offen offset:0 lds
    buffer_load_dwordx4 v9, s[8:11], s63 offen offset:2048 lds
    s_add_u32 m0, s61, 4096
    s_nop 0
    buffer_load_dwordx4 v10, s[8:11], s63 offen offset:0 lds
    buffer_load_dwordx4 v11, s[8:11], s63 offen offset:2048 lds
    s_add_u32 m0, s61, 8192
    s_nop 0
    buffer_load_dwordx4 v12, s[8:11], s63 offen offset:0 lds
    buffer_load_dwordx4 v13, s[8:11], s63 offen offset:2048 lds
    s_add_u32 m0, s61, 12288
    s_nop 0
    buffer_load_dwordx4 v14, s[8:11], s63 offen offset:0 lds
    buffer_load_dwordx4 v15, s[8:11], s63 offen offset:2048 lds
    s_add_u32 m0, s61, 16384
    s_nop 0
    buffer_load_dwordx4 v16, s[8:11], s63 offen offset:0 lds
    buffer_load_dwordx4 v17, s[8:11], s63 offen offset:2048 lds
    s_add_u32 m0, s61, 20480
    s_nop 0
    buffer_load_dwordx4 v18, s[8:11], s63 offen offset:0 lds
    buffer_load_dwordx4 v19, s[8:11], s63 offen offset:2048 lds
    s_add_u32 m0, s62, 0
    s_nop 0
    buffer_load_dwordx4 v20, s[12:15], s64 offen offset:0 lds
    buffer_load_dwordx4 v21, s[12:15], s64 offen offset:2048 lds
    s_add_u32 m0, s62, 4096
    s_nop 0
    buffer_load_dwordx4 v22, s[12:15], s64 offen offset:0 lds
    buffer_load_dwordx4 v23, s[12:15], s64 offen offset:2048 lds
    s_add_u32 m0, s62, 8192
    s_nop 0
    buffer_load_dwordx4 v24, s[12:15], s64 offen offset:0 lds
    buffer_load_dwordx4 v25, s[12:15], s64 offen offset:2048 lds
    s_add_u32 m0, s62, 12288
    s_nop 0
    buffer_load_dwordx4 v26, s[12:15], s64 offen offset:0 lds
    buffer_load_dwordx4 v27, s[12:15], s64 offen offset:2048 lds
    s_add_u32 s63, s63, 128
    s_add_u32 s64, s64, 147456
    s_add_u32 s65, s65, 1
    s_cmp_eq_u32 s65, 18
    s_cselect_b32 s63, 0, s63
    s_cselect_b32 s64, 0, s64
    s_cselect_b32 s65, 0, s65
    s_add_u32 s66, s66, 1
    s_cmp_eq_u32 s66, 3
    s_cselect_b32 s68, 4294885376, s69
    s_cselect_b32 s66, 0, s66
    s_add_u32 s61, s61, s68
    s_add_u32 s62, s62, s68
    s_add_u32 s67, s67, 1
    s_cmp_eq_u32 s67, 18
    s_cbranch_scc1 L_jBh_ltail
    s_cmp_lt_u32 s67, s71
    s_cbranch_scc1 L_jBh_lloop
    s_waitcnt vmcnt(20)
    s_barrier
    s_add_u32 s70, s70, 1
    s_add_u32 s71, s71, 1
    s_branch L_jBh_lloop
L_jBh_ltail:
    s_waitcnt vmcnt(20)
    s_barrier
    s_waitcnt vmcnt(0)
    s_barrier
    s_mov_b32 s24, s56
    s_mov_b32 s25, s57
    s_mov_b32 s26, 256
    s_mov_b32 s27, 0x20000
    v_mov_b32 v7, 128
    buffer_load_dword v3, v7, s[24:27], 0 offen sc1
    s_barrier
    s_waitcnt vmcnt(0)
    v_readfirstlane_b32 s101, v3
    s_branch L_next
L_code_a:
L_jT:
    s_cmp_ge_u32 s3, 4
    s_cbranch_scc1 L_jT_ld
    s_and_b32 s60, s3, 1
    s_lshr_b32 s61, s3, 1
    v_lshlrev_b32 v8, 4, v0
    s_mul_i32 s28, s60, 8192
    v_add_u32 v8, s28, v8
    v_lshlrev_b32 v9, 4, v0
    s_mul_i32 s28, s61, 8192
    s_add_u32 s28, s28, 16384
    v_add_u32 v9, s28, v9
    v_mov_b32 v76, 0
    v_mov_b32 v77, 0
    v_mov_b32 v78, 0
    v_mov_b32 v79, 0
    v_mov_b32 v80, 0
    v_mov_b32 v81, 0
    v_mov_b32 v82, 0
    v_mov_b32 v83, 0
    v_mov_b32 v84, 0
    v_mov_b32 v85, 0
    v_mov_b32 v86, 0
    v_mov_b32 v87, 0
    v_mov_b32 v88, 0
    v_mov_b32 v89, 0
    v_mov_b32 v90, 0
    v_mov_b32 v91, 0
    v_mov_b32 v92, 0
    v_mov_b32 v93, 0
    v_mov_b32 v94, 0
    v_mov_b32 v95, 0
    v_mov_b32 v96, 0
    v_mov_b32 v97, 0
    v_mov_b32 v98, 0
    v_mov_b32 v99, 0
    v_mov_b32 v100, 0
    v_mov_b32 v101, 0
    v_mov_b32 v102, 0
    v_mov_b32 v103, 0
    v_mov_b32 v104, 0
    v_mov_b32 v105, 0
    v_mov_b32 v106, 0
    v_mov_b32 v107, 0
    v_mov_b32 v108, 0
    v_mov_b32 v109, 0
    v_mov_b32 v110, 0
    v_mov_b32 v111, 0
    v_mov_b32 v112, 0
    v_mov_b32 v113, 0
    v_mov_b32 v114, 0
    v_mov_b32 v115, 0
    v_mov_b32 v116, 0
    v_mov_b32 v117, 0
    v_mov_b32 v118, 0
    v_mov_b32 v119, 0
    v_mov_b32 v120, 0
    v_mov_b32 v121, 0
    v_mov_b32 v122, 0
    v_mov_b32 v123, 0
    v_mov_b32 v124, 0
    v_mov_b32 v125, 0
    v_mov_b32 v126, 0
    v_mov_b32 v127, 0
    v_mov_b32 v128, 0
    v_mov_b32 v129, 0
    v_mov_b32 v130, 0
    v_mov_b32 v131, 0
    v_mov_b32 v132, 0
    v_mov_b32 v133, 0
    v_mov_b32 v134, 0
    v_mov_b32 v135, 0
    v_mov_b32 v136, 0
    v_mov_b32 v137, 0
    v_mov_b32 v138, 0
    v_mov_b32 v139, 0
    s_mov_b32 s66, 0
    s_mov_b32 s67, 0
    s_mov_b32 s69, 32768
    s_waitcnt lgkmcnt(0)
    s_mov_b32 s16, s58
    s_mov_b32 s17, s59
    s_mov_b32 s18, 50331648
    s_mov_b32 s19, 0x20000
    s_barrier
    ds_read_b128 v[12:15], v8 offset:0
    ds_read_b128 v[28:31], v9 offset:0
    ds_read_b128 v[32:35], v9 offset:2048
    ds_read_b128 v[36:39], v9 offset:4096
    ds_read_b128 v[40:43], v9 offset:6144
    ds_read_b128 v[16:19], v8 offset:2048
    ds_read_b128 v[20:23], v8 offset:4096
    ds_read_b128 v[24:27], v8 offset:6144
L_jT_cloop:
    s_waitcnt lgkmcnt(7)
    s_waitcnt lgkmcnt(6)
    v_mfma_f32_16x16x32_bf16 v[76:79], v[12:15], v[28:31], v[76:79]
    ds_read_b128 v[44:47], v8 offset:1024
    s_waitcnt lgkmcnt(6)
    v_mfma_f32_16x16x32_bf16 v[80:83], v[12:15], v[32:35], v[80:83]
    ds_read_b128 v[60:63], v9 offset:1024
    s_waitcnt lgkmcnt(6)
    v_mfma_f32_16x16x32_bf16 v[84:87], v[12:15], v[36:39], v[84:87]
    ds_read_b128 v[64:67], v9 offset:3072
    s_waitcnt lgkmcnt(6)
    v_mfma_f32_16x16x32_bf16 v[88:91], v[12:15], v[40:43], v[88:91]
    ds_read_b128 v[68:71], v9 offset:5120
    s_waitcnt lgkmcnt(6)
    v_mfma_f32_16x16x32_bf16 v[104:107], v[16:19], v[40:43], v[104:107]
    ds_read_b128 v[72:75], v9 offset:7168
    v_mfma_f32_16x16x32_bf16 v[100:103], v[16:19], v[36:39], v[100:103]
    ds_read_b128 v[48:51], v8 offset:3072
    v_mfma_f32_16x16x32_bf16 v[96:99], v[16:19], v[32:35], v[96:99]
    ds_read_b128 v[52:55], v8 offset:5120
    v_mfma_f32_16x16x32_bf16 v[92:95], v[16:19], v[28:31], v[92:95]
    ds_read_b128 v[56:59], v8 offset:7168
    s_waitcnt lgkmcnt(9)
    v_mfma_f32_16x16x32_bf16 v[108:111], v[20:23], v[28:31], v[108:111]
    s_add_u32 s66, s66, 1
    s_cmp_eq_u32 s66, 4
    v_mfma_f32_16x16x32_bf16 v[112:115], v[20:23], v[32:35], v[112:115]
    s_cselect_b32 s68, 4294868992, s69
    v_mfma_f32_16x16x32_bf16 v[116:119], v[20:23], v[36:39], v[116:119]
    s_cselect_b32 s66, 0, s66
    v_mfma_f32_16x16x32_bf16 v[120:123], v[20:23], v[40:43], v[120:123]
    v_add_u32 v8, s68, v8
    s_waitcnt lgkmcnt(8)
    v_mfma_f32_16x16x32_bf16 v[136:139], v[24:27], v[40:43], v[136:139]
    v_add_u32 v9, s68, v9
    v_mfma_f32_16x16x32_bf16 v[132:135], v[24:27], v[36:39], v[132:135]
    s_add_u32 s67, s67, 1
    v_mfma_f32_16x16x32_bf16 v[128:131], v[24:27], v[32:35], v[128:131]
    s_cmp_eq_u32 s67, 18
    v_mfma_f32_16x16x32_bf16 v[124:127], v[24:27], v[28:31], v[124:127]
    s_cbranch_scc1 L_jT_ctail
    s_waitcnt lgkmcnt(0)
    s_barrier
    v_mfma_f32_16x16x32_bf16 v[76:79], v[44:47], v[60:63], v[76:79]
    ds_read_b128 v[12:15], v8 offset:0
    v_mfma_f32_16x16x32_bf16 v[80:83], v[44:47], v[64:67], v[80:83]
    ds_read_b128 v[28:31], v9 offset:0
    v_mfma_f32_16x16x32_bf16 v[84:87], v[44:47], v[68:71], v[84:87]
    ds_read_b128 v[32:35], v9 offset:2048
    v_mfma_f32_16x16x32_bf16 v[88:91], v[44:47], v[72:75], v[88:91]
    ds_read_b128 v[36:39], v9 offset:4096
    v_mfma_f32_16x16x32_bf16 v[104:107], v[48:51], v[72:75], v[104:107]
    ds_read_b128 v[40:43], v9 offset:6144
    v_mfma_f32_16x16x32_bf16 v[100:103], v[48:51], v[68:71], v[100:103]
    ds_read_b128 v[16:19], v8 offset:2048
    v_mfma_f32_16x16x32_bf16 v[96:99], v[48:51], v[64:67], v[96:99]
    ds_read_b128 v[20:23], v8 offset:4096
    v_mfma_f32_16x16x32_bf16 v[92:95], v[48:51], v[60:63], v[92:95]
    ds_read_b128 v[24:27], v8 offset:6144
    v_mfma_f32_16x16x32_bf16 v[108:111], v[52:55], v[60:63], v[108:111]
    v_mfma_f32_16x16x32_bf16 v[112:115], v[52:55], v[64:67], v[112:115]
    v_mfma_f32_16x16x32_bf16 v[116:119], v[52:55], v[68:71], v[116:119]
    v_mfma_f32_16x16x32_bf16 v[120:123], v[52:55], v[72:75], v[120:123]
    v_mfma_f32_16x16x32_bf16 v[136:139], v[56:59], v[72:75], v[136:139]
    v_mfma_f32_16x16x32_bf16 v[132:135], v[56:59], v[68:71], v[132:135]
    v_mfma_f32_16x16x32_bf16 v[128:131], v[56:59], v[64:67], v[128:131]
    v_mfma_f32_16x16x32_bf16 v[124:127], v[56:59], v[60:63], v[124:127]
    s_branch L_jT_cloop
L_jT_ctail:
    s_waitcnt lgkmcnt(0)
    s_barrier
    v_mfma_f32_16x16x32_bf16 v[76:79], v[44:47], v[60:63], v[76:79]
    v_mfma_f32_16x16x32_bf16 v[80:83], v[44:47], v[64:67], v[80:83]
    v_mfma_f32_16x16x32_bf16 v[84:87], v[44:47], v[68:71], v[84:87]
    v_mfma_f32_16x16x32_bf16 v[88:91], v[44:47], v[72:75], v[88:91]
    v_mfma_f32_16x16x32_bf16 v[104:107], v[48:51], v[72:75], v[104:107]
    v_mfma_f32_16x16x32_bf16 v[100:103], v[48:51], v[68:71], v[100:103]
    v_mfma_f32_16x16x32_bf16 v[96:99], v[48:51], v[64:67], v[96:99]
    v_mfma_f32_16x16x32_bf16 v[92:95], v[48:51], v[60:63], v[92:95]
    v_mfma_f32_16x16x32_bf16 v[108:111], v[52:55], v[60:63], v[108:111]
    v_mfma_f32_16x16x32_bf16 v[112:115], v[52:55], v[64:67], v[112:115]
    v_mfma_f32_16x16x32_bf16 v[116:119], v[52:55], v[68:71], v[116:119]
    v_mfma_f32_16x16x32_bf16 v[120:123], v[52:55], v[72:75], v[120:123]
    v_mfma_f32_16x16x32_bf16 v[136:139], v[56:59], v[72:75], v[136:139]
    v_mfma_f32_16x16x32_bf16 v[132:135], v[56:59], v[68:71], v[132:135]
    v_mfma_f32_16x16x32_bf16 v[128:131], v[56:59], v[64:67], v[128:131]
    v_mfma_f32_16x16x32_bf16 v[124:127], v[56:59], v[60:63], v[124:127]
    s_lshl_b32 s30, s6, 3
    s_lshl_b32 s31, s5, 2
    s_mov_b32 s28, s30
    s_mul_i32 s29, s61, 4
    s_add_u32 s28, s28, s29
    s_lshl_b32 s28, s28, 11
    s_mov_b32 s32, s31
    s_mul_i32 s29, s60, 2
    s_add_u32 s32, s32, s29
    s_lshr_b32 s29, s32, 1
    s_mul_i32 s29, s29, 262144
    s_add_u32 s28, s28, s29
    s_add_u32 s28, s28, 17825792
    v_lshlrev_b32 v4, 4, v0
    s_nop 1
    v_cvt_pk_bf16_f32 v12, v76, v77
    v_cvt_pk_bf16_f32 v13, v78, v79
    v_cvt_pk_bf16_f32 v14, v92, v93
    v_cvt_pk_bf16_f32 v15, v94, v95
    buffer_store_dwordx4 v[12:15], v4, s[16:19], s28 offen offset:0 sc1
    v_cvt_pk_bf16_f32 v16, v108, v109
    v_cvt_pk_bf16_f32 v17, v110, v111
    v_cvt_pk_bf16_f32 v18, v124, v125
    v_cvt_pk_bf16_f32 v19, v126, v127
    buffer_store_dwordx4 v[16:19], v4, s[16:19], s28 offen offset:1024 sc1
    v_cvt_pk_bf16_f32 v20, v80, v81
    v_cvt_pk_bf16_f32 v21, v82, v83
    v_cvt_pk_bf16_f32 v22, v96, v97
    v_cvt_pk_bf16_f32 v23, v98, v99
    buffer_store_dwordx4 v[20:23], v4, s[16:19], s28 offen offset:2048 sc1
    v_cvt_pk_bf16_f32 v24, v112, v113
    v_cvt_pk_bf16_f32 v25, v114, v115
    v_cvt_pk_bf16_f32 v26, v128, v129
    v_cvt_pk_bf16_f32 v27, v130, v131
    buffer_store_dwordx4 v[24:27], v4, s[16:19], s28 offen offset:3072 sc1
    s_add_u32 s28, s28, 4096
    v_cvt_pk_bf16_f32 v28, v84, v85
    v_cvt_pk_bf16_f32 v29, v86, v87
    v_cvt_pk_bf16_f32 v30, v100, v101
    v_cvt_pk_bf16_f32 v31, v102, v103
    buffer_store_dwordx4 v[28:31], v4, s[16:19], s28 offen offset:0 sc1
    v_cvt_pk_bf16_f32 v32, v116, v117
    v_cvt_pk_bf16_f32 v33, v118, v119
    v_cvt_pk_bf16_f32 v34, v132, v133
    v_cvt_pk_bf16_f32 v35, v134, v135
    buffer_store_dwordx4 v[32:35], v4, s[16:19], s28 offen offset:1024 sc1
    v_cvt_pk_bf16_f32 v36, v88, v89
    v_cvt_pk_bf16_f32 v37, v90, v91
    v_cvt_pk_bf16_f32 v38, v104, v105
    v_cvt_pk_bf16_f32 v39, v106, v107
    buffer_store_dwordx4 v[36:39], v4, s[16:19], s28 offen offset:2048 sc1
    v_cvt_pk_bf16_f32 v40, v120, v121
    v_cvt_pk_bf16_f32 v41, v122, v123
    v_cvt_pk_bf16_f32 v42, v136, v137
    v_cvt_pk_bf16_f32 v43, v138, v139
    buffer_store_dwordx4 v[40:43], v4, s[16:19], s28 offen offset:3072 sc1
    s_lshl_b32 s30, s6, 7
    s_lshl_b32 s31, s5, 2
    s_add_u32 s30, s30, s31
    s_add_u32 s30, s30, 16384
    s_mov_b64 exec, 1
    s_lshl_b32 s30, s30, 0
    s_add_u32 s30, s30, 48234496
    v_mov_b32 v5, 2
    s_add_u32 s28, s100, 8
    v_mov_b32 v4, s28
    s_waitcnt vmcnt(0)
    v_mov_b32 v7, 0
    ds_add_rtn_u32 v6, v4, v5
    s_waitcnt lgkmcnt(0)
    v_readfirstlane_b32 s29, v6
    s_cmp_lg_u32 s29, 6
    s_cbranch_scc1 L_sejT
    buffer_store_dword v5, v7, s[16:19], s30 offen sc1
    v_mov_b32 v6, 16
    ds_write_b32 v4, v6
L_sejT:
    s_mov_b64 exec, -1
    s_branch L_next
L_jT_ld:
    s_sub_u32 s60, s3, 4
    s_mul_i32 s28, s5, 16384
    s_mul_i32 s29, s60, 8192
    s_add_u32 s28, s28, s29
    s_add_u32 s28, s28, 10485760
    v_lshl_add_u32 v8, v0, 4, s28
    s_mov_b32 s61, s29
    v_add_u32 v9, 4096, v8
    s_mul_i32 s28, s6, 16384
    s_mul_i32 s29, s60, 8192
    s_add_u32 s28, s28, s29
    s_add_u32 s28, s28, 5242880
    v_lshl_add_u32 v10, v0, 4, s28
    s_add_u32 s62, s29, 16384
    v_add_u32 v11, 4096, v10
    s_mov_b32 s63, 0
    s_mov_b32 s64, 0
    s_mov_b32 s66, 0
    s_mov_b32 s67, 0
    s_mov_b32 s69, 32768
    s_waitcnt lgkmcnt(0)
    s_mov_b32 s16, s58
    s_mov_b32 s17, s59
    s_mov_b32 s18, 50331648
    s_mov_b32 s19, 0x20000
    s_add_u32 s28, s100, 0
    v_mov_b32 v4, s28
    s_mov_b32 s29, 0
L_lwoT:
    ds_read_b32 v6, v4
    s_add_u32 s29, s29, 1
    s_waitcnt lgkmcnt(0)
    v_readfirstlane_b32 s28, v6
    s_cmp_gt_u32 s29, 0x400000
    s_cbranch_scc1 L_lgoT
    s_cmp_ge_u32 s28, 16
    s_cbranch_scc1 L_lgoT
    s_sleep 1
    s_branch L_lwoT
L_lgoT:
    s_cmp_lg_u32 s3, 4
    s_cbranch_scc1 L_pwT
    s_lshl_b32 s31, s5, 2
    s_mul_hi_u32 s31, s31, 1431655766
    v_min_u32 v5, 8, v1
    v_and_b32 v6, 1, v2
    v_lshlrev_b32 v6, 7, v6
    v_lshl_add_u32 v5, v5, 2, v6
    s_lshl_b32 s28, s31, 7
    s_add_u32 s28, s28, 24064
    v_add_u32 v5, s28, v5
    v_and_b32 v6, 3, v0
    v_cmp_lt_u32 vcc, 31, v0
    s_lshl_b32 s28, s6, 7
    s_add_u32 s28, s28, 25728
    v_lshl_add_u32 v6, v6, 2, s28
    v_cndmask_b32 v5, v5, v6, vcc
    v_lshlrev_b32 v5, 0, v5
    s_mov_b32 s28, 48234496
    s_mov_b32 s29, 0
L_pollT:
    buffer_load_dword v6, v5, s[16:19], s28 offen sc1
    s_add_u32 s29, s29, 1
    s_waitcnt vmcnt(0)
    v_cmp_eq_u32 vcc, 0, v6
    s_cmp_gt_u32 s29, 0x40000
    s_cbranch_scc1 L_pgotT
    s_cbranch_vccz L_pgotT
    s_sleep 4
    s_branch L_pollT
L_pgotT:
    s_add_u32 s28, s100, 4
    v_mov_b32 v4, s28
    v_mov_b32 v6, 1
    ds_write_b32 v4, v6
    s_branch L_pdoneT
L_pwT:
    s_add_u32 s28, s100, 4
    v_mov_b32 v4, s28
    s_mov_b32 s29, 0
L_lwTr:
    ds_read_b32 v6, v4
    s_add_u32 s29, s29, 1
    s_waitcnt lgkmcnt(0)
    v_readfirstlane_b32 s28, v6
    s_cmp_gt_u32 s29, 0x400000
    s_cbranch_scc1 L_lgTr
    s_cmp_ge_u32 s28, 1
    s_cbranch_scc1 L_lgTr
    s_sleep 1
    s_branch L_lwTr
L_lgTr:
L_pdoneT:
    s_mov_b32 s70, 0
    s_mov_b32 s71, 2
L_jT_lloop:
    s_add_u32 m0, s61, 0
    s_nop 0
    buffer_load_dwordx4 v8, s[16:19], s63 offen offset:0 sc1 lds
    buffer_load_dwordx4 v8, s[16:19], s63 offen offset:1024 sc1 lds
    buffer_load_dwordx4 v8, s[16:19], s63 offen offset:2048 sc1 lds
    buffer_load_dwordx4 v8, s[16:19], s63 offen offset:3072 sc1 lds
    s_add_u32 m0, s61, 4096
    s_nop 0
    buffer_load_dwordx4 v9, s[16:19], s63 offen offset:0 sc1 lds
    buffer_load_dwordx4 v9, s[16:19], s63 offen offset:1024 sc1 lds
    buffer_load_dwordx4 v9, s[16:19], s63 offen offset:2048 sc1 lds
    buffer_load_dwordx4 v9, s[16:19], s63 offen offset:3072 sc1 lds
    s_add_u32 m0, s62, 0
    s_nop 0
    buffer_load_dwordx4 v10, s[16:19], s64 offen offset:0 sc1 lds
    buffer_load_dwordx4 v10, s[16:19], s64 offen offset:1024 sc1 lds
    buffer_load_dwordx4 v10, s[16:19], s64 offen offset:2048 sc1 lds
    buffer_load_dwordx4 v10, s[16:19], s64 offen offset:3072 sc1 lds
    s_add_u32 m0, s62, 4096
    s_nop 0
    buffer_load_dwordx4 v11, s[16:19], s64 offen offset:0 sc1 lds
    buffer_load_dwordx4 v11, s[16:19], s64 offen offset:1024 sc1 lds
    buffer_load_dwordx4 v11, s[16:19], s64 offen offset:2048 sc1 lds
    buffer_load_dwordx4 v11, s[16:19], s64 offen offset:3072 sc1 lds
    s_add_u32 s63, s63, 147456
    s_add_u32 s64, s64, 262144
    s_add_u32 s66, s66, 1
    s_cmp_eq_u32 s66, 4
    s_cselect_b32 s68, 4294868992, s69
    s_cselect_b32 s66, 0, s66
    s_add_u32 s61, s61, s68
    s_add_u32 s62, s62, s68
    s_add_u32 s67, s67, 1
    s_cmp_eq_u32 s67, 18
    s_cbranch_scc1 L_jT_ltail
    s_cmp_lt_u32 s67, s71
    s_cbranch_scc1 L_jT_lloop
    s_cmp_lg_u32 s70, 0
    s_cbranch_scc1 L_jT_r0
    s_waitcnt vmcnt(16)
    s_add_u32 s71, s71, 1
L_jT_r0:
    s_waitcnt vmcnt(32)
    s_barrier
    s_add_u32 s70, s70, 1
    s_add_u32 s71, s71, 1
    s_branch L_jT_lloop
L_jT_ltail:
    s_waitcnt vmcnt(32)
    s_barrier
    s_waitcnt vmcnt(16)
    s_barrier
    s_waitcnt vmcnt(0)
    s_barrier
    s_mov_b32 s24, s56
    s_mov_b32 s25, s57
    s_mov_b32 s26, 256
    s_mov_b32 s27, 0x20000
    v_mov_b32 v7, 128
    buffer_load_dword v3, v7, s[24:27], 0 offen sc1
    s_barrier
    s_waitcnt vmcnt(0)
    v_readfirstlane_b32 s101, v3
    s_branch L_next
L_jB:
    s_cmp_ge_u32 s3, 4
    s_cbranch_scc1 L_jB_ld
    s_and_b32 s60, s3, 1
    s_lshr_b32 s61, s3, 1
    v_lshrrev_b32 v4, 1, v1
    v_lshlrev_b32 v5, 7, v1
    s_mul_i32 s28, s60, 8192
    v_add_u32 v5, s28, v5
    v_xor_b32 v4, v4, v2
    v_lshl_add_u32 v8, v4, 4, v5
    v_xor_b32 v9, 64, v8
    v_bfe_u32 v4, v0, 2, 2
    v_and_b32 v5, 1, v2
    v_lshl_add_u32 v5, v5, 2, v4
    v_lshl_add_u32 v4, v2, 3, v4
    v_lshlrev_b32 v4, 8, v4
    v_and_b32 v6, 3, v0
    v_lshl_add_u32 v4, v6, 3, v4
    v_add_u32 v4, 16384, v4
    s_mul_i32 s28, s61, 4
    v_xor_b32 v5, s28, v5
    v_xor_b32 v6, 0, v5
    v_lshl_add_u32 v10, v6, 5, v4
    v_xor_b32 v6, 1, v5
    v_lshl_add_u32 v11, v6, 5, v4
    v_xor_b32 v6, 2, v5
    v_lshl_add_u32 v12, v6, 5, v4
    v_xor_b32 v6, 3, v5
    v_lshl_add_u32 v13, v6, 5, v4
    v_mov_b32 v80, 0
    v_mov_b32 v81, 0
    v_mov_b32 v82, 0
    v_mov_b32 v83, 0
    v_mov_b32 v84, 0
    v_mov_b32 v85, 0
    v_mov_b32 v86, 0
    v_mov_b32 v87, 0
    v_mov_b32 v88, 0
    v_mov_b32 v89, 0
    v_mov_b32 v90, 0
    v_mov_b32 v91, 0
    v_mov_b32 v92, 0
    v_mov_b32 v93, 0
    v_mov_b32 v94, 0
    v_mov_b32 v95, 0
    v_mov_b32 v96, 0
    v_mov_b32 v97, 0
    v_mov_b32 v98, 0
    v_mov_b32 v99, 0
    v_mov_b32 v100, 0
    v_mov_b32 v101, 0
    v_mov_b32 v102, 0
    v_mov_b32 v103, 0
    v_mov_b32 v104, 0
    v_mov_b32 v105, 0
    v_mov_b32 v106, 0
    v_mov_b32 v107, 0
    v_mov_b32 v108, 0
    v_mov_b32 v109, 0
    v_mov_b32 v110, 0
    v_mov_b32 v111, 0
    v_mov_b32 v112, 0
    v_mov_b32 v113, 0
    v_mov_b32 v114, 0
    v_mov_b32 v115, 0
    v_mov_b32 v116, 0
    v_mov_b32 v117, 0
    v_mov_b32 v118, 0
    v_mov_b32 v119, 0
    v_mov_b32 v120, 0
    v_mov_b32 v121, 0
    v_mov_b32 v122, 0
    v_mov_b32 v123, 0
    v_mov_b32 v124, 0
    v_mov_b32 v125, 0
    v_mov_b32 v126, 0
    v_mov_b32 v127, 0
    v_mov_b32 v128, 0
    v_mov_b32 v129, 0
    v_mov_b32 v130, 0
    v_mov_b32 v131, 0
    v_mov_b32 v132, 0
    v_mov_b32 v133, 0
    v_mov_b32 v134, 0
    v_mov_b32 v135, 0
    v_mov_b32 v136, 0
    v_mov_b32 v137, 0
    v_mov_b32 v138, 0
    v_mov_b32 v139, 0
    v_mov_b32 v140, 0
    v_mov_b32 v141, 0
    v_mov_b32 v142, 0
    v_mov_b32 v143, 0
    s_mov_b32 s66, 0
    s_mov_b32 s67, 0
    s_mov_b32 s69, 32768
    s_waitcnt lgkmcnt(0)
    s_mov_b32 s16, s58
    s_mov_b32 s17, s59
    s_mov_b32 s18, 50331648
    s_mov_b32 s19, 0x20000
    s_barrier
    ds_read_b128 v[16:19], v8 offset:0
    ds_read_b64_tr_b16 v[32:33], v10 offset:0
    ds_read_b64_tr_b16 v[34:35], v10 offset:1024
    ds_read_b64_tr_b16 v[36:37], v11 offset:0
    ds_read_b64_tr_b16 v[38:39], v11 offset:1024
    ds_read_b64_tr_b16 v[40:41], v12 offset:0
    ds_read_b64_tr_b16 v[42:43], v12 offset:1024
    ds_read_b64_tr_b16 v[44:45], v13 offset:0
    ds_read_b64_tr_b16 v[46:47], v13 offset:1024
    ds_read_b128 v[20:23], v8 offset:2048
    ds_read_b128 v[24:27], v8 offset:4096
    ds_read_b128 v[28:31], v8 offset:6144
L_jB_cloop:
    s_waitcnt lgkmcnt(11)
    s_waitcnt lgkmcnt(9)
    v_mfma_f32_16x16x32_bf16 v[80:83], v[16:19], v[32:35], v[80:83]
    ds_read_b128 v[48:51], v9 offset:0
    ds_read_b64_tr_b16 v[64:65], v10 offset:8192
    s_waitcnt lgkmcnt(9)
    v_mfma_f32_16x16x32_bf16 v[84:87], v[16:19], v[36:39], v[84:87]
    ds_read_b64_tr_b16 v[66:67], v10 offset:9216
    ds_read_b64_tr_b16 v[68:69], v11 offset:8192
    s_waitcnt lgkmcnt(9)
    v_mfma_f32_16x16x32_bf16 v[88:91], v[16:19], v[40:43], v[88:91]
    ds_read_b64_tr_b16 v[70:71], v11 offset:9216
    ds_read_b64_tr_b16 v[72:73], v12 offset:8192
    s_waitcnt lgkmcnt(9)
    v_mfma_f32_16x16x32_bf16 v[92:95], v[16:19], v[44:47], v[92:95]
    ds_read_b64_tr_b16 v[74:75], v12 offset:9216
    ds_read_b64_tr_b16 v[76:77], v13 offset:8192
    s_waitcnt lgkmcnt(10)
    v_mfma_f32_16x16x32_bf16 v[108:111], v[20:23], v[44:47], v[108:111]
    ds_read_b64_tr_b16 v[78:79], v13 offset:9216
    ds_read_b128 v[52:55], v9 offset:2048
    v_mfma_f32_16x16x32_bf16 v[104:107], v[20:23], v[40:43], v[104:107]
    ds_read_b128 v[56:59], v9 offset:4096
    ds_read_b128 v[60:63], v9 offset:6144
    v_mfma_f32_16x16x32_bf16 v[100:103], v[20:23], v[36:39], v[100:103]
    s_add_u32 s66, s66, 1
    s_cmp_eq_u32 s66, 4
    v_mfma_f32_16x16x32_bf16 v[96:99], v[20:23], v[32:35], v[96:99]
    s_cselect_b32 s68, 4294868992, s69
    s_cselect_b32 s66, 0, s66
    s_waitcnt lgkmcnt(13)
    v_mfma_f32_16x16x32_bf16 v[112:115], v[24:27], v[32:35], v[112:115]
    v_add_u32 v8, s68, v8
    v_add_u32 v9, s68, v9
    v_mfma_f32_16x16x32_bf16 v[116:119], v[24:27], v[36:39], v[116:119]
    v_add_u32 v10, s68, v10
    v_mfma_f32_16x16x32_bf16 v[120:123], v[24:27], v[40:43], v[120:123]
    v_add_u32 v11, s68, v11
    v_mfma_f32_16x16x32_bf16 v[124:127], v[24:27], v[44:47], v[124:127]
    v_add_u32 v12, s68, v12
    s_waitcnt lgkmcnt(12)
    v_mfma_f32_16x16x32_bf16 v[140:143], v[28:31], v[44:47], v[140:143]
    v_add_u32 v13, s68, v13
    v_mfma_f32_16x16x32_bf16 v[136:139], v[28:31], v[40:43], v[136:139]
    s_add_u32 s67, s67, 1
    v_mfma_f32_16x16x32_bf16 v[132:135], v[28:31], v[36:39], v[132:135]
    s_cmp_eq_u32 s67, 18
    v_mfma_f32_16x16x32_bf16 v[128:131], v[28:31], v[32:35], v[128:131]
    s_cbranch_scc1 L_jB_ctail
    s_waitcnt lgkmcnt(0)
    s_barrier
    v_mfma_f32_16x16x32_bf16 v[80:83], v[48:51], v[64:67], v[80:83]
    ds_read_b128 v[16:19], v8 offset:0
    ds_read_b64_tr_b16 v[32:33], v10 offset:0
    v_mfma_f32_16x16x32_bf16 v[84:87], v[48:51], v[68:71], v[84:87]
    ds_read_b64_tr_b16 v[34:35], v10 offset:1024
    ds_read_b64_tr_b16 v[36:37], v11 offset:0
    v_mfma_f32_16x16x32_bf16 v[88:91], v[48:51], v[72:75], v[88:91]
    ds_read_b64_tr_b16 v[38:39], v11 offset:1024
    ds_read_b64_tr_b16 v[40:41], v12 offset:0
    v_mfma_f32_16x16x32_bf16 v[92:95], v[48:51], v[76:79], v[92:95]
    ds_read_b64_tr_b16 v[42:43], v12 offset:1024
    ds_read_b64_tr_b16 v[44:45], v13 offset:0
    v_mfma_f32_16x16x32_bf16 v[108:111], v[52:55], v[76:79], v[108:111]
    ds_read_b64_tr_b16 v[46:47], v13 offset:1024
    ds_read_b128 v[20:23], v8 offset:2048
    v_mfma_f32_16x16x32_bf16 v[104:107], v[52:55], v[72:75], v[104:107]
    ds_read_b128 v[24:27], v8 offset:4096
    ds_read_b128 v[28:31], v8 offset:6144
    v_mfma_f32_16x16x32_bf16 v[100:103], v[52:55], v[68:71], v[100:103]
    v_mfma_f32_16x16x32_bf16 v[96:99], v[52:55], v[64:67], v[96:99]
    v_mfma_f32_16x16x32_bf16 v[112:115], v[56:59], v[64:67], v[112:115]
    v_mfma_f32_16x16x32_bf16 v[116:119], v[56:59], v[68:71], v[116:119]
    v_mfma_f32_16x16x32_bf16 v[120:123], v[56:59], v[72:75], v[120:123]
    v_mfma_f32_16x16x32_bf16 v[124:127], v[56:59], v[76:79], v[124:127]
    v_mfma_f32_16x16x32_bf16 v[140:143], v[60:63], v[76:79], v[140:143]
    v_mfma_f32_16x16x32_bf16 v[136:139], v[60:63], v[72:75], v[136:139]
    v_mfma_f32_16x16x32_bf16 v[132:135], v[60:63], v[68:71], v[132:135]
    v_mfma_f32_16x16x32_bf16 v[128:131], v[60:63], v[64:67], v[128:131]
    s_branch L_jB_cloop
L_jB_ctail:
    s_waitcnt lgkmcnt(0)
    s_barrier
    v_mfma_f32_16x16x32_bf16 v[80:83], v[48:51], v[64:67], v[80:83]
    v_mfma_f32_16x16x32_bf16 v[84:87], v[48:51], v[68:71], v[84:87]
    v_mfma_f32_16x16x32_bf16 v[88:91], v[48:51], v[72:75], v[88:91]
    v_mfma_f32_16x16x32_bf16 v[92:95], v[48:51], v[76:79], v[92:95]
    v_mfma_f32_16x16x32_bf16 v[108:111], v[52:55], v[76:79], v[108:111]
    v_mfma_f32_16x16x32_bf16 v[104:107], v[52:55], v[72:75], v[104:107]
    v_mfma_f32_16x16x32_bf16 v[100:103], v[52:55], v[68:71], v[100:103]
    v_mfma_f32_16x16x32_bf16 v[96:99], v[52:55], v[64:67], v[96:99]
    v_mfma_f32_16x16x32_bf16 v[112:115], v[56:59], v[64:67], v[112:115]
    v_mfma_f32_16x16x32_bf16 v[116:119], v[56:59], v[68:71], v[116:119]
    v_mfma_f32_16x16x32_bf16 v[120:123], v[56:59], v[72:75], v[120:123]
    v_mfma_f32_16x16x32_bf16 v[124:127], v[56:59], v[76:79], v[124:127]
    v_mfma_f32_16x16x32_bf16 v[140:143], v[60:63], v[76:79], v[140:143]
    v_mfma_f32_16x16x32_bf16 v[136:139], v[60:63], v[72:75], v[136:139]
    v_mfma_f32_16x16x32_bf16 v[132:135], v[60:63], v[68:71], v[132:135]
    v_mfma_f32_16x16x32_bf16 v[128:131], v[60:63], v[64:67], v[128:131]
    s_mov_b32 s24, s56
    s_mov_b32 s25, s57
    s_mov_b32 s26, 256
    s_mov_b32 s27, 0x20000
    v_mov_b32 v7, 128
    buffer_load_dword v3, v7, s[24:27], 0 offen sc1
    s_lshl_b32 s30, s6, 3
    s_lshl_b32 s31, s5, 2
    s_mov_b32 s28, s30
    s_mul_i32 s29, s61, 4
    s_add_u32 s28, s28, s29
    s_lshl_b32 s28, s28, 11
    s_mov_b32 s32, s31
    s_mul_i32 s29, s60, 2
    s_add_u32 s32, s32, s29
    s_lshr_b32 s29, s32, 1
    s_mul_i32 s29, s29, 147456
    s_add_u32 s28, s28, s29
    s_add_u32 s28, s28, 13631488
    v_lshlrev_b32 v4, 4, v0
    s_nop 1
    v_cvt_pk_bf16_f32 v16, v80, v81
    v_cvt_pk_bf16_f32 v17, v82, v83
    v_cvt_pk_bf16_f32 v18, v96, v97
    v_cvt_pk_bf16_f32 v19, v98, v99
    buffer_store_dwordx4 v[16:19], v4, s[16:19], s28 offen offset:0 sc1
    v_cvt_pk_bf16_f32 v20, v112, v113
    v_cvt_pk_bf16_f32 v21, v114, v115
    v_cvt_pk_bf16_f32 v22, v128, v129
    v_cvt_pk_bf16_f32 v23, v130, v131
    buffer_store_dwordx4 v[20:23], v4, s[16:19], s28 offen offset:1024 sc1
    v_cvt_pk_bf16_f32 v24, v84, v85
    v_cvt_pk_bf16_f32 v25, v86, v87
    v_cvt_pk_bf16_f32 v26, v100, v101
    v_cvt_pk_bf16_f32 v27, v102, v103
    buffer_store_dwordx4 v[24:27], v4, s[16:19], s28 offen offset:2048 sc1
    v_cvt_pk_bf16_f32 v28, v116, v117
    v_cvt_pk_bf16_f32 v29, v118, v119
    v_cvt_pk_bf16_f32 v30, v132, v133
    v_cvt_pk_bf16_f32 v31, v134, v135
    buffer_store_dwordx4 v[28:31], v4, s[16:19], s28 offen offset:3072 sc1
    s_add_u32 s28, s28, 4096
    v_cvt_pk_bf16_f32 v32, v88, v89
    v_cvt_pk_bf16_f32 v33, v90, v91
    v_cvt_pk_bf16_f32 v34, v104, v105
    v_cvt_pk_bf16_f32 v35, v106, v107
    buffer_store_dwordx4 v[32:35], v4, s[16:19], s28 offen offset:0 sc1
    v_cvt_pk_bf16_f32 v36, v120, v121
    v_cvt_pk_bf16_f32 v37, v122, v123
    v_cvt_pk_bf16_f32 v38, v136, v137
    v_cvt_pk_bf16_f32 v39, v138, v139
    buffer_store_dwordx4 v[36:39], v4, s[16:19], s28 offen offset:1024 sc1
    v_cvt_pk_bf16_f32 v40, v92, v93
    v_cvt_pk_bf16_f32 v41, v94, v95
    v_cvt_pk_bf16_f32 v42, v108, v109
    v_cvt_pk_bf16_f32 v43, v110, v111
    buffer_store_dwordx4 v[40:43], v4, s[16:19], s28 offen offset:2048 sc1
    v_cvt_pk_bf16_f32 v44, v124, v125
    v_cvt_pk_bf16_f32 v45, v126, v127
    v_cvt_pk_bf16_f32 v46, v140, v141
    v_cvt_pk_bf16_f32 v47, v142, v143
    buffer_store_dwordx4 v[44:47], v4, s[16:19], s28 offen offset:3072 sc1
    s_lshl_b32 s30, s6, 7
    s_lshl_b32 s31, s5, 2
    s_add_u32 s30, s30, s31
    s_add_u32 s30, s30, 18432
    s_mov_b64 exec, 1
    s_lshl_b32 s30, s30, 0
    s_add_u32 s30, s30, 48234496
    v_mov_b32 v5, 2
    s_add_u32 s28, s100, 8
    v_mov_b32 v4, s28
    s_waitcnt vmcnt(0)
    s_mov_b32 s28, 0
    v_mov_b32 v7, 128
L_prjB:
    v_readfirstlane_b32 s29, v3
    s_add_u32 s28, s28, 1
    s_cmp_gt_u32 s28, 0x40000
    s_cbranch_scc1 L_prdjB
    s_cmp_lg_u32 s29, 0
    s_cbranch_scc1 L_prdjB
    buffer_load_dword v3, v7, s[24:27], 0 offen sc1
    s_waitcnt vmcnt(0)
    s_branch L_prjB
L_prdjB:
    v_mov_b32 v7, 0
    ds_add_rtn_u32 v6, v4, v5
    s_waitcnt lgkmcnt(0)
    v_readfirstlane_b32 s29, v6
    s_cmp_lg_u32 s29, 6
    s_cbranch_scc1 L_sejB
    buffer_store_dword v5, v7, s[16:19], s30 offen sc1
    v_mov_b32 v6, 16
    ds_write_b32 v4, v6
L_sejB:
    s_mov_b64 exec, -1
    s_branch L_next
L_jB_ld:
    s_sub_u32 s60, s3, 4
    v_lshrrev_b32 v4, 3, v0
    v_and_b32 v5, 7, v0
    s_and_b32 s29, s60, 1
    s_lshl_b32 s29, s29, 2
    v_add_u32 v6, s29, v2
    v_xor_b32 v5, v5, v6
    v_mul_u32_u24 v4, 6912, v4
    v_lshl_add_u32 v4, v5, 4, v4
    s_mul_i32 s28, s5, 884736
    s_mul_i32 s29, s60, 55296
    s_add_u32 s28, s28, s29
    s_add_u32 s28, s28, 4608
    v_add_u32 v8, s28, v4
    s_lshl_b32 s61, s60, 10
    v_add_u32 v9, 108544, v8
    v_add_u32 v10, 221184, v8
    v_add_u32 v11, 329728, v8
    v_add_u32 v12, 442368, v8
    v_add_u32 v13, 550912, v8
    v_add_u32 v14, 663552, v8
    v_add_u32 v15, 772096, v8
    v_lshrrev_b32 v4, 4, v0
    v_and_b32 v5, 15, v0
    v_lshlrev_b32 v6, 1, v2
    v_xor_b32 v5, v5, v6
    v_mul_u32_u24 v4, 2304, v4
    v_lshl_add_u32 v4, v5, 4, v4
    s_mul_i32 s28, s6, 256
    s_mul_i32 s29, s60, 9216
    s_add_u32 s28, s28, s29
    v_add_u32 v16, s28, v4
    s_lshl_b32 s62, s60, 10
    s_add_u32 s62, s62, 16384
    v_xor_b32 v4, 128, v16
    v_add_u32 v17, 16384, v4
    v_add_u32 v18, 36864, v16
    v_add_u32 v19, 53248, v4
    v_add_u32 v20, 73728, v16
    v_add_u32 v21, 90112, v4
    v_add_u32 v22, 110592, v16
    v_add_u32 v23, 126976, v4
    s_mul_i32 s63, s7, 128
    s_mul_i32 s64, s7, 147456
    s_mov_b32 s65, s7
    s_mov_b32 s66, 0
    s_mov_b32 s67, 0
    s_mov_b32 s69, 32768
    s_waitcnt lgkmcnt(0)
    s_mov_b32 s8, s42
    s_mov_b32 s9, s43
    s_mov_b32 s10, 7962624
    s_mov_b32 s11, 0x20000
    s_mov_b32 s12, s44
    s_mov_b32 s13, s45
    s_mov_b32 s14, 2654208
    s_mov_b32 s15, 0x20000
    s_add_u32 s28, s100, 0
    v_mov_b32 v4, s28
    s_mov_b32 s29, 0
L_lwoB:
    ds_read_b32 v6, v4
    s_add_u32 s29, s29, 1
    s_waitcnt lgkmcnt(0)
    v_readfirstlane_b32 s28, v6
    s_cmp_gt_u32 s29, 0x400000
    s_cbranch_scc1 L_lgoB
    s_cmp_ge_u32 s28, 16
    s_cbranch_scc1 L_lgoB
    s_sleep 1
    s_branch L_lwoB
L_lgoB:
    s_mov_b32 s70, 0
    s_mov_b32 s71, 2
L_jB_lloop:
    s_add_u32 m0, s61, 0
    s_nop 0
    buffer_load_dwordx4 v8, s[8:11], s63 offen offset:0 lds
    buffer_load_dwordx4 v9, s[8:11], s63 offen offset:2048 lds
    s_add_u32 m0, s61, 4096
    s_nop 0
    buffer_load_dwordx4 v10, s[8:11], s63 offen offset:0 lds
    buffer_load_dwordx4 v11, s[8:11], s63 offen offset:2048 lds
    s_add_u32 m0, s61, 8192
    s_nop 0
    buffer_load_dwordx4 v12, s[8:11], s63 offen offset:0 lds
    buffer_load_dwordx4 v13, s[8:11], s63 offen offset:2048 lds
    s_add_u32 m0, s61, 12288
    s_nop 0
    buffer_load_dwordx4 v14, s[8:11], s63 offen offset:0 lds
    buffer_load_dwordx4 v15, s[8:11], s63 offen offset:2048 lds
    s_add_u32 m0, s62, 0
    s_nop 0
    buffer_load_dwordx4 v16, s[12:15], s64 offen offset:0 lds
    buffer_load_dwordx4 v17, s[12:15], s64 offen offset:2048 lds
    s_add_u32 m0, s62, 4096
    s_nop 0
    buffer_load_dwordx4 v18, s[12:15], s64 offen offset:0 lds
    buffer_load_dwordx4 v19, s[12:15], s64 offen offset:2048 lds
    s_add_u32 m0, s62, 8192
    s_nop 0
    buffer_load_dwordx4 v20, s[12:15], s64 offen offset:0 lds
    buffer_load_dwordx4 v21, s[12:15], s64 offen offset:2048 lds
    s_add_u32 m0, s62, 12288
    s_nop 0
    buffer_load_dwordx4 v22, s[12:15], s64 offen offset:0 lds
    buffer_load_dwordx4 v23, s[12:15], s64 offen offset:2048 lds
    s_add_u32 s63, s63, 128
    s_add_u32 s64, s64, 147456
    s_add_u32 s65, s65, 1
    s_cmp_eq_u32 s65, 18
    s_cselect_b32 s63, 0, s63
    s_cselect_b32 s64, 0, s64
    s_cselect_b32 s65, 0, s65
    s_add_u32 s66, s66, 1
    s_cmp_eq_u32 s66, 4
    s_cselect_b32 s68, 4294868992, s69
    s_cselect_b32 s66, 0, s66
    s_add_u32 s61, s61, s68
    s_add_u32 s62, s62, s68
    s_add_u32 s67, s67, 1
    s_cmp_eq_u32 s67, 18
    s_cbranch_scc1 L_jB_ltail
    s_cmp_lt_u32 s67, s71
    s_cbranch_scc1 L_jB_lloop
    s_cmp_lg_u32 s70, 0
    s_cbranch_scc1 L_jB_r0
    s_waitcnt vmcnt(16)
    s_add_u32 s71, s71, 1
L_jB_r0:
    s_waitcnt vmcnt(32)
    s_barrier
    s_add_u32 s70, s70, 1
    s_add_u32 s71, s71, 1
    s_branch L_jB_lloop
L_jB_ltail:
    s_waitcnt vmcnt(32)
    s_barrier
    s_waitcnt vmcnt(16)
    s_barrier
    s_waitcnt vmcnt(0)
    s_barrier
    s_mov_b32 s24, s56
    s_mov_b32 s25, s57
    s_mov_b32 s26, 256
    s_mov_b32 s27, 0x20000
    v_mov_b32 v7, 128
    buffer_load_dword v3, v7, s[24:27], 0 offen sc1
    s_barrier
    s_waitcnt vmcnt(0)
    v_readfirstlane_b32 s101, v3
    s_branch L_next
L_jU:
    s_cmp_ge_u32 s3, 4
    s_cbranch_scc1 L_jU_ld
    v_lshlrev_b32 v8, 4, v0
    s_mul_i32 s28, s3, 4096
    v_add_u32 v8, s28, v8
    v_lshlrev_b32 v9, 4, v0
    v_add_u32 v9, 16384, v9
    v_mov_b32 v100, 0
    v_mov_b32 v101, 0
    v_mov_b32 v102, 0
    v_mov_b32 v103, 0
    v_mov_b32 v104, 0
    v_mov_b32 v105, 0
    v_mov_b32 v106, 0
    v_mov_b32 v107, 0
    v_mov_b32 v108, 0
    v_mov_b32 v109, 0
    v_mov_b32 v110, 0
    v_mov_b32 v111, 0
    v_mov_b32 v112, 0
    v_mov_b32 v113, 0
    v_mov_b32 v114, 0
    v_mov_b32 v115, 0
    v_mov_b32 v116, 0
    v_mov_b32 v117, 0
    v_mov_b32 v118, 0
    v_mov_b32 v119, 0
    v_mov_b32 v120, 0
    v_mov_b32 v121, 0
    v_mov_b32 v122, 0
    v_mov_b32 v123, 0
    v_mov_b32 v124, 0
    v_mov_b32 v125, 0
    v_mov_b32 v126, 0
    v_mov_b32 v127, 0
    v_mov_b32 v128, 0
    v_mov_b32 v129, 0
    v_mov_b32 v130, 0
    v_mov_b32 v131, 0
    v_mov_b32 v132, 0
    v_mov_b32 v133, 0
    v_mov_b32 v134, 0
    v_mov_b32 v135, 0
    v_mov_b32 v136, 0
    v_mov_b32 v137, 0
    v_mov_b32 v138, 0
    v_mov_b32 v139, 0
    v_mov_b32 v140, 0
    v_mov_b32 v141, 0
    v_mov_b32 v142, 0
    v_mov_b32 v143, 0
    v_mov_b32 v144, 0
    v_mov_b32 v145, 0
    v_mov_b32 v146, 0
    v_mov_b32 v147, 0
    v_mov_b32 v148, 0
    v_mov_b32 v149, 0
    v_mov_b32 v150, 0
    v_mov_b32 v151, 0
    v_mov_b32 v152, 0
    v_mov_b32 v153, 0
    v_mov_b32 v154, 0
    v_mov_b32 v155, 0
    v_mov_b32 v156, 0
    v_mov_b32 v157, 0
    v_mov_b32 v158, 0
    v_mov_b32 v159, 0
    v_mov_b32 v160, 0
    v_mov_b32 v161, 0
    v_mov_b32 v162, 0
    v_mov_b32 v163, 0
    v_mov_b32 v164, 0
    v_mov_b32 v165, 0
    v_mov_b32 v166, 0
    v_mov_b32 v167, 0
    v_mov_b32 v168, 0
    v_mov_b32 v169, 0
    v_mov_b32 v170, 0
    v_mov_b32 v171, 0
    s_mov_b32 s66, 0
    s_mov_b32 s67, 0
    s_mov_b32 s69, 34816
    s_waitcnt lgkmcnt(0)
    s_mov_b32 s16, s58
    s_mov_b32 s17, s59
    s_mov_b32 s18, 50331648
    s_mov_b32 s19, 0x20000
    s_barrier
    ds_read_b128 v[12:15], v8 offset:0
    ds_read_b128 v[20:23], v9 offset:0
    ds_read_b128 v[16:19], v8 offset:2048
    ds_read_b128 v[24:27], v9 offset:2048
    ds_read_b128 v[28:31], v9 offset:4096
    ds_read_b128 v[32:35], v9 offset:6144
    ds_read_b128 v[36:39], v9 offset:8192
    ds_read_b128 v[40:43], v9 offset:10240
    ds_read_b128 v[44:47], v9 offset:12288
    ds_read_b128 v[48:51], v9 offset:14336
    ds_read_b128 v[52:55], v9 offset:16384
L_jU_cloop:
    s_waitcnt lgkmcnt(10)
    s_waitcnt lgkmcnt(9)
    v_mfma_f32_16x16x32_bf16 v[100:103], v[12:15], v[20:23], v[100:103]
    ds_read_b128 v[56:59], v8 offset:1024
    s_waitcnt lgkmcnt(9)
    v_mfma_f32_16x16x32_bf16 v[136:139], v[16:19], v[20:23], v[136:139]
    ds_read_b128 v[64:67], v9 offset:1024
    s_waitcnt lgkmcnt(9)
    v_mfma_f32_16x16x32_bf16 v[140:143], v[16:19], v[24:27], v[140:143]
    ds_read_b128 v[60:63], v8 offset:3072
    v_mfma_f32_16x16x32_bf16 v[104:107], v[12:15], v[24:27], v[104:107]
    ds_read_b128 v[68:71], v9 offset:3072
    s_waitcnt lgkmcnt(10)
    v_mfma_f32_16x16x32_bf16 v[108:111], v[12:15], v[28:31], v[108:111]
    ds_read_b128 v[72:75], v9 offset:5120
    v_mfma_f32_16x16x32_bf16 v[144:147], v[16:19], v[28:31], v[144:147]
    ds_read_b128 v[76:79], v9 offset:7168
    s_waitcnt lgkmcnt(11)
    v_mfma_f32_16x16x32_bf16 v[148:151], v[16:19], v[32:35], v[148:151]
    ds_read_b128 v[80:83], v9 offset:9216
    v_mfma_f32_16x16x32_bf16 v[112:115], v[12:15], v[32:35], v[112:115]
    ds_read_b128 v[84:87], v9 offset:11264
    s_waitcnt lgkmcnt(12)
    v_mfma_f32_16x16x32_bf16 v[116:119], v[12:15], v[36:39], v[116:119]
    ds_read_b128 v[88:91], v9 offset:13312
    v_mfma_f32_16x16x32_bf16 v[152:155], v[16:19], v[36:39], v[152:155]
    ds_read_b128 v[92:95], v9 offset:15360
    s_waitcnt lgkmcnt(13)
    v_mfma_f32_16x16x32_bf16 v[156:159], v[16:19], v[40:43], v[156:159]
    ds_read_b128 v[96:99], v9 offset:17408
    v_mfma_f32_16x16x32_bf16 v[120:123], v[12:15], v[40:43], v[120:123]
    s_add_u32 s66, s66, 1
    s_cmp_eq_u32 s66, 4
    s_waitcnt lgkmcnt(13)
    v_mfma_f32_16x16x32_bf16 v[124:127], v[12:15], v[44:47], v[124:127]
    s_cselect_b32 s68, 4294862848, s69
    s_cselect_b32 s66, 0, s66
    v_mfma_f32_16x16x32_bf16 v[160:163], v[16:19], v[44:47], v[160:163]
    v_add_u32 v8, s68, v8
    s_waitcnt lgkmcnt(12)
    v_mfma_f32_16x16x32_bf16 v[164:167], v[16:19], v[48:51], v[164:167]
    v_add_u32 v9, s68, v9
    v_mfma_f32_16x16x32_bf16 v[128:131], v[12:15], v[48:51], v[128:131]
    s_add_u32 s67, s67, 1
    s_waitcnt lgkmcnt(11)
    v_mfma_f32_16x16x32_bf16 v[132:135], v[12:15], v[52:55], v[132:135]
    s_cmp_eq_u32 s67, 18
    v_mfma_f32_16x16x32_bf16 v[168:171], v[16:19], v[52:55], v[168:171]
    s_cbranch_scc1 L_jU_ctail
    s_waitcnt lgkmcnt(0)
    s_barrier
    v_mfma_f32_16x16x32_bf16 v[100:103], v[56:59], v[64:67], v[100:103]
    ds_read_b128 v[12:15], v8 offset:0
    v_mfma_f32_16x16x32_bf16 v[136:139], v[60:63], v[64:67], v[136:139]
    ds_read_b128 v[20:23], v9 offset:0
    v_mfma_f32_16x16x32_bf16 v[140:143], v[60:63], v[68:71], v[140:143]
    ds_read_b128 v[16:19], v8 offset:2048
    v_mfma_f32_16x16x32_bf16 v[104:107], v[56:59], v[68:71], v[104:107]
    ds_read_b128 v[24:27], v9 offset:2048
    v_mfma_f32_16x16x32_bf16 v[108:111], v[56:59], v[72:75], v[108:111]
    ds_read_b128 v[28:31], v9 offset:4096
    v_mfma_f32_16x16x32_bf16 v[144:147], v[60:63], v[72:75], v[144:147]
    ds_read_b128 v[32:35], v9 offset:6144
    v_mfma_f32_16x16x32_bf16 v[148:151], v[60:63], v[76:79], v[148:151]
    ds_read_b128 v[36:39], v9 offset:8192
    v_mfma_f32_16x16x32_bf16 v[112:115], v[56:59], v[76:79], v[112:115]
    ds_read_b128 v[40:43], v9 offset:10240
    v_mfma_f32_16x16x32_bf16 v[116:119], v[56:59], v[80:83], v[116:119]
    ds_read_b128 v[44:47], v9 offset:12288
    v_mfma_f32_16x16x32_bf16 v[152:155], v[60:63], v[80:83], v[152:155]
    ds_read_b128 v[48:51], v9 offset:14336
    v_mfma_f32_16x16x32_bf16 v[156:159], v[60:63], v[84:87], v[156:159]
    ds_read_b128 v[52:55], v9 offset:16384
    v_mfma_f32_16x16x32_bf16 v[120:123], v[56:59], v[84:87], v[120:123]
    v_mfma_f32_16x16x32_bf16 v[124:127], v[56:59], v[88:91], v[124:127]
    v_mfma_f32_16x16x32_bf16 v[160:163], v[60:63], v[88:91], v[160:163]
    v_mfma_f32_16x16x32_bf16 v[164:167], v[60:63], v[92:95], v[164:167]
    v_mfma_f32_16x16x32_bf16 v[128:131], v[56:59], v[92:95], v[128:131]
    v_mfma_f32_16x16x32_bf16 v[132:135], v[56:59], v[96:99], v[132:135]
    v_mfma_f32_16x16x32_bf16 v[168:171], v[60:63], v[96:99], v[168:171]
    s_branch L_jU_cloop
L_jU_ctail:
    s_waitcnt lgkmcnt(0)
    s_barrier
    v_mfma_f32_16x16x32_bf16 v[100:103], v[56:59], v[64:67], v[100:103]
    v_mfma_f32_16x16x32_bf16 v[136:139], v[60:63], v[64:67], v[136:139]
    v_mfma_f32_16x16x32_bf16 v[140:143], v[60:63], v[68:71], v[140:143]
    v_mfma_f32_16x16x32_bf16 v[104:107], v[56:59], v[68:71], v[104:107]
    v_mfma_f32_16x16x32_bf16 v[108:111], v[56:59], v[72:75], v[108:111]
    v_mfma_f32_16x16x32_bf16 v[144:147], v[60:63], v[72:75], v[144:147]
    v_mfma_f32_16x16x32_bf16 v[148:151], v[60:63], v[76:79], v[148:151]
    v_mfma_f32_16x16x32_bf16 v[112:115], v[56:59], v[76:79], v[112:115]
    v_mfma_f32_16x16x32_bf16 v[116:119], v[56:59], v[80:83], v[116:119]
    v_mfma_f32_16x16x32_bf16 v[152:155], v[60:63], v[80:83], v[152:155]
    v_mfma_f32_16x16x32_bf16 v[156:159], v[60:63], v[84:87], v[156:159]
    v_mfma_f32_16x16x32_bf16 v[120:123], v[56:59], v[84:87], v[120:123]
    v_mfma_f32_16x16x32_bf16 v[124:127], v[56:59], v[88:91], v[124:127]
    v_mfma_f32_16x16x32_bf16 v[160:163], v[60:63], v[88:91], v[160:163]
    v_mfma_f32_16x16x32_bf16 v[164:167], v[60:63], v[92:95], v[164:167]
    v_mfma_f32_16x16x32_bf16 v[128:131], v[56:59], v[92:95], v[128:131]
    v_mfma_f32_16x16x32_bf16 v[132:135], v[56:59], v[96:99], v[132:135]
    v_mfma_f32_16x16x32_bf16 v[168:171], v[60:63], v[96:99], v[168:171]
    s_lshr_b32 s30, s5, 3
    s_mul_i32 s30, s30, 72
    s_mul_i32 s31, s6, 9
    s_add_u32 s30, s30, s31
    s_and_b32 s31, s5, 7
    s_lshl_b32 s31, s31, 2
    s_mov_b32 s28, s30
    s_lshl_b32 s28, s28, 11
    s_mov_b32 s32, s31
    s_mul_i32 s29, s3, 1
    s_add_u32 s32, s32, s29
    s_lshr_b32 s29, s32, 1
    s_mul_i32 s29, s29, 294912
    s_add_u32 s28, s28, s29
    s_and_b32 s29, s32, 1
    s_lshl_b32 s29, s29, 10
    s_add_u32 s28, s28, s29
    s_add_u32 s28, s28, 23068672
    v_lshlrev_b32 v4, 4, v0
    s_nop 1
    v_cvt_pk_bf16_f32 v12, v100, v101
    v_cvt_pk_bf16_f32 v13, v102, v103
    v_cvt_pk_bf16_f32 v14, v136, v137
    v_cvt_pk_bf16_f32 v15, v138, v139
    buffer_store_dwordx4 v[12:15], v4, s[16:19], s28 offen offset:0 sc1
    v_cvt_pk_bf16_f32 v16, v104, v105
    v_cvt_pk_bf16_f32 v17, v106, v107
    v_cvt_pk_bf16_f32 v18, v140, v141
    v_cvt_pk_bf16_f32 v19, v142, v143
    buffer_store_dwordx4 v[16:19], v4, s[16:19], s28 offen offset:2048 sc1
    s_add_u32 s28, s28, 4096
    v_cvt_pk_bf16_f32 v20, v108, v109
    v_cvt_pk_bf16_f32 v21, v110, v111
    v_cvt_pk_bf16_f32 v22, v144, v145
    v_cvt_pk_bf16_f32 v23, v146, v147
    buffer_store_dwordx4 v[20:23], v4, s[16:19], s28 offen offset:0 sc1
    v_cvt_pk_bf16_f32 v24, v112, v113
    v_cvt_pk_bf16_f32 v25, v114, v115
    v_cvt_pk_bf16_f32 v26, v148, v149
    v_cvt_pk_bf16_f32 v27, v150, v151
    buffer_store_dwordx4 v[24:27], v4, s[16:19], s28 offen offset:2048 sc1
    s_add_u32 s28, s28, 4096
    v_cvt_pk_bf16_f32 v28, v116, v117
    v_cvt_pk_bf16_f32 v29, v118, v119
    v_cvt_pk_bf16_f32 v30, v152, v153
    v_cvt_pk_bf16_f32 v31, v154, v155
    buffer_store_dwordx4 v[28:31], v4, s[16:19], s28 offen offset:0 sc1
    v_cvt_pk_bf16_f32 v32, v120, v121
    v_cvt_pk_bf16_f32 v33, v122, v123
    v_cvt_pk_bf16_f32 v34, v156, v157
    v_cvt_pk_bf16_f32 v35, v158, v159
    buffer_store_dwordx4 v[32:35], v4, s[16:19], s28 offen offset:2048 sc1
    s_add_u32 s28, s28, 4096
    v_cvt_pk_bf16_f32 v36, v124, v125
    v_cvt_pk_bf16_f32 v37, v126, v127
    v_cvt_pk_bf16_f32 v38, v160, v161
    v_cvt_pk_bf16_f32 v39, v162, v163
    buffer_store_dwordx4 v[36:39], v4, s[16:19], s28 offen offset:0 sc1
    v_cvt_pk_bf16_f32 v40, v128, v129
    v_cvt_pk_bf16_f32 v41, v130, v131
    v_cvt_pk_bf16_f32 v42, v164, v165
    v_cvt_pk_bf16_f32 v43, v166, v167
    buffer_store_dwordx4 v[40:43], v4, s[16:19], s28 offen offset:2048 sc1
    s_add_u32 s28, s28, 4096
    v_cvt_pk_bf16_f32 v44, v132, v133
    v_cvt_pk_bf16_f32 v45, v134, v135
    v_cvt_pk_bf16_f32 v46, v168, v169
    v_cvt_pk_bf16_f32 v47, v170, v171
    buffer_store_dwordx4 v[44:47], v4, s[16:19], s28 offen offset:0 sc1
    s_and_b32 s30, s5, 8
    s_add_u32 s30, s30, s6
    s_lshl_b32 s30, s30, 7
    s_and_b32 s31, s5, 7
    s_lshl_b32 s31, s31, 2
    s_add_u32 s30, s30, s31
    s_add_u32 s30, s30, 22016
    s_mov_b64 exec, 1
    s_lshl_b32 s30, s30, 0
    s_add_u32 s30, s30, 48234496
    v_mov_b32 v5, 2
    s_add_u32 s28, s100, 8
    v_mov_b32 v4, s28
    s_waitcnt vmcnt(0)
    v_mov_b32 v7, 0
    ds_add_rtn_u32 v6, v4, v5
    s_waitcnt lgkmcnt(0)
    v_readfirstlane_b32 s29, v6
    s_cmp_lg_u32 s29, 6
    s_cbranch_scc1 L_sejU
    buffer_store_dword v5, v7, s[16:19], s30 offen sc1
    v_mov_b32 v6, 16
    ds_write_b32 v4, v6
L_sejU:
    s_mov_b64 exec, -1
    s_branch L_next
L_jU_ld:
    s_sub_u32 s60, s3, 4
    s_mul_i32 s28, s5, 16384
    s_mul_i32 s29, s60, 8192
    s_add_u32 s28, s28, s29
    s_add_u32 s28, s28, 5242880
    v_lshl_add_u32 v8, v0, 4, s28
    s_mov_b32 s61, s29
    v_add_u32 v9, 4096, v8
    s_mul_i32 s28, s6, 18432
    s_mul_i32 s29, s60, 9216
    s_add_u32 s28, s28, s29
    s_add_u32 s28, s28, 13631488
    v_lshl_add_u32 v10, v0, 4, s28
    s_add_u32 s62, s29, 16384
    v_add_u32 v11, 4096, v10
    v_add_u32 v12, 8192, v10
    s_mov_b32 s63, 0
    s_mov_b32 s64, 0
    s_mov_b32 s66, 0
    s_mov_b32 s67, 0
    s_mov_b32 s69, 34816
    s_waitcnt lgkmcnt(0)
    s_mov_b32 s16, s58
    s_mov_b32 s17, s59
    s_mov_b32 s18, 50331648
    s_mov_b32 s19, 0x20000
    s_cmp_lg_u32 s3, 4
    s_cbranch_scc1 L_pwU
    s_cmp_eq_u32 s6, 7
    s_cselect_b32 s31, 14, 11
    v_min_u32 v5, s31, v0
    v_cmp_lt_u32 vcc, 5, v0
    v_add_u32 v6, 26, v5
    s_lshl_b32 s28, s6, 7
    s_add_u32 s28, s28, 18432
    v_cndmask_b32 v5, v5, v6, vcc
    v_lshl_add_u32 v5, v5, 2, s28
    v_and_b32 v6, 3, v0
    v_cmp_lt_u32 vcc, 31, v0
    s_lshl_b32 s28, s5, 7
    s_add_u32 s28, s28, 25728
    v_lshl_add_u32 v6, v6, 2, s28
    v_cndmask_b32 v5, v5, v6, vcc
    v_lshlrev_b32 v5, 0, v5
    s_cmp_eq_u32 s101, 0
    s_cbranch_scc1 L_poU
    s_mov_b32 s28, 48234496
    buffer_load_dword v6, v5, s[16:19], s28 offen sc1
    s_waitcnt vmcnt(0)
    v_cmp_eq_u32 vcc, 0, v6
    s_nop 0
    s_cbranch_vccz L_pgotU
L_poU:
    s_add_u32 s28, s100, 0
    v_mov_b32 v4, s28
    s_mov_b32 s29, 0
L_lwoU:
    ds_read_b32 v6, v4
    s_add_u32 s29, s29, 1
    s_waitcnt lgkmcnt(0)
    v_readfirstlane_b32 s28, v6
    s_cmp_gt_u32 s29, 0x400000
    s_cbranch_scc1 L_lgoU
    s_cmp_ge_u32 s28, 16
    s_cbranch_scc1 L_lgoU
    s_sleep 1
    s_branch L_lwoU
L_lgoU:
    s_mov_b32 s28, 48234496
    s_mov_b32 s29, 0
L_pollU:
    buffer_load_dword v6, v5, s[16:19], s28 offen sc1
    s_add_u32 s29, s29, 1
    s_waitcnt vmcnt(0)
    v_cmp_eq_u32 vcc, 0, v6
    s_cmp_gt_u32 s29, 0x40000
    s_cbranch_scc1 L_pgotU
    s_cbranch_vccz L_pgotU
    s_sleep 4
    s_branch L_pollU
L_pgotU:
    s_add_u32 s28, s100, 4
    v_mov_b32 v4, s28
    v_mov_b32 v6, 1
    ds_write_b32 v4, v6
    s_branch L_pdoneU
L_pwU:
    s_add_u32 s28, s100, 4
    v_mov_b32 v4, s28
    s_mov_b32 s29, 0
L_lwUr:
    ds_read_b32 v6, v4
    s_add_u32 s29, s29, 1
    s_waitcnt lgkmcnt(0)
    v_readfirstlane_b32 s28, v6
    s_cmp_gt_u32 s29, 0x400000
    s_cbranch_scc1 L_lgUr
    s_cmp_ge_u32 s28, 1
    s_cbranch_scc1 L_lgUr
    s_sleep 1
    s_branch L_lwUr
L_lgUr:
L_pdoneU:
    s_mov_b32 s70, 0
    s_mov_b32 s71, 2
L_jU_lloop:
    s_add_u32 m0, s61, 0
    s_nop 0
    buffer_load_dwordx4 v8, s[16:19], s63 offen offset:0 sc1 lds
    buffer_load_dwordx4 v8, s[16:19], s63 offen offset:1024 sc1 lds
    buffer_load_dwordx4 v8, s[16:19], s63 offen offset:2048 sc1 lds
    buffer_load_dwordx4 v8, s[16:19], s63 offen offset:3072 sc1 lds
    s_add_u32 m0, s61, 4096
    s_nop 0
    buffer_load_dwordx4 v9, s[16:19], s63 offen offset:0 sc1 lds
    buffer_load_dwordx4 v9, s[16:19], s63 offen offset:1024 sc1 lds
    buffer_load_dwordx4 v9, s[16:19], s63 offen offset:2048 sc1 lds
    buffer_load_dwordx4 v9, s[16:19], s63 offen offset:3072 sc1 lds
    s_add_u32 m0, s62, 0
    s_nop 0
    buffer_load_dwordx4 v10, s[16:19], s64 offen offset:0 sc1 lds
    buffer_load_dwordx4 v10, s[16:19], s64 offen offset:1024 sc1 lds
    buffer_load_dwordx4 v10, s[16:19], s64 offen offset:2048 sc1 lds
    buffer_load_dwordx4 v10, s[16:19], s64 offen offset:3072 sc1 lds
    s_add_u32 m0, s62, 4096
    s_nop 0
    buffer_load_dwordx4 v11, s[16:19], s64 offen offset:0 sc1 lds
    buffer_load_dwordx4 v11, s[16:19], s64 offen offset:1024 sc1 lds
    buffer_load_dwordx4 v11, s[16:19], s64 offen offset:2048 sc1 lds
    buffer_load_dwordx4 v11, s[16:19], s64 offen offset:3072 sc1 lds
    s_add_u32 m0, s62, 8192
    s_nop 0
    buffer_load_dwordx4 v12, s[16:19], s64 offen offset:0 sc1 lds
    s_add_u32 s63, s63, 262144
    s_add_u32 s64, s64, 147456
    s_add_u32 s66, s66, 1
    s_cmp_eq_u32 s66, 4
    s_cselect_b32 s68, 4294862848, s69
    s_cselect_b32 s66, 0, s66
    s_add_u32 s61, s61, s68
    s_add_u32 s62, s62, s68
    s_add_u32 s67, s67, 1
    s_cmp_eq_u32 s67, 18
    s_cbranch_scc1 L_jU_ltail
    s_cmp_lt_u32 s67, s71
    s_cbranch_scc1 L_jU_lloop
    s_cmp_lg_u32 s70, 0
    s_cbranch_scc1 L_jU_r0
    s_waitcnt vmcnt(17)
    s_add_u32 s71, s71, 1
L_jU_r0:
    s_waitcnt vmcnt(34)
    s_barrier
    s_add_u32 s70, s70, 1
    s_add_u32 s71, s71, 1
    s_branch L_jU_lloop
L_jU_ltail:
    s_waitcnt vmcnt(34)
    s_barrier
    s_waitcnt vmcnt(17)
    s_barrier
    s_waitcnt vmcnt(0)
    s_barrier
    s_mov_b32 s24, s56
    s_mov_b32 s25, s57
    s_mov_b32 s26, 256
    s_mov_b32 s27, 0x20000
    v_mov_b32 v7, 128
    buffer_load_dword v3, v7, s[24:27], 0 offen sc1
    s_barrier
    s_waitcnt vmcnt(0)
    v_readfirstlane_b32 s101, v3
    s_branch L_next
L_jS:
    s_cmp_ge_u32 s3, 4
    s_cbranch_scc1 L_jS_ld
    s_and_b32 s60, s3, 1
    s_lshr_b32 s61, s3, 1
    v_lshlrev_b32 v8, 4, v0
    s_mul_i32 s28, s60, 8192
    v_add_u32 v8, s28, v8
    v_lshlrev_b32 v9, 4, v0
    s_mul_i32 s28, s61, 8192
    s_add_u32 s28, s28, 16384
    v_add_u32 v9, s28, v9
    v_mov_b32 v76, 0
    v_mov_b32 v77, 0
    v_mov_b32 v78, 0
    v_mov_b32 v79, 0
    v_mov_b32 v80, 0
    v_mov_b32 v81, 0
    v_mov_b32 v82, 0
    v_mov_b32 v83, 0
    v_mov_b32 v84, 0
    v_mov_b32 v85, 0
    v_mov_b32 v86, 0
    v_mov_b32 v87, 0
    v_mov_b32 v88, 0
    v_mov_b32 v89, 0
    v_mov_b32 v90, 0
    v_mov_b32 v91, 0
    v_mov_b32 v92, 0
    v_mov_b32 v93, 0
    v_mov_b32 v94, 0
    v_mov_b32 v95, 0
    v_mov_b32 v96, 0
    v_mov_b32 v97, 0
    v_mov_b32 v98, 0
    v_mov_b32 v99, 0
    v_mov_b32 v100, 0
    v_mov_b32 v101, 0
    v_mov_b32 v102, 0
    v_mov_b32 v103, 0
    v_mov_b32 v104, 0
    v_mov_b32 v105, 0
    v_mov_b32 v106, 0
    v_mov_b32 v107, 0
    v_mov_b32 v108, 0
    v_mov_b32 v109, 0
    v_mov_b32 v110, 0
    v_mov_b32 v111, 0
    v_mov_b32 v112, 0
    v_mov_b32 v113, 0
    v_mov_b32 v114, 0
    v_mov_b32 v115, 0
    v_mov_b32 v116, 0
    v_mov_b32 v117, 0
    v_mov_b32 v118, 0
    v_mov_b32 v119, 0
    v_mov_b32 v120, 0
    v_mov_b32 v121, 0
    v_mov_b32 v122, 0
    v_mov_b32 v123, 0
    v_mov_b32 v124, 0
    v_mov_b32 v125, 0
    v_mov_b32 v126, 0
    v_mov_b32 v127, 0
    v_mov_b32 v128, 0
    v_mov_b32 v129, 0
    v_mov_b32 v130, 0
    v_mov_b32 v131, 0
    v_mov_b32 v132, 0
    v_mov_b32 v133, 0
    v_mov_b32 v134, 0
    v_mov_b32 v135, 0
    v_mov_b32 v136, 0
    v_mov_b32 v137, 0
    v_mov_b32 v138, 0
    v_mov_b32 v139, 0
    s_mov_b32 s66, 0
    s_mov_b32 s67, 0
    s_mov_b32 s69, 32768
    s_waitcnt lgkmcnt(0)
    s_mov_b32 s16, s58
    s_mov_b32 s17, s59
    s_mov_b32 s18, 50331648
    s_mov_b32 s19, 0x20000
    s_barrier
    ds_read_b128 v[12:15], v8 offset:0
    ds_read_b128 v[28:31], v9 offset:0
    ds_read_b128 v[32:35], v9 offset:2048
    ds_read_b128 v[36:39], v9 offset:4096
    ds_read_b128 v[40:43], v9 offset:6144
    ds_read_b128 v[16:19], v8 offset:2048
    ds_read_b128 v[20:23], v8 offset:4096
    ds_read_b128 v[24:27], v8 offset:6144
L_jS_cloop:
    s_waitcnt lgkmcnt(7)
    s_waitcnt lgkmcnt(6)
    v_mfma_f32_16x16x32_bf16 v[76:79], v[12:15], v[28:31], v[76:79]
    ds_read_b128 v[44:47], v8 offset:1024
    s_waitcnt lgkmcnt(6)
    v_mfma_f32_16x16x32_bf16 v[80:83], v[12:15], v[32:35], v[80:83]
    ds_read_b128 v[60:63], v9 offset:1024
    s_waitcnt lgkmcnt(6)
    v_mfma_f32_16x16x32_bf16 v[84:87], v[12:15], v[36:39], v[84:87]
    ds_read_b128 v[64:67], v9 offset:3072
    s_waitcnt lgkmcnt(6)
    v_mfma_f32_16x16x32_bf16 v[88:91], v[12:15], v[40:43], v[88:91]
    ds_read_b128 v[68:71], v9 offset:5120
    s_waitcnt lgkmcnt(6)
    v_mfma_f32_16x16x32_bf16 v[104:107], v[16:19], v[40:43], v[104:107]
    ds_read_b128 v[72:75], v9 offset:7168
    v_mfma_f32_16x16x32_bf16 v[100:103], v[16:19], v[36:39], v[100:103]
    ds_read_b128 v[48:51], v8 offset:3072
    v_mfma_f32_16x16x32_bf16 v[96:99], v[16:19], v[32:35], v[96:99]
    ds_read_b128 v[52:55], v8 offset:5120
    v_mfma_f32_16x16x32_bf16 v[92:95], v[16:19], v[28:31], v[92:95]
    ds_read_b128 v[56:59], v8 offset:7168
    s_waitcnt lgkmcnt(9)
    v_mfma_f32_16x16x32_bf16 v[108:111], v[20:23], v[28:31], v[108:111]
    s_add_u32 s66, s66, 1
    s_cmp_eq_u32 s66, 4
    v_mfma_f32_16x16x32_bf16 v[112:115], v[20:23], v[32:35], v[112:115]
    s_cselect_b32 s68, 4294868992, s69
    v_mfma_f32_16x16x32_bf16 v[116:119], v[20:23], v[36:39], v[116:119]
    s_cselect_b32 s66, 0, s66
    v_mfma_f32_16x16x32_bf16 v[120:123], v[20:23], v[40:43], v[120:123]
    v_add_u32 v8, s68, v8
    s_waitcnt lgkmcnt(8)
    v_mfma_f32_16x16x32_bf16 v[136:139], v[24:27], v[40:43], v[136:139]
    v_add_u32 v9, s68, v9
    v_mfma_f32_16x16x32_bf16 v[132:135], v[24:27], v[36:39], v[132:135]
    s_add_u32 s67, s67, 1
    v_mfma_f32_16x16x32_bf16 v[128:131], v[24:27], v[32:35], v[128:131]
    s_cmp_eq_u32 s67, 18
    v_mfma_f32_16x16x32_bf16 v[124:127], v[24:27], v[28:31], v[124:127]
    s_cbranch_scc1 L_jS_ctail
    s_waitcnt lgkmcnt(0)
    s_barrier
    v_mfma_f32_16x16x32_bf16 v[76:79], v[44:47], v[60:63], v[76:79]
    ds_read_b128 v[12:15], v8 offset:0
    v_mfma_f32_16x16x32_bf16 v[80:83], v[44:47], v[64:67], v[80:83]
    ds_read_b128 v[28:31], v9 offset:0
    v_mfma_f32_16x16x32_bf16 v[84:87], v[44:47], v[68:71], v[84:87]
    ds_read_b128 v[32:35], v9 offset:2048
    v_mfma_f32_16x16x32_bf16 v[88:91], v[44:47], v[72:75], v[88:91]
    ds_read_b128 v[36:39], v9 offset:4096
    v_mfma_f32_16x16x32_bf16 v[104:107], v[48:51], v[72:75], v[104:107]
    ds_read_b128 v[40:43], v9 offset:6144
    v_mfma_f32_16x16x32_bf16 v[100:103], v[48:51], v[68:71], v[100:103]
    ds_read_b128 v[16:19], v8 offset:2048
    v_mfma_f32_16x16x32_bf16 v[96:99], v[48:51], v[64:67], v[96:99]
    ds_read_b128 v[20:23], v8 offset:4096
    v_mfma_f32_16x16x32_bf16 v[92:95], v[48:51], v[60:63], v[92:95]
    ds_read_b128 v[24:27], v8 offset:6144
    v_mfma_f32_16x16x32_bf16 v[108:111], v[52:55], v[60:63], v[108:111]
    v_mfma_f32_16x16x32_bf16 v[112:115], v[52:55], v[64:67], v[112:115]
    v_mfma_f32_16x16x32_bf16 v[116:119], v[52:55], v[68:71], v[116:119]
    v_mfma_f32_16x16x32_bf16 v[120:123], v[52:55], v[72:75], v[120:123]
    v_mfma_f32_16x16x32_bf16 v[136:139], v[56:59], v[72:75], v[136:139]
    v_mfma_f32_16x16x32_bf16 v[132:135], v[56:59], v[68:71], v[132:135]
    v_mfma_f32_16x16x32_bf16 v[128:131], v[56:59], v[64:67], v[128:131]
    v_mfma_f32_16x16x32_bf16 v[124:127], v[56:59], v[60:63], v[124:127]
    s_branch L_jS_cloop
L_jS_ctail:
    s_waitcnt lgkmcnt(0)
    s_barrier
    v_mfma_f32_16x16x32_bf16 v[76:79], v[44:47], v[60:63], v[76:79]
    v_mfma_f32_16x16x32_bf16 v[80:83], v[44:47], v[64:67], v[80:83]
    v_mfma_f32_16x16x32_bf16 v[84:87], v[44:47], v[68:71], v[84:87]
    v_mfma_f32_16x16x32_bf16 v[88:91], v[44:47], v[72:75], v[88:91]
    v_mfma_f32_16x16x32_bf16 v[104:107], v[48:51], v[72:75], v[104:107]
    v_mfma_f32_16x16x32_bf16 v[100:103], v[48:51], v[68:71], v[100:103]
    v_mfma_f32_16x16x32_bf16 v[96:99], v[48:51], v[64:67], v[96:99]
    v_mfma_f32_16x16x32_bf16 v[92:95], v[48:51], v[60:63], v[92:95]
    v_mfma_f32_16x16x32_bf16 v[108:111], v[52:55], v[60:63], v[108:111]
    v_mfma_f32_16x16x32_bf16 v[112:115], v[52:55], v[64:67], v[112:115]
    v_mfma_f32_16x16x32_bf16 v[116:119], v[52:55], v[68:71], v[116:119]
    v_mfma_f32_16x16x32_bf16 v[120:123], v[52:55], v[72:75], v[120:123]
    v_mfma_f32_16x16x32_bf16 v[136:139], v[56:59], v[72:75], v[136:139]
    v_mfma_f32_16x16x32_bf16 v[132:135], v[56:59], v[68:71], v[132:135]
    v_mfma_f32_16x16x32_bf16 v[128:131], v[56:59], v[64:67], v[128:131]
    v_mfma_f32_16x16x32_bf16 v[124:127], v[56:59], v[60:63], v[124:127]
    s_and_b32 s72, s5, 7
    s_mov_b32 s74, 1026431635
    s_mov_b32 s75, 1026431635
    s_lshl_b32 s28, s6, 3
    s_lshl_b32 s29, s61, 2
    s_add_u32 s28, s28, s29
    s_lshl_b32 s30, s28, 11
    s_lshl_b32 s29, s72, 1
    s_add_u32 s29, s29, s60
    s_lshl_b32 s29, s29, 18
    s_add_u32 s28, s30, s29
    s_add_u32 s28, s28, 28311552
    s_lshr_b32 s29, s29, 9
    s_add_u32 s30, s30, s29
    s_add_u32 s30, s30, 35717120
    v_cmp_eq_u32 s[32:33], 1, v2
    v_cmp_eq_u32 s[34:35], 2, v2
    v_cmp_eq_u32 s[76:77], 3, v2
    v_lshlrev_b32 v4, 4, v0
    v_mov_b32 v24, 0x3f803f80
    v_mov_b32 v25, 0x3f803f80
    v_mov_b32 v26, 0x3f803f80
    v_mov_b32 v27, 0x3f803f80
    v_max3_f32 v12, v76, v77, v78
    v_max3_f32 v12, v12, v79, v92
    v_max3_f32 v12, v12, v93, v94
    v_max3_f32 v12, v12, v95, v108
    v_max3_f32 v12, v12, v109, v110
    v_max3_f32 v12, v12, v111, v124
    v_max3_f32 v12, v12, v125, v126
    v_max_f32 v12, v12, v127
    v_max3_f32 v14, v80, v81, v82
    v_max3_f32 v14, v14, v83, v96
    v_max3_f32 v14, v14, v97, v98
    v_max3_f32 v14, v14, v99, v112
    v_max3_f32 v14, v14, v113, v114
    v_max3_f32 v14, v14, v115, v128
    v_max3_f32 v14, v14, v129, v130
    v_max_f32 v14, v14, v131
    v_max3_f32 v16, v84, v85, v86
    v_max3_f32 v16, v16, v87, v100
    v_max3_f32 v16, v16, v101, v102
    v_max3_f32 v16, v16, v103, v116
    v_max3_f32 v16, v16, v117, v118
    v_max3_f32 v16, v16, v119, v132
    v_max3_f32 v16, v16, v133, v134
    v_max_f32 v16, v16, v135
    v_max3_f32 v18, v88, v89, v90
    v_max3_f32 v18, v18, v91, v104
    v_max3_f32 v18, v18, v105, v106
    v_max3_f32 v18, v18, v107, v120
    v_max3_f32 v18, v18, v121, v122
    v_max3_f32 v18, v18, v123, v136
    v_max3_f32 v18, v18, v137, v138
    v_max_f32 v18, v18, v139
    v_mov_b32 v20, v12
    v_mov_b32 v21, v14
    v_mov_b32 v22, v16
    v_mov_b32 v23, v18
    v_permlane16_swap_b32 v12, v20
    v_permlane16_swap_b32 v14, v21
    v_permlane16_swap_b32 v16, v22
    v_permlane16_swap_b32 v18, v23
    v_max_f32 v12, v12, v20
    v_max_f32 v14, v14, v21
    v_max_f32 v16, v16, v22
    v_max_f32 v18, v18, v23
    v_mov_b32 v20, v12
    v_mov_b32 v21, v14
    v_mov_b32 v22, v16
    v_mov_b32 v23, v18
    v_permlane32_swap_b32 v12, v20
    v_permlane32_swap_b32 v14, v21
    v_permlane32_swap_b32 v16, v22
    v_permlane32_swap_b32 v18, v23
    v_max_f32 v12, v12, v20
    v_max_f32 v14, v14, v21
    v_max_f32 v16, v16, v22
    v_max_f32 v18, v18, v23
    v_mul_f32 v12, s74, v12
    v_mul_f32 v14, s74, v14
    v_mul_f32 v16, s74, v16
    v_mul_f32 v18, s74, v18
    v_ceil_f32 v12, v12
    v_ceil_f32 v14, v14
    v_ceil_f32 v16, v16
    v_ceil_f32 v18, v18
    v_pk_fma_f32 v[76:77], v[76:77], s[74:75], v[12:13] op_sel_hi:[1,1,0] neg_lo:[0,0,1] neg_hi:[0,0,1]
    v_pk_fma_f32 v[78:79], v[78:79], s[74:75], v[12:13] op_sel_hi:[1,1,0] neg_lo:[0,0,1] neg_hi:[0,0,1]
    v_pk_fma_f32 v[92:93], v[92:93], s[74:75], v[12:13] op_sel_hi:[1,1,0] neg_lo:[0,0,1] neg_hi:[0,0,1]
    v_pk_fma_f32 v[94:95], v[94:95], s[74:75], v[12:13] op_sel_hi:[1,1,0] neg_lo:[0,0,1] neg_hi:[0,0,1]
    v_pk_fma_f32 v[108:109], v[108:109], s[74:75], v[12:13] op_sel_hi:[1,1,0] neg_lo:[0,0,1] neg_hi:[0,0,1]
    v_pk_fma_f32 v[110:111], v[110:111], s[74:75], v[12:13] op_sel_hi:[1,1,0] neg_lo:[0,0,1] neg_hi:[0,0,1]
    v_pk_fma_f32 v[124:125], v[124:125], s[74:75], v[12:13] op_sel_hi:[1,1,0] neg_lo:[0,0,1] neg_hi:[0,0,1]
    v_pk_fma_f32 v[126:127], v[126:127], s[74:75], v[12:13] op_sel_hi:[1,1,0] neg_lo:[0,0,1] neg_hi:[0,0,1]
    v_exp_f32 v76, v76
    v_exp_f32 v77, v77
    v_exp_f32 v78, v78
    v_exp_f32 v79, v79
    v_exp_f32 v92, v92
    v_exp_f32 v93, v93
    v_exp_f32 v94, v94
    v_exp_f32 v95, v95
    v_exp_f32 v108, v108
    v_exp_f32 v109, v109
    v_exp_f32 v110, v110
    v_exp_f32 v111, v111
    v_exp_f32 v124, v124
    v_exp_f32 v125, v125
    v_exp_f32 v126, v126
    v_exp_f32 v127, v127
    v_cvt_pk_bf16_f32 v28, v76, v77
    v_cvt_pk_bf16_f32 v29, v78, v79
    v_cvt_pk_bf16_f32 v30, v92, v93
    v_cvt_pk_bf16_f32 v31, v94, v95
    v_cvt_pk_bf16_f32 v32, v108, v109
    v_cvt_pk_bf16_f32 v33, v110, v111
    v_cvt_pk_bf16_f32 v34, v124, v125
    v_cvt_pk_bf16_f32 v35, v126, v127
    buffer_store_dwordx4 v[28:31], v4, s[16:19], s28 offen offset:0 sc1
    buffer_store_dwordx4 v[32:35], v4, s[16:19], s28 offen offset:1024 sc1
    v_mfma_f32_16x16x32_bf16 v[60:63], v[24:27], v[28:31], 0
    v_mfma_f32_16x16x32_bf16 v[60:63], v[24:27], v[32:35], v[60:63]
    s_add_u32 s28, s28, 2048
    v_pk_fma_f32 v[80:81], v[80:81], s[74:75], v[14:15] op_sel_hi:[1,1,0] neg_lo:[0,0,1] neg_hi:[0,0,1]
    v_pk_fma_f32 v[82:83], v[82:83], s[74:75], v[14:15] op_sel_hi:[1,1,0] neg_lo:[0,0,1] neg_hi:[0,0,1]
    v_pk_fma_f32 v[96:97], v[96:97], s[74:75], v[14:15] op_sel_hi:[1,1,0] neg_lo:[0,0,1] neg_hi:[0,0,1]
    v_pk_fma_f32 v[98:99], v[98:99], s[74:75], v[14:15] op_sel_hi:[1,1,0] neg_lo:[0,0,1] neg_hi:[0,0,1]
    v_pk_fma_f32 v[112:113], v[112:113], s[74:75], v[14:15] op_sel_hi:[1,1,0] neg_lo:[0,0,1] neg_hi:[0,0,1]
    v_pk_fma_f32 v[114:115], v[114:115], s[74:75], v[14:15] op_sel_hi:[1,1,0] neg_lo:[0,0,1] neg_hi:[0,0,1]
    v_pk_fma_f32 v[128:129], v[128:129], s[74:75], v[14:15] op_sel_hi:[1,1,0] neg_lo:[0,0,1] neg_hi:[0,0,1]
    v_pk_fma_f32 v[130:131], v[130:131], s[74:75], v[14:15] op_sel_hi:[1,1,0] neg_lo:[0,0,1] neg_hi:[0,0,1]
    v_exp_f32 v80, v80
    v_exp_f32 v81, v81
    v_exp_f32 v82, v82
    v_exp_f32 v83, v83
    v_exp_f32 v96, v96
    v_exp_f32 v97, v97
    v_exp_f32 v98, v98
    v_exp_f32 v99, v99
    v_exp_f32 v112, v112
    v_exp_f32 v113, v113
    v_exp_f32 v114, v114
    v_exp_f32 v115, v115
    v_exp_f32 v128, v128
    v_exp_f32 v129, v129
    v_exp_f32 v130, v130
    v_exp_f32 v131, v131
    v_cvt_pk_bf16_f32 v36, v80, v81
    v_cvt_pk_bf16_f32 v37, v82, v83
    v_cvt_pk_bf16_f32 v38, v96, v97
    v_cvt_pk_bf16_f32 v39, v98, v99
    v_cvt_pk_bf16_f32 v40, v112, v113
    v_cvt_pk_bf16_f32 v41, v114, v115
    v_cvt_pk_bf16_f32 v42, v128, v129
    v_cvt_pk_bf16_f32 v43, v130, v131
    buffer_store_dwordx4 v[36:39], v4, s[16:19], s28 offen offset:0 sc1
    buffer_store_dwordx4 v[40:43], v4, s[16:19], s28 offen offset:1024 sc1
    v_mfma_f32_16x16x32_bf16 v[64:67], v[24:27], v[36:39], 0
    v_mfma_f32_16x16x32_bf16 v[64:67], v[24:27], v[40:43], v[64:67]
    s_add_u32 s28, s28, 2048
    v_pk_fma_f32 v[84:85], v[84:85], s[74:75], v[16:17] op_sel_hi:[1,1,0] neg_lo:[0,0,1] neg_hi:[0,0,1]
    v_pk_fma_f32 v[86:87], v[86:87], s[74:75], v[16:17] op_sel_hi:[1,1,0] neg_lo:[0,0,1] neg_hi:[0,0,1]
    v_pk_fma_f32 v[100:101], v[100:101], s[74:75], v[16:17] op_sel_hi:[1,1,0] neg_lo:[0,0,1] neg_hi:[0,0,1]
    v_pk_fma_f32 v[102:103], v[102:103], s[74:75], v[16:17] op_sel_hi:[1,1,0] neg_lo:[0,0,1] neg_hi:[0,0,1]
    v_pk_fma_f32 v[116:117], v[116:117], s[74:75], v[16:17] op_sel_hi:[1,1,0] neg_lo:[0,0,1] neg_hi:[0,0,1]
    v_pk_fma_f32 v[118:119], v[118:119], s[74:75], v[16:17] op_sel_hi:[1,1,0] neg_lo:[0,0,1] neg_hi:[0,0,1]
    v_pk_fma_f32 v[132:133], v[132:133], s[74:75], v[16:17] op_sel_hi:[1,1,0] neg_lo:[0,0,1] neg_hi:[0,0,1]
    v_pk_fma_f32 v[134:135], v[134:135], s[74:75], v[16:17] op_sel_hi:[1,1,0] neg_lo:[0,0,1] neg_hi:[0,0,1]
    v_exp_f32 v84, v84
    v_exp_f32 v85, v85
    v_exp_f32 v86, v86
    v_exp_f32 v87, v87
    v_exp_f32 v100, v100
    v_exp_f32 v101, v101
    v_exp_f32 v102, v102
    v_exp_f32 v103, v103
    v_exp_f32 v116, v116
    v_exp_f32 v117, v117
    v_exp_f32 v118, v118
    v_exp_f32 v119, v119
    v_exp_f32 v132, v132
    v_exp_f32 v133, v133
    v_exp_f32 v134, v134
    v_exp_f32 v135, v135
    v_cvt_pk_bf16_f32 v44, v84, v85
    v_cvt_pk_bf16_f32 v45, v86, v87
    v_cvt_pk_bf16_f32 v46, v100, v101
    v_cvt_pk_bf16_f32 v47, v102, v103
    v_cvt_pk_bf16_f32 v48, v116, v117
    v_cvt_pk_bf16_f32 v49, v118, v119
    v_cvt_pk_bf16_f32 v50, v132, v133
    v_cvt_pk_bf16_f32 v51, v134, v135
    buffer_store_dwordx4 v[44:47], v4, s[16:19], s28 offen offset:0 sc1
    buffer_store_dwordx4 v[48:51], v4, s[16:19], s28 offen offset:1024 sc1
    v_mfma_f32_16x16x32_bf16 v[68:71], v[24:27], v[44:47], 0
    v_mfma_f32_16x16x32_bf16 v[68:71], v[24:27], v[48:51], v[68:71]
    s_add_u32 s28, s28, 2048
    v_pk_fma_f32 v[88:89], v[88:89], s[74:75], v[18:19] op_sel_hi:[1,1,0] neg_lo:[0,0,1] neg_hi:[0,0,1]
    v_pk_fma_f32 v[90:91], v[90:91], s[74:75], v[18:19] op_sel_hi:[1,1,0] neg_lo:[0,0,1] neg_hi:[0,0,1]
    v_pk_fma_f32 v[104:105], v[104:105], s[74:75], v[18:19] op_sel_hi:[1,1,0] neg_lo:[0,0,1] neg_hi:[0,0,1]
    v_pk_fma_f32 v[106:107], v[106:107], s[74:75], v[18:19] op_sel_hi:[1,1,0] neg_lo:[0,0,1] neg_hi:[0,0,1]
    v_pk_fma_f32 v[120:121], v[120:121], s[74:75], v[18:19] op_sel_hi:[1,1,0] neg_lo:[0,0,1] neg_hi:[0,0,1]
    v_pk_fma_f32 v[122:123], v[122:123], s[74:75], v[18:19] op_sel_hi:[1,1,0] neg_lo:[0,0,1] neg_hi:[0,0,1]
    v_pk_fma_f32 v[136:137], v[136:137], s[74:75], v[18:19] op_sel_hi:[1,1,0] neg_lo:[0,0,1] neg_hi:[0,0,1]
    v_pk_fma_f32 v[138:139], v[138:139], s[74:75], v[18:19] op_sel_hi:[1,1,0] neg_lo:[0,0,1] neg_hi:[0,0,1]
    v_exp_f32 v88, v88
    v_exp_f32 v89, v89
    v_exp_f32 v90, v90
    v_exp_f32 v91, v91
    v_exp_f32 v104, v104
    v_exp_f32 v105, v105
    v_exp_f32 v106, v106
    v_exp_f32 v107, v107
    v_exp_f32 v120, v120
    v_exp_f32 v121, v121
    v_exp_f32 v122, v122
    v_exp_f32 v123, v123
    v_exp_f32 v136, v136
    v_exp_f32 v137, v137
    v_exp_f32 v138, v138
    v_exp_f32 v139, v139
    v_cvt_pk_bf16_f32 v52, v88, v89
    v_cvt_pk_bf16_f32 v53, v90, v91
    v_cvt_pk_bf16_f32 v54, v104, v105
    v_cvt_pk_bf16_f32 v55, v106, v107
    v_cvt_pk_bf16_f32 v56, v120, v121
    v_cvt_pk_bf16_f32 v57, v122, v123
    v_cvt_pk_bf16_f32 v58, v136, v137
    v_cvt_pk_bf16_f32 v59, v138, v139
    buffer_store_dwordx4 v[52:55], v4, s[16:19], s28 offen offset:0 sc1
    buffer_store_dwordx4 v[56:59], v4, s[16:19], s28 offen offset:1024 sc1
    v_mfma_f32_16x16x32_bf16 v[72:75], v[24:27], v[52:55], 0
    v_mfma_f32_16x16x32_bf16 v[72:75], v[24:27], v[56:59], v[72:75]
    v_lshlrev_b32 v5, 3, v0
    v_mov_b32 v20, v12
    v_cndmask_b32 v20, v20, v14, s[32:33]
    v_cndmask_b32 v20, v20, v16, s[34:35]
    v_cndmask_b32 v20, v20, v18, s[76:77]
    v_mov_b32 v21, v60
    v_cndmask_b32 v21, v21, v64, s[32:33]
    v_cndmask_b32 v21, v21, v68, s[34:35]
    s_nop 0
    v_cndmask_b32 v21, v21, v72, s[76:77]
    buffer_store_dwordx2 v[20:21], v5, s[16:19], s30 offen sc1
    s_lshl_b32 s30, s6, 7
    s_and_b32 s31, s5, 7
    s_lshl_b32 s31, s31, 2
    s_add_u32 s30, s30, s31
    s_add_u32 s30, s30, 19968
    s_mov_b64 exec, 1
    s_lshl_b32 s30, s30, 0
    s_add_u32 s30, s30, 48234496
    v_mov_b32 v5, 2
    s_add_u32 s28, s100, 8
    v_mov_b32 v4, s28
    s_waitcnt vmcnt(0)
    v_mov_b32 v7, 0
    ds_add_rtn_u32 v6, v4, v5
    s_waitcnt lgkmcnt(0)
    v_readfirstlane_b32 s29, v6
    s_cmp_lg_u32 s29, 6
    s_cbranch_scc1 L_sejS
    buffer_store_dword v5, v7, s[16:19], s30 offen sc1
    v_mov_b32 v6, 16
    ds_write_b32 v4, v6
L_sejS:
    s_mov_b64 exec, -1
    s_branch L_next
L_jS_ld:
    s_sub_u32 s60, s3, 4
    s_mul_i32 s28, s5, 16384
    s_mul_i32 s29, s60, 8192
    s_add_u32 s28, s28, s29
    s_add_u32 s28, s28, 5242880
    v_lshl_add_u32 v8, v0, 4, s28
    s_mov_b32 s61, s29
    v_add_u32 v9, 4096, v8
    s_mul_i32 s28, s6, 16384
    s_mul_i32 s29, s60, 8192
    s_add_u32 s28, s28, s29
    s_add_u32 s28, s28, 17825792
    v_lshl_add_u32 v10, v0, 4, s28
    s_add_u32 s62, s29, 16384
    v_add_u32 v11, 4096, v10
    s_mov_b32 s63, 0
    s_mov_b32 s66, 0
    s_mov_b32 s67, 0
    s_mov_b32 s69, 32768
    s_waitcnt lgkmcnt(0)
    s_mov_b32 s16, s58
    s_mov_b32 s17, s59
    s_mov_b32 s18, 50331648
    s_mov_b32 s19, 0x20000
    s_add_u32 s28, s100, 0
    v_mov_b32 v4, s28
    s_mov_b32 s29, 0
L_lwoS:
    ds_read_b32 v6, v4
    s_add_u32 s29, s29, 1
    s_waitcnt lgkmcnt(0)
    v_readfirstlane_b32 s28, v6
    s_cmp_gt_u32 s29, 0x400000
    s_cbranch_scc1 L_lgoS
    s_cmp_ge_u32 s28, 16
    s_cbranch_scc1 L_lgoS
    s_sleep 1
    s_branch L_lwoS
L_lgoS:
    s_cmp_lg_u32 s3, 4
    s_cbranch_scc1 L_pwS
    v_min_u32 v5, 8, v1
    v_lshlrev_b32 v5, 2, v5
    s_lshl_b32 s28, s6, 7
    s_add_u32 s28, s28, 16384
    v_add_u32 v5, s28, v5
    v_and_b32 v6, 3, v0
    v_cmp_lt_u32 vcc, 31, v0
    s_lshl_b32 s28, s5, 7
    s_add_u32 s28, s28, 25728
    v_lshl_add_u32 v6, v6, 2, s28
    v_cndmask_b32 v5, v5, v6, vcc
    v_lshlrev_b32 v5, 0, v5
    s_mov_b32 s28, 48234496
    s_mov_b32 s29, 0
L_pollS:
    buffer_load_dword v6, v5, s[16:19], s28 offen sc1
    s_add_u32 s29, s29, 1
    s_waitcnt vmcnt(0)
    v_cmp_eq_u32 vcc, 0, v6
    s_cmp_gt_u32 s29, 0x40000
    s_cbranch_scc1 L_pgotS
    s_cbranch_vccz L_pgotS
    s_sleep 4
    s_branch L_pollS
L_pgotS:
    s_add_u32 s28, s100, 4
    v_mov_b32 v4, s28
    v_mov_b32 v6, 1
    ds_write_b32 v4, v6
    s_branch L_pdoneS
L_pwS:
    s_add_u32 s28, s100, 4
    v_mov_b32 v4, s28
    s_mov_b32 s29, 0
L_lwSr:
    ds_read_b32 v6, v4
    s_add_u32 s29, s29, 1
    s_waitcnt lgkmcnt(0)
    v_readfirstlane_b32 s28, v6
    s_cmp_gt_u32 s29, 0x400000
    s_cbranch_scc1 L_lgSr
    s_cmp_ge_u32 s28, 1
    s_cbranch_scc1 L_lgSr
    s_sleep 1
    s_branch L_lwSr
L_lgSr:
L_pdoneS:
    s_mov_b32 s70, 0
    s_mov_b32 s71, 2
L_jS_lloop:
    s_add_u32 m0, s61, 0
    s_nop 0
    buffer_load_dwordx4 v8, s[16:19], s63 offen offset:0 sc1 lds
    buffer_load_dwordx4 v8, s[16:19], s63 offen offset:1024 sc1 lds
    buffer_load_dwordx4 v8, s[16:19], s63 offen offset:2048 sc1 lds
    buffer_load_dwordx4 v8, s[16:19], s63 offen offset:3072 sc1 lds
    s_add_u32 m0, s61, 4096
    s_nop 0
    buffer_load_dwordx4 v9, s[16:19], s63 offen offset:0 sc1 lds
    buffer_load_dwordx4 v9, s[16:19], s63 offen offset:1024 sc1 lds
    buffer_load_dwordx4 v9, s[16:19], s63 offen offset:2048 sc1 lds
    buffer_load_dwordx4 v9, s[16:19], s63 offen offset:3072 sc1 lds
    s_add_u32 m0, s62, 0
    s_nop 0
    buffer_load_dwordx4 v10, s[16:19], s63 offen offset:0 sc1 lds
    buffer_load_dwordx4 v10, s[16:19], s63 offen offset:1024 sc1 lds
    buffer_load_dwordx4 v10, s[16:19], s63 offen offset:2048 sc1 lds
    buffer_load_dwordx4 v10, s[16:19], s63 offen offset:3072 sc1 lds
    s_add_u32 m0, s62, 4096
    s_nop 0
    buffer_load_dwordx4 v11, s[16:19], s63 offen offset:0 sc1 lds
    buffer_load_dwordx4 v11, s[16:19], s63 offen offset:1024 sc1 lds
    buffer_load_dwordx4 v11, s[16:19], s63 offen offset:2048 sc1 lds
    buffer_load_dwordx4 v11, s[16:19], s63 offen offset:3072 sc1 lds
    s_add_u32 s63, s63, 262144
    s_add_u32 s66, s66, 1
    s_cmp_eq_u32 s66, 4
    s_cselect_b32 s68, 4294868992, s69
    s_cselect_b32 s66, 0, s66
    s_add_u32 s61, s61, s68
    s_add_u32 s62, s62, s68
    s_add_u32 s67, s67, 1
    s_cmp_eq_u32 s67, 18
    s_cbranch_scc1 L_jS_ltail
    s_cmp_lt_u32 s67, s71
    s_cbranch_scc1 L_jS_lloop
    s_cmp_lg_u32 s70, 0
    s_cbranch_scc1 L_jS_r0
    s_waitcnt vmcnt(16)
    s_add_u32 s71, s71, 1
L_jS_r0:
    s_waitcnt vmcnt(32)
    s_barrier
    s_add_u32 s70, s70, 1
    s_add_u32 s71, s71, 1
    s_branch L_jS_lloop
L_jS_ltail:
    s_waitcnt vmcnt(32)
    s_barrier
    s_waitcnt vmcnt(16)
    s_barrier
    s_waitcnt vmcnt(0)
    s_barrier
    s_mov_b32 s24, s56
    s_mov_b32 s25, s57
    s_mov_b32 s26, 256
    s_mov_b32 s27, 0x20000
    v_mov_b32 v7, 128
    buffer_load_dword v3, v7, s[24:27], 0 offen sc1
    s_barrier
    s_waitcnt vmcnt(0)
    v_readfirstlane_b32 s101, v3
    s_branch L_next
L_jW:
    s_cmp_ge_u32 s3, 4
    s_cbranch_scc1 L_jW_ld
    v_lshrrev_b32 v4, 1, v1
    v_lshlrev_b32 v5, 7, v1
    s_mul_i32 s28, s3, 4096
    v_add_u32 v5, s28, v5
    v_lshrrev_b32 v6, 1, v2
    v_xor_b32 v4, v4, v6
    v_lshl_add_u32 v5, v4, 4, v5
    v_and_b32 v6, 1, v2
    v_lshl_add_u32 v8, v6, 3, v5
    v_xor_b32 v9, 32, v8
    v_xor_b32 v10, 64, v8
    v_xor_b32 v11, 96, v8
    v_lshlrev_b32 v12, 4, v0
    v_add_u32 v12, 16384, v12
    v_mov_b32 v72, 0
    v_mov_b32 v73, 0
    v_mov_b32 v74, 0
    v_mov_b32 v75, 0
    v_mov_b32 v76, 0
    v_mov_b32 v77, 0
    v_mov_b32 v78, 0
    v_mov_b32 v79, 0
    v_mov_b32 v80, 0
    v_mov_b32 v81, 0
    v_mov_b32 v82, 0
    v_mov_b32 v83, 0
    v_mov_b32 v84, 0
    v_mov_b32 v85, 0
    v_mov_b32 v86, 0
    v_mov_b32 v87, 0
    v_mov_b32 v88, 0
    v_mov_b32 v89, 0
    v_mov_b32 v90, 0
    v_mov_b32 v91, 0
    v_mov_b32 v92, 0
    v_mov_b32 v93, 0
    v_mov_b32 v94, 0
    v_mov_b32 v95, 0
    v_mov_b32 v96, 0
    v_mov_b32 v97, 0
    v_mov_b32 v98, 0
    v_mov_b32 v99, 0
    v_mov_b32 v100, 0
    v_mov_b32 v101, 0
    v_mov_b32 v102, 0
    v_mov_b32 v103, 0
    v_mov_b32 v104, 0
    v_mov_b32 v105, 0
    v_mov_b32 v106, 0
    v_mov_b32 v107, 0
    v_mov_b32 v108, 0
    v_mov_b32 v109, 0
    v_mov_b32 v110, 0
    v_mov_b32 v111, 0
    s_mov_b32 s66, 0
    s_mov_b32 s67, 0
    s_mov_b32 s69, 26624
    s_waitcnt lgkmcnt(0)
    s_mov_b32 s16, s58
    s_mov_b32 s17, s59
    s_mov_b32 s18, 50331648
    s_mov_b32 s19, 0x20000
    s_barrier
    ds_read_b64 v[16:17], v8 offset:0
    ds_read_b64 v[18:19], v9 offset:0
    ds_read_b128 v[24:27], v12 offset:0
    ds_read_b64 v[20:21], v8 offset:2048
    ds_read_b64 v[22:23], v9 offset:2048
    ds_read_b128 v[28:31], v12 offset:2048
    ds_read_b128 v[32:35], v12 offset:4096
    ds_read_b128 v[36:39], v12 offset:6144
    ds_read_b128 v[40:43], v12 offset:8192
L_jW_cloop:
    s_waitcnt lgkmcnt(7)
    s_waitcnt lgkmcnt(6)
    v_mfma_f32_16x16x32_bf16 v[72:75], v[16:19], v[24:27], v[72:75]
    ds_read_b64 v[44:45], v10 offset:0
    ds_read_b64 v[46:47], v11 offset:0
    s_waitcnt lgkmcnt(6)
    v_mfma_f32_16x16x32_bf16 v[92:95], v[20:23], v[24:27], v[92:95]
    ds_read_b128 v[52:55], v12 offset:1024
    ds_read_b64 v[48:49], v10 offset:2048
    s_waitcnt lgkmcnt(7)
    v_mfma_f32_16x16x32_bf16 v[96:99], v[20:23], v[28:31], v[96:99]
    ds_read_b64 v[50:51], v11 offset:2048
    ds_read_b128 v[56:59], v12 offset:3072
    v_mfma_f32_16x16x32_bf16 v[76:79], v[16:19], v[28:31], v[76:79]
    ds_read_b128 v[60:63], v12 offset:5120
    ds_read_b128 v[64:67], v12 offset:7168
    s_waitcnt lgkmcnt(10)
    v_mfma_f32_16x16x32_bf16 v[80:83], v[16:19], v[32:35], v[80:83]
    ds_read_b128 v[68:71], v12 offset:9216
    v_mfma_f32_16x16x32_bf16 v[100:103], v[20:23], v[32:35], v[100:103]
    s_add_u32 s66, s66, 1
    s_cmp_eq_u32 s66, 5
    s_cselect_b32 s68, 4294860800, s69
    s_waitcnt lgkmcnt(10)
    v_mfma_f32_16x16x32_bf16 v[104:107], v[20:23], v[36:39], v[104:107]
    s_cselect_b32 s66, 0, s66
    v_add_u32 v8, s68, v8
    v_add_u32 v9, s68, v9
    v_mfma_f32_16x16x32_bf16 v[84:87], v[16:19], v[36:39], v[84:87]
    v_add_u32 v10, s68, v10
    v_add_u32 v11, s68, v11
    v_add_u32 v12, s68, v12
    s_waitcnt lgkmcnt(9)
    v_mfma_f32_16x16x32_bf16 v[88:91], v[16:19], v[40:43], v[88:91]
    s_add_u32 s67, s67, 1
    s_cmp_eq_u32 s67, 18
    v_mfma_f32_16x16x32_bf16 v[108:111], v[20:23], v[40:43], v[108:111]
    s_cbranch_scc1 L_jW_ctail
    s_waitcnt lgkmcnt(0)
    s_barrier
    v_mfma_f32_16x16x32_bf16 v[72:75], v[44:47], v[52:55], v[72:75]
    ds_read_b64 v[16:17], v8 offset:0
    ds_read_b64 v[18:19], v9 offset:0
    v_mfma_f32_16x16x32_bf16 v[92:95], v[48:51], v[52:55], v[92:95]
    ds_read_b128 v[24:27], v12 offset:0
    ds_read_b64 v[20:21], v8 offset:2048
    v_mfma_f32_16x16x32_bf16 v[96:99], v[48:51], v[56:59], v[96:99]
    ds_read_b64 v[22:23], v9 offset:2048
    ds_read_b128 v[28:31], v12 offset:2048
    v_mfma_f32_16x16x32_bf16 v[76:79], v[44:47], v[56:59], v[76:79]
    ds_read_b128 v[32:35], v12 offset:4096
    ds_read_b128 v[36:39], v12 offset:6144
    v_mfma_f32_16x16x32_bf16 v[80:83], v[44:47], v[60:63], v[80:83]
    ds_read_b128 v[40:43], v12 offset:8192
    v_mfma_f32_16x16x32_bf16 v[100:103], v[48:51], v[60:63], v[100:103]
    v_mfma_f32_16x16x32_bf16 v[104:107], v[48:51], v[64:67], v[104:107]
    v_mfma_f32_16x16x32_bf16 v[84:87], v[44:47], v[64:67], v[84:87]
    v_mfma_f32_16x16x32_bf16 v[88:91], v[44:47], v[68:71], v[88:91]
    v_mfma_f32_16x16x32_bf16 v[108:111], v[48:51], v[68:71], v[108:111]
    s_branch L_jW_cloop
L_jW_ctail:
    s_waitcnt lgkmcnt(0)
    s_barrier
    v_mfma_f32_16x16x32_bf16 v[72:75], v[44:47], v[52:55], v[72:75]
    v_mfma_f32_16x16x32_bf16 v[92:95], v[48:51], v[52:55], v[92:95]
    v_mfma_f32_16x16x32_bf16 v[96:99], v[48:51], v[56:59], v[96:99]
    v_mfma_f32_16x16x32_bf16 v[76:79], v[44:47], v[56:59], v[76:79]
    v_mfma_f32_16x16x32_bf16 v[80:83], v[44:47], v[60:63], v[80:83]
    v_mfma_f32_16x16x32_bf16 v[100:103], v[48:51], v[60:63], v[100:103]
    v_mfma_f32_16x16x32_bf16 v[104:107], v[48:51], v[64:67], v[104:107]
    v_mfma_f32_16x16x32_bf16 v[84:87], v[44:47], v[64:67], v[84:87]
    v_mfma_f32_16x16x32_bf16 v[88:91], v[44:47], v[68:71], v[88:91]
    v_mfma_f32_16x16x32_bf16 v[108:111], v[48:51], v[68:71], v[108:111]
    s_mul_i32 s30, s6, 5
    s_mul_i32 s31, s5, 8
    s_mov_b32 s28, s30
    s_mul_i32 s28, s28, 72
    s_add_u32 s28, s28, s31
    s_mul_i32 s29, s3, 2
    s_add_u32 s28, s28, s29
    s_lshl_b32 s28, s28, 9
    s_add_u32 s28, s28, 33554432
    v_lshlrev_b32 v4, 3, v0
    s_nop 4
    v_cvt_pk_bf16_f32 v72, v72, v73
    v_cvt_pk_bf16_f32 v73, v74, v75
    buffer_store_dwordx2 v[72:73], v4, s[16:19], s28 offen offset:0 sc1
    v_cvt_pk_bf16_f32 v92, v92, v93
    v_cvt_pk_bf16_f32 v93, v94, v95
    buffer_store_dwordx2 v[92:93], v4, s[16:19], s28 offen offset:512 sc1
    s_add_u32 s28, s28, 36864
    v_cvt_pk_bf16_f32 v76, v76, v77
    v_cvt_pk_bf16_f32 v77, v78, v79
    buffer_store_dwordx2 v[76:77], v4, s[16:19], s28 offen offset:0 sc1
    v_cvt_pk_bf16_f32 v96, v96, v97
    v_cvt_pk_bf16_f32 v97, v98, v99
    buffer_store_dwordx2 v[96:97], v4, s[16:19], s28 offen offset:512 sc1
    s_add_u32 s28, s28, 36864
    v_cvt_pk_bf16_f32 v80, v80, v81
    v_cvt_pk_bf16_f32 v81, v82, v83
    buffer_store_dwordx2 v[80:81], v4, s[16:19], s28 offen offset:0 sc1
    v_cvt_pk_bf16_f32 v100, v100, v101
    v_cvt_pk_bf16_f32 v101, v102, v103
    buffer_store_dwordx2 v[100:101], v4, s[16:19], s28 offen offset:512 sc1
    s_add_u32 s28, s28, 36864
    v_cvt_pk_bf16_f32 v84, v84, v85
    v_cvt_pk_bf16_f32 v85, v86, v87
    buffer_store_dwordx2 v[84:85], v4, s[16:19], s28 offen offset:0 sc1
    v_cvt_pk_bf16_f32 v104, v104, v105
    v_cvt_pk_bf16_f32 v105, v106, v107
    buffer_store_dwordx2 v[104:105], v4, s[16:19], s28 offen offset:512 sc1
    s_add_u32 s28, s28, 36864
    v_cvt_pk_bf16_f32 v88, v88, v89
    v_cvt_pk_bf16_f32 v89, v90, v91
    buffer_store_dwordx2 v[88:89], v4, s[16:19], s28 offen offset:0 sc1
    v_cvt_pk_bf16_f32 v108, v108, v109
    v_cvt_pk_bf16_f32 v109, v110, v111
    buffer_store_dwordx2 v[108:109], v4, s[16:19], s28 offen offset:512 sc1
    v_mov_b32 v16, 0x3f803f80
    v_mov_b32 v17, 0x3f803f80
    s_mul_i32 s28, s3, 320
    s_add_u32 s28, s28, 159808
    v_lshl_add_u32 v5, v1, 2, s28
    v_mfma_f32_16x16x16_bf16 v[20:23], v[16:17], v[72:73], 0
    v_mfma_f32_16x16x16_bf16 v[24:27], v[16:17], v[76:77], 0
    v_mfma_f32_16x16x16_bf16 v[28:31], v[16:17], v[80:81], 0
    v_mfma_f32_16x16x16_bf16 v[32:35], v[16:17], v[84:85], 0
    v_mfma_f32_16x16x16_bf16 v[36:39], v[16:17], v[88:89], 0
    v_mfma_f32_16x16x16_bf16 v[20:23], v[16:17], v[92:93], v[20:23]
    v_mfma_f32_16x16x16_bf16 v[24:27], v[16:17], v[96:97], v[24:27]
    v_mfma_f32_16x16x16_bf16 v[28:31], v[16:17], v[100:101], v[28:31]
    v_mfma_f32_16x16x16_bf16 v[32:35], v[16:17], v[104:105], v[32:35]
    v_mfma_f32_16x16x16_bf16 v[36:39], v[16:17], v[108:109], v[36:39]
    s_nop 7
    ds_write_b32 v5, v20 offset:0
    ds_write_b32 v5, v24 offset:64
    ds_write_b32 v5, v28 offset:128
    ds_write_b32 v5, v32 offset:192
    ds_write_b32 v5, v36 offset:256
    s_waitcnt lgkmcnt(0)
    s_lshl_b32 s30, s6, 8
    s_lshl_b32 s31, s5, 2
    s_add_u32 s30, s30, s31
    s_add_u32 s30, s30, 28032
    s_mov_b64 exec, 1
    s_lshl_b32 s30, s30, 0
    s_add_u32 s30, s30, 48234496
    v_mov_b32 v5, 2
    s_add_u32 s28, s100, 8
    v_mov_b32 v4, s28
    s_waitcnt vmcnt(0)
    v_mov_b32 v7, 0
    ds_add_rtn_u32 v6, v4, v5
    s_waitcnt lgkmcnt(0)
    v_readfirstlane_b32 s29, v6
    s_cmp_lg_u32 s29, 6
    s_cbranch_scc1 L_sejW
    s_mov_b64 exec, 0xfffff
    v_lshlrev_b32 v6, 4, v0
    v_add_u32 v6, 159808, v6
    ds_read_b128 v[16:19], v6 offset:0
    ds_read_b128 v[20:23], v6 offset:320
    ds_read_b128 v[24:27], v6 offset:640
    ds_read_b128 v[28:31], v6 offset:960
    v_lshlrev_b32 v6, 9, v0
    s_mul_i32 s28, s6, 10240
    s_lshl_b32 s29, s5, 4
    s_add_u32 s28, s28, s29
    s_add_u32 s28, s28, 36175872
    s_waitcnt lgkmcnt(0)
    v_pk_add_f32 v[16:17], v[16:17], v[20:21]
    v_pk_add_f32 v[18:19], v[18:19], v[22:23]
    v_pk_add_f32 v[16:17], v[16:17], v[24:25]
    v_pk_add_f32 v[18:19], v[18:19], v[26:27]
    v_pk_add_f32 v[16:17], v[16:17], v[28:29]
    v_pk_add_f32 v[18:19], v[18:19], v[30:31]
    buffer_store_dwordx4 v[16:19], v6, s[16:19], s28 offen sc1
    s_mov_b64 exec, 1
    s_waitcnt vmcnt(0)
    buffer_store_dword v5, v7, s[16:19], s30 offen sc1
    v_mov_b32 v6, 16
    ds_write_b32 v4, v6
L_sejW:
    s_mov_b64 exec, -1
    s_branch L_next
L_jW_ld:
    s_sub_u32 s60, s3, 4
    v_lshrrev_b32 v4, 3, v0
    v_and_b32 v5, 7, v0
    s_and_b32 s29, s60, 1
    s_lshl_b32 s29, s29, 2
    v_add_u32 v6, s29, v2
    v_xor_b32 v5, v5, v6
    v_mul_u32_u24 v4, 2304, v4
    v_lshl_add_u32 v4, v5, 4, v4
    s_mul_i32 s28, s5, 294912
    s_mul_i32 s29, s60, 18432
    s_add_u32 s28, s28, s29
    v_add_u32 v8, s28, v4
    s_lshl_b32 s61, s60, 10
    v_add_u32 v9, 34816, v8
    v_add_u32 v10, 73728, v8
    v_add_u32 v11, 108544, v8
    v_add_u32 v12, 147456, v8
    v_add_u32 v13, 182272, v8
    v_add_u32 v14, 221184, v8
    v_add_u32 v15, 256000, v8
    s_mul_i32 s28, s6, 10240
    s_mul_i32 s29, s60, 5120
    s_add_u32 s28, s28, s29
    s_add_u32 s28, s28, 16777216
    v_lshl_add_u32 v16, v0, 4, s28
    s_add_u32 s62, s29, 16384
    v_add_u32 v17, 4096, v16
    s_mul_i32 s63, s7, 128
    s_mul_i32 s64, s7, 20480
    s_mov_b32 s65, s7
    s_mov_b32 s66, 0
    s_mov_b32 s67, 0
    s_mov_b32 s69, 26624
    s_waitcnt lgkmcnt(0)
    s_mov_b32 s8, s46
    s_mov_b32 s9, s47
    s_mov_b32 s10, 2654208
    s_mov_b32 s11, 0x20000
    s_mov_b32 s16, s58
    s_mov_b32 s17, s59
    s_mov_b32 s18, 50331648
    s_mov_b32 s19, 0x20000
    s_add_u32 s28, s100, 0
    v_mov_b32 v4, s28
    s_mov_b32 s29, 0
L_lwoW:
    ds_read_b32 v6, v4
    s_add_u32 s29, s29, 1
    s_waitcnt lgkmcnt(0)
    v_readfirstlane_b32 s28, v6
    s_cmp_gt_u32 s29, 0x400000
    s_cbranch_scc1 L_lgoW
    s_cmp_ge_u32 s28, 16
    s_cbranch_scc1 L_lgoW
    s_sleep 1
    s_branch L_lwoW
L_lgoW:
    s_mov_b32 s70, 0
    s_mov_b32 s71, 2
    s_mov_b32 s67, 0
L_jW_pm:
    s_add_u32 m0, s61, 0
    s_nop 0
    buffer_load_dwordx4 v8, s[8:11], s63 offen offset:0 lds
    buffer_load_dwordx4 v9, s[8:11], s63 offen offset:2048 lds
    s_add_u32 m0, s61, 4096
    s_nop 0
    buffer_load_dwordx4 v10, s[8:11], s63 offen offset:0 lds
    buffer_load_dwordx4 v11, s[8:11], s63 offen offset:2048 lds
    s_add_u32 m0, s61, 8192
    s_nop 0
    buffer_load_dwordx4 v12, s[8:11], s63 offen offset:0 lds
    buffer_load_dwordx4 v13, s[8:11], s63 offen offset:2048 lds
    s_add_u32 m0, s61, 12288
    s_nop 0
    buffer_load_dwordx4 v14, s[8:11], s63 offen offset:0 lds
    buffer_load_dwordx4 v15, s[8:11], s63 offen offset:2048 lds
    s_add_u32 s63, s63, 128
    s_add_u32 s61, s61, s69
    s_add_u32 s67, s67, 1
    s_cmp_lt_u32 s67, 4
    s_cbranch_scc1 L_jW_pm
    s_cmp_lg_u32 s3, 4
    s_cbranch_scc1 L_pwW
    v_min_u32 v5, 8, v0
    s_lshl_b32 s28, s6, 7
    s_add_u32 s28, s28, 27776
    v_lshl_add_u32 v5, v5, 2, s28
    v_lshlrev_b32 v5, 0, v5
    s_mov_b32 s28, 48234496
    s_mov_b32 s29, 0
L_pollW:
    buffer_load_dword v6, v5, s[16:19], s28 offen sc1
    s_add_u32 s29, s29, 1
    s_waitcnt vmcnt(0)
    v_cmp_eq_u32 vcc, 0, v6
    s_cmp_gt_u32 s29, 0x40000
    s_cbranch_scc1 L_pgotW
    s_cbranch_vccz L_pgotW
    s_sleep 4
    s_branch L_pollW
L_pgotW:
    s_add_u32 s28, s100, 4
    v_mov_b32 v4, s28
    v_mov_b32 v6, 1
    ds_write_b32 v4, v6
    s_branch L_pdoneW
L_pwW:
    s_add_u32 s28, s100, 4
    v_mov_b32 v4, s28
    s_mov_b32 s29, 0
L_lwWr:
    ds_read_b32 v6, v4
    s_add_u32 s29, s29, 1
    s_waitcnt lgkmcnt(0)
    v_readfirstlane_b32 s28, v6
    s_cmp_gt_u32 s29, 0x400000
    s_cbranch_scc1 L_lgWr
    s_cmp_ge_u32 s28, 1
    s_cbranch_scc1 L_lgWr
    s_sleep 1
    s_branch L_lwWr
L_lgWr:
L_pdoneW:
    s_mov_b32 s67, 0
L_jW_pn:
    s_add_u32 m0, s62, 0
    s_nop 0
    buffer_load_dwordx4 v16, s[16:19], s64 offen offset:0 sc1 lds
    buffer_load_dwordx4 v16, s[16:19], s64 offen offset:1024 sc1 lds
    buffer_load_dwordx4 v16, s[16:19], s64 offen offset:2048 sc1 lds
    buffer_load_dwordx4 v16, s[16:19], s64 offen offset:3072 sc1 lds
    s_add_u32 m0, s62, 4096
    s_nop 0
    buffer_load_dwordx4 v17, s[16:19], s64 offen offset:0 sc1 lds
    s_add_u32 s64, s64, 20480
    s_add_u32 s62, s62, s69
    s_add_u32 s67, s67, 1
    s_cmp_lt_u32 s67, 4
    s_cbranch_scc1 L_jW_pn
    s_add_u32 s65, s65, 4
    s_mov_b32 s66, 4
    s_mov_b32 s71, 5
    s_waitcnt vmcnt(15)
    s_barrier
L_jW_lloop:
    s_add_u32 m0, s61, 0
    s_nop 0
    buffer_load_dwordx4 v8, s[8:11], s63 offen offset:0 lds
    buffer_load_dwordx4 v9, s[8:11], s63 offen offset:2048 lds
    s_add_u32 m0, s61, 4096
    s_nop 0
    buffer_load_dwordx4 v10, s[8:11], s63 offen offset:0 lds
    buffer_load_dwordx4 v11, s[8:11], s63 offen offset:2048 lds
    s_add_u32 m0, s61, 8192
    s_nop 0
    buffer_load_dwordx4 v12, s[8:11], s63 offen offset:0 lds
    buffer_load_dwordx4 v13, s[8:11], s63 offen offset:2048 lds
    s_add_u32 m0, s61, 12288
    s_nop 0
    buffer_load_dwordx4 v14, s[8:11], s63 offen offset:0 lds
    buffer_load_dwordx4 v15, s[8:11], s63 offen offset:2048 lds
    s_add_u32 m0, s62, 0
    s_nop 0
    buffer_load_dwordx4 v16, s[16:19], s64 offen offset:0 sc1 lds
    buffer_load_dwordx4 v16, s[16:19], s64 offen offset:1024 sc1 lds
    buffer_load_dwordx4 v16, s[16:19], s64 offen offset:2048 sc1 lds
    buffer_load_dwordx4 v16, s[16:19], s64 offen offset:3072 sc1 lds
    s_add_u32 m0, s62, 4096
    s_nop 0
    buffer_load_dwordx4 v17, s[16:19], s64 offen offset:0 sc1 lds
    s_add_u32 s63, s63, 128
    s_add_u32 s64, s64, 20480
    s_add_u32 s65, s65, 1
    s_cmp_eq_u32 s65, 18
    s_cselect_b32 s63, 0, s63
    s_cselect_b32 s64, 0, s64
    s_cselect_b32 s65, 0, s65
    s_add_u32 s66, s66, 1
    s_cmp_eq_u32 s66, 5
    s_cselect_b32 s68, 4294860800, s69
    s_cselect_b32 s66, 0, s66
    s_add_u32 s61, s61, s68
    s_add_u32 s62, s62, s68
    s_add_u32 s67, s67, 1
    s_cmp_eq_u32 s67, 18
    s_cbranch_scc1 L_jW_ltail
    s_cmp_lt_u32 s67, s71
    s_cbranch_scc1 L_jW_lloop
    s_cmp_lg_u32 s70, 0
    s_cbranch_scc1 L_jW_r0
    s_waitcnt vmcnt(23)
L_jW_r0:
    s_cmp_lg_u32 s70, 1
    s_cbranch_scc1 L_jW_r1
    s_waitcnt vmcnt(31)
L_jW_r1:
    s_waitcnt vmcnt(39)
    s_barrier
    s_add_u32 s70, s70, 1
    s_add_u32 s71, s71, 1
    s_branch L_jW_lloop
L_jW_ltail:
    s_waitcnt vmcnt(39)
    s_barrier
    s_waitcnt vmcnt(26)
    s_barrier
    s_waitcnt vmcnt(13)
    s_barrier
    s_waitcnt vmcnt(0)
    s_barrier
    s_mov_b32 s24, s56
    s_mov_b32 s25, s57
    s_mov_b32 s26, 256
    s_mov_b32 s27, 0x20000
    v_mov_b32 v7, 128
    buffer_load_dword v3, v7, s[24:27], 0 offen sc1
    s_barrier
    s_waitcnt vmcnt(0)
    v_readfirstlane_b32 s101, v3
    s_branch L_next
L_jV:
    s_cmp_ge_u32 s3, 4
    s_cbranch_scc1 L_jV_ld
    v_lshlrev_b32 v8, 4, v0
    v_bfe_u32 v4, v0, 2, 2
    v_and_b32 v5, 1, v2
    v_lshrrev_b32 v6, 1, v4
    v_lshl_add_u32 v5, v5, 1, v6
    v_lshl_add_u32 v4, v2, 2, v4
    v_lshlrev_b32 v4, 7, v4
    v_and_b32 v6, 3, v0
    v_lshl_add_u32 v4, v6, 3, v4
    v_add_u32 v4, 10240, v4
    s_mul_i32 s28, s3, 1
    v_xor_b32 v5, s28, v5
    v_xor_b32 v6, 0, v5
    v_lshl_add_u32 v9, v6, 5, v4
    v_mov_b32 v60, 0
    v_mov_b32 v61, 0
    v_mov_b32 v62, 0
    v_mov_b32 v63, 0
    v_mov_b32 v64, 0
    v_mov_b32 v65, 0
    v_mov_b32 v66, 0
    v_mov_b32 v67, 0
    v_mov_b32 v68, 0
    v_mov_b32 v69, 0
    v_mov_b32 v70, 0
    v_mov_b32 v71, 0
    v_mov_b32 v72, 0
    v_mov_b32 v73, 0
    v_mov_b32 v74, 0
    v_mov_b32 v75, 0
    v_mov_b32 v76, 0
    v_mov_b32 v77, 0
    v_mov_b32 v78, 0
    v_mov_b32 v79, 0
    s_mov_b32 s66, 0
    s_mov_b32 s67, 0
    s_mov_b32 s69, 18432
    s_waitcnt lgkmcnt(0)
    s_mov_b32 s16, s58
    s_mov_b32 s17, s59
    s_mov_b32 s18, 50331648
    s_mov_b32 s19, 0x20000
    s_barrier
    ds_read_b128 v[12:15], v8 offset:0
    ds_read_b64_tr_b16 v[32:33], v9 offset:0
    ds_read_b64_tr_b16 v[34:35], v9 offset:2048
    ds_read_b128 v[16:19], v8 offset:2048
    ds_read_b128 v[20:23], v8 offset:4096
    ds_read_b128 v[24:27], v8 offset:6144
    ds_read_b128 v[28:31], v8 offset:8192
L_jV_cloop:
    s_waitcnt lgkmcnt(6)
    s_waitcnt lgkmcnt(4)
    v_mfma_f32_16x16x32_bf16 v[60:63], v[12:15], v[32:35], v[60:63]
    ds_read_b128 v[36:39], v8 offset:1024
    ds_read_b64_tr_b16 v[56:57], v9 offset:4096
    ds_read_b64_tr_b16 v[58:59], v9 offset:6144
    s_waitcnt lgkmcnt(6)
    v_mfma_f32_16x16x32_bf16 v[64:67], v[16:19], v[32:35], v[64:67]
    ds_read_b128 v[40:43], v8 offset:3072
    ds_read_b128 v[44:47], v8 offset:5120
    ds_read_b128 v[48:51], v8 offset:7168
    s_waitcnt lgkmcnt(8)
    v_mfma_f32_16x16x32_bf16 v[68:71], v[20:23], v[32:35], v[68:71]
    ds_read_b128 v[52:55], v8 offset:9216
    s_waitcnt lgkmcnt(8)
    v_mfma_f32_16x16x32_bf16 v[72:75], v[24:27], v[32:35], v[72:75]
    s_add_u32 s66, s66, 1
    s_cmp_eq_u32 s66, 6
    s_cselect_b32 s68, 4294875136, s69
    s_cselect_b32 s66, 0, s66
    v_add_u32 v8, s68, v8
    v_add_u32 v9, s68, v9
    s_add_u32 s67, s67, 1
    s_cmp_eq_u32 s67, 18
    s_waitcnt lgkmcnt(7)
    v_mfma_f32_16x16x32_bf16 v[76:79], v[28:31], v[32:35], v[76:79]
    s_cbranch_scc1 L_jV_ctail
    s_waitcnt lgkmcnt(0)
    s_barrier
    v_mfma_f32_16x16x32_bf16 v[60:63], v[36:39], v[56:59], v[60:63]
    ds_read_b128 v[12:15], v8 offset:0
    ds_read_b64_tr_b16 v[32:33], v9 offset:0
    ds_read_b64_tr_b16 v[34:35], v9 offset:2048
    v_mfma_f32_16x16x32_bf16 v[64:67], v[40:43], v[56:59], v[64:67]
    ds_read_b128 v[16:19], v8 offset:2048
    ds_read_b128 v[20:23], v8 offset:4096
    ds_read_b128 v[24:27], v8 offset:6144
    v_mfma_f32_16x16x32_bf16 v[68:71], v[44:47], v[56:59], v[68:71]
    ds_read_b128 v[28:31], v8 offset:8192
    v_mfma_f32_16x16x32_bf16 v[72:75], v[48:51], v[56:59], v[72:75]
    v_mfma_f32_16x16x32_bf16 v[76:79], v[52:55], v[56:59], v[76:79]
    s_branch L_jV_cloop
L_jV_ctail:
    s_waitcnt lgkmcnt(0)
    s_barrier
    v_mfma_f32_16x16x32_bf16 v[60:63], v[36:39], v[56:59], v[60:63]
    v_mfma_f32_16x16x32_bf16 v[64:67], v[40:43], v[56:59], v[64:67]
    v_mfma_f32_16x16x32_bf16 v[68:71], v[44:47], v[56:59], v[68:71]
    v_mfma_f32_16x16x32_bf16 v[72:75], v[48:51], v[56:59], v[72:75]
    v_mfma_f32_16x16x32_bf16 v[76:79], v[52:55], v[56:59], v[76:79]
    s_lshl_b32 s30, s6, 2
    s_mul_i32 s31, s5, 5
    s_mov_b32 s28, s30
    s_mul_i32 s29, s3, 1
    s_add_u32 s28, s28, s29
    s_mul_i32 s28, s28, 10
    s_add_u32 s28, s28, s31
    s_lshl_b32 s28, s28, 9
    s_add_u32 s28, s28, 34603008
    v_lshlrev_b32 v4, 3, v0
    s_nop 4
    v_cvt_pk_bf16_f32 v60, v60, v61
    v_cvt_pk_bf16_f32 v61, v62, v63
    buffer_store_dwordx2 v[60:61], v4, s[16:19], s28 offen offset:0 sc1
    v_cvt_pk_bf16_f32 v64, v64, v65
    v_cvt_pk_bf16_f32 v65, v66, v67
    buffer_store_dwordx2 v[64:65], v4, s[16:19], s28 offen offset:512 sc1
    v_cvt_pk_bf16_f32 v68, v68, v69
    v_cvt_pk_bf16_f32 v69, v70, v71
    buffer_store_dwordx2 v[68:69], v4, s[16:19], s28 offen offset:1024 sc1
    v_cvt_pk_bf16_f32 v72, v72, v73
    v_cvt_pk_bf16_f32 v73, v74, v75
    buffer_store_dwordx2 v[72:73], v4, s[16:19], s28 offen offset:1536 sc1
    v_cvt_pk_bf16_f32 v76, v76, v77
    v_cvt_pk_bf16_f32 v77, v78, v79
    buffer_store_dwordx2 v[76:77], v4, s[16:19], s28 offen offset:2048 sc1
    s_lshl_b32 s30, s5, 8
    s_lshl_b32 s31, s6, 2
    s_add_u32 s30, s30, s31
    s_add_u32 s30, s30, 28068
    s_mov_b64 exec, 1
    s_lshl_b32 s30, s30, 0
    s_add_u32 s30, s30, 48234496
    v_mov_b32 v5, 2
    s_add_u32 s28, s100, 8
    v_mov_b32 v4, s28
    s_waitcnt vmcnt(0)
    v_mov_b32 v7, 0
    ds_add_rtn_u32 v6, v4, v5
    s_waitcnt lgkmcnt(0)
    v_readfirstlane_b32 s29, v6
    s_cmp_lg_u32 s29, 6
    s_cbranch_scc1 L_sejV
    buffer_store_dword v5, v7, s[16:19], s30 offen sc1
    v_mov_b32 v6, 16
    ds_write_b32 v4, v6
L_sejV:
    s_mov_b64 exec, -1
    s_branch L_next
L_jV_ld:
    s_sub_u32 s60, s3, 4
    s_mul_i32 s28, s5, 10240
    s_mul_i32 s29, s60, 5120
    s_add_u32 s28, s28, s29
    s_add_u32 s28, s28, 17145856
    v_lshl_add_u32 v8, v0, 4, s28
    s_mov_b32 s61, s29
    v_add_u32 v9, 4096, v8
    v_lshrrev_b32 v4, 3, v0
    v_and_b32 v5, 7, v0
    v_lshlrev_b32 v6, 1, v2
    v_xor_b32 v5, v5, v6
    v_mul_u32_u24 v4, 2304, v4
    v_lshl_add_u32 v4, v5, 4, v4
    s_mul_i32 s28, s6, 128
    s_mul_i32 s29, s60, 18432
    s_add_u32 s28, s28, s29
    v_add_u32 v10, s28, v4
    s_lshl_b32 s62, s60, 10
    s_add_u32 s62, s62, 10240
    v_add_u32 v11, 34816, v10
    v_add_u32 v12, 73728, v10
    v_add_u32 v13, 108544, v10
    s_mul_i32 s63, s7, 20480
    s_mul_i32 s64, s7, 147456
    s_mov_b32 s65, s7
    s_mov_b32 s66, 0
    s_mov_b32 s67, 0
    s_mov_b32 s69, 18432
    s_waitcnt lgkmcnt(0)
    s_mov_b32 s12, s50
    s_mov_b32 s13, s51
    s_mov_b32 s14, 2654208
    s_mov_b32 s15, 0x20000
    s_mov_b32 s16, s58
    s_mov_b32 s17, s59
    s_mov_b32 s18, 50331648
    s_mov_b32 s19, 0x20000
    s_add_u32 s28, s100, 0
    v_mov_b32 v4, s28
    s_mov_b32 s29, 0
L_lwoV:
    ds_read_b32 v6, v4
    s_add_u32 s29, s29, 1
    s_waitcnt lgkmcnt(0)
    v_readfirstlane_b32 s28, v6
    s_cmp_gt_u32 s29, 0x400000
    s_cbranch_scc1 L_lgoV
    s_cmp_ge_u32 s28, 16
    s_cbranch_scc1 L_lgoV
    s_sleep 1
    s_branch L_lwoV
L_lgoV:
    s_mov_b32 s70, 0
    s_mov_b32 s71, 2
    s_mov_b32 s67, 0
L_jV_pn:
    s_add_u32 m0, s62, 0
    s_nop 0
    buffer_load_dwordx4 v10, s[12:15], s64 offen offset:0 lds
    buffer_load_dwordx4 v11, s[12:15], s64 offen offset:2048 lds
    s_add_u32 m0, s62, 4096
    s_nop 0
    buffer_load_dwordx4 v12, s[12:15], s64 offen offset:0 lds
    buffer_load_dwordx4 v13, s[12:15], s64 offen offset:2048 lds
    s_add_u32 s64, s64, 147456
    s_add_u32 s62, s62, s69
    s_add_u32 s67, s67, 1
    s_cmp_lt_u32 s67, 5
    s_cbranch_scc1 L_jV_pn
    s_cmp_lg_u32 s3, 4
    s_cbranch_scc1 L_pwV
    v_min_u32 v5, 8, v0
    s_lshl_b32 s28, s5, 7
    s_add_u32 s28, s28, 27812
    v_lshl_add_u32 v5, v5, 2, s28
    v_lshlrev_b32 v5, 0, v5
    s_mov_b32 s28, 48234496
    s_mov_b32 s29, 0
L_pollV:
    buffer_load_dword v6, v5, s[16:19], s28 offen sc1
    s_add_u32 s29, s29, 1
    s_waitcnt vmcnt(0)
    v_cmp_eq_u32 vcc, 0, v6
    s_cmp_gt_u32 s29, 0x40000
    s_cbranch_scc1 L_pgotV
    s_cbranch_vccz L_pgotV
    s_sleep 4
    s_branch L_pollV
L_pgotV:
    s_add_u32 s28, s100, 4
    v_mov_b32 v4, s28
    v_mov_b32 v6, 1
    ds_write_b32 v4, v6
    s_branch L_pdoneV
L_pwV:
    s_add_u32 s28, s100, 4
    v_mov_b32 v4, s28
    s_mov_b32 s29, 0
L_lwVr:
    ds_read_b32 v6, v4
    s_add_u32 s29, s29, 1
    s_waitcnt lgkmcnt(0)
    v_readfirstlane_b32 s28, v6
    s_cmp_gt_u32 s29, 0x400000
    s_cbranch_scc1 L_lgVr
    s_cmp_ge_u32 s28, 1
    s_cbranch_scc1 L_lgVr
    s_sleep 1
    s_branch L_lwVr
L_lgVr:
L_pdoneV:
    s_mov_b32 s67, 0
L_jV_pm:
    s_add_u32 m0, s61, 0
    s_nop 0
    buffer_load_dwordx4 v8, s[16:19], s63 offen offset:0 sc1 lds
    buffer_load_dwordx4 v8, s[16:19], s63 offen offset:1024 sc1 lds
    buffer_load_dwordx4 v8, s[16:19], s63 offen offset:2048 sc1 lds
    buffer_load_dwordx4 v8, s[16:19], s63 offen offset:3072 sc1 lds
    s_add_u32 m0, s61, 4096
    s_nop 0
    buffer_load_dwordx4 v9, s[16:19], s63 offen offset:0 sc1 lds
    s_add_u32 s63, s63, 20480
    s_add_u32 s61, s61, s69
    s_add_u32 s67, s67, 1
    s_cmp_lt_u32 s67, 5
    s_cbranch_scc1 L_jV_pm
    s_add_u32 s65, s65, 5
    s_mov_b32 s66, 5
    s_mov_b32 s71, 6
    s_waitcnt vmcnt(20)
    s_barrier
L_jV_lloop:
    s_add_u32 m0, s61, 0
    s_nop 0
    buffer_load_dwordx4 v8, s[16:19], s63 offen offset:0 sc1 lds
    buffer_load_dwordx4 v8, s[16:19], s63 offen offset:1024 sc1 lds
    buffer_load_dwordx4 v8, s[16:19], s63 offen offset:2048 sc1 lds
    buffer_load_dwordx4 v8, s[16:19], s63 offen offset:3072 sc1 lds
    s_add_u32 m0, s61, 4096
    s_nop 0
    buffer_load_dwordx4 v9, s[16:19], s63 offen offset:0 sc1 lds
    s_add_u32 m0, s62, 0
    s_nop 0
    buffer_load_dwordx4 v10, s[12:15], s64 offen offset:0 lds
    buffer_load_dwordx4 v11, s[12:15], s64 offen offset:2048 lds
    s_add_u32 m0, s62, 4096
    s_nop 0
    buffer_load_dwordx4 v12, s[12:15], s64 offen offset:0 lds
    buffer_load_dwordx4 v13, s[12:15], s64 offen offset:2048 lds
    s_add_u32 s63, s63, 20480
    s_add_u32 s64, s64, 147456
    s_add_u32 s65, s65, 1
    s_cmp_eq_u32 s65, 18
    s_cselect_b32 s63, 0, s63
    s_cselect_b32 s64, 0, s64
    s_cselect_b32 s65, 0, s65
    s_add_u32 s66, s66, 1
    s_cmp_eq_u32 s66, 6
    s_cselect_b32 s68, 4294875136, s69
    s_cselect_b32 s66, 0, s66
    s_add_u32 s61, s61, s68
    s_add_u32 s62, s62, s68
    s_add_u32 s67, s67, 1
    s_cmp_eq_u32 s67, 18
    s_cbranch_scc1 L_jV_ltail
    s_cmp_lt_u32 s67, s71
    s_cbranch_scc1 L_jV_lloop
    s_cmp_lg_u32 s70, 0
    s_cbranch_scc1 L_jV_r0
    s_waitcnt vmcnt(24)
L_jV_r0:
    s_cmp_lg_u32 s70, 1
    s_cbranch_scc1 L_jV_r1
    s_waitcnt vmcnt(28)
L_jV_r1:
    s_cmp_lg_u32 s70, 2
    s_cbranch_scc1 L_jV_r2
    s_waitcnt vmcnt(32)
L_jV_r2:
    s_waitcnt vmcnt(36)
    s_barrier
    s_add_u32 s70, s70, 1
    s_add_u32 s71, s71, 1
    s_branch L_jV_lloop
L_jV_ltail:
    s_waitcnt vmcnt(36)
    s_barrier
    s_waitcnt vmcnt(27)
    s_barrier
    s_waitcnt vmcnt(18)
    s_barrier
    s_waitcnt vmcnt(9)
    s_barrier
    s_waitcnt vmcnt(0)
    s_barrier
    s_mov_b32 s24, s56
    s_mov_b32 s25, s57
    s_mov_b32 s26, 256
    s_mov_b32 s27, 0x20000
    v_mov_b32 v7, 128
    buffer_load_dword v3, v7, s[24:27], 0 offen sc1
    s_barrier
    s_waitcnt vmcnt(0)
    v_readfirstlane_b32 s101, v3
    s_branch L_next
L_st3:
    s_and_b32 s30, s2, 7
    s_lshr_b32 s31, s2, 3
    s_lshr_b32 s32, s30, 1
    s_lshl_b32 s32, s32, 3
    s_lshr_b32 s33, s31, 2
    s_add_u32 s6, s32, s33
    s_and_b32 s32, s30, 1
    s_lshl_b32 s32, s32, 2
    s_and_b32 s33, s31, 3
    s_add_u32 s72, s32, s33
    s_lshr_b32 s73, s6, 4
    s_lshl_b32 s32, s73, 3
    s_add_u32 s5, s32, s72
    s_cmp_ge_u32 s3, 4
    s_cbranch_scc1 L_jP_ld
    s_and_b32 s60, s3, 1
    s_lshl_b32 s28, s60, 10
    v_lshl_add_u32 v84, v0, 4, s28
    s_lshl_b32 s29, s3, 11
    s_add_u32 s29, s29, 18432
    v_add_u32 v85, s29, v84
    s_xor_b32 s29, s3, 1
    s_lshl_b32 s29, s29, 11
    s_add_u32 s29, s29, 18432
    v_add_u32 v86, s29, v84
    v_mov_b32 v176, 0
    v_mov_b32 v177, 0
    v_mov_b32 v178, 0
    v_mov_b32 v179, 0
    v_mov_b32 v180, 0
    v_mov_b32 v181, 0
    v_mov_b32 v182, 0
    v_mov_b32 v183, 0
    v_mov_b32 v184, 0
    v_mov_b32 v185, 0
    v_mov_b32 v186, 0
    v_mov_b32 v187, 0
    v_mov_b32 v188, 0
    v_mov_b32 v189, 0
    v_mov_b32 v190, 0
    v_mov_b32 v191, 0
    v_mov_b32 v192, 0
    v_mov_b32 v193, 0
    v_mov_b32 v194, 0
    v_mov_b32 v195, 0
    v_mov_b32 v196, 0
    v_mov_b32 v197, 0
    v_mov_b32 v198, 0
    v_mov_b32 v199, 0
    v_mov_b32 v200, 0
    v_mov_b32 v201, 0
    v_mov_b32 v202, 0
    v_mov_b32 v203, 0
    v_mov_b32 v204, 0
    v_mov_b32 v205, 0
    v_mov_b32 v206, 0
    v_mov_b32 v207, 0
    v_mov_b32 v208, 0
    v_mov_b32 v209, 0
    v_mov_b32 v210, 0
    v_mov_b32 v211, 0
    v_mov_b32 v212, 0
    v_mov_b32 v213, 0
    v_mov_b32 v214, 0
    v_mov_b32 v215, 0
    v_mov_b32 v216, 0
    v_mov_b32 v217, 0
    v_mov_b32 v218, 0
    v_mov_b32 v219, 0
    v_mov_b32 v220, 0
    v_mov_b32 v221, 0
    v_mov_b32 v222, 0
    v_mov_b32 v223, 0
    v_mov_b32 v224, 0
    v_mov_b32 v225, 0
    v_mov_b32 v226, 0
    v_mov_b32 v227, 0
    v_mov_b32 v228, 0
    v_mov_b32 v229, 0
    v_mov_b32 v230, 0
    v_mov_b32 v231, 0
    v_mov_b32 v232, 0
    v_mov_b32 v233, 0
    v_mov_b32 v234, 0
    v_mov_b32 v235, 0
    v_mov_b32 v236, 0
    v_mov_b32 v237, 0
    v_mov_b32 v238, 0
    v_mov_b32 v239, 0
    v_mov_b32 v240, 0
    v_mov_b32 v241, 0
    v_mov_b32 v242, 0
    v_mov_b32 v243, 0
    v_mov_b32 v244, 0
    v_mov_b32 v245, 0
    v_mov_b32 v246, 0
    v_mov_b32 v247, 0
    s_mov_b32 s66, 0
    s_mov_b32 s67, 0
    s_mov_b32 s69, 26624
    s_waitcnt lgkmcnt(0)
    s_mov_b32 s16, s58
    s_mov_b32 s17, s59
    s_mov_b32 s18, 50331648
    s_mov_b32 s19, 0x20000
    s_add_u32 s28, s100, 4
    v_mov_b32 v4, s28
    s_mov_b32 s29, 0
L_lwPcr:
    ds_read_b32 v6, v4
    s_add_u32 s29, s29, 1
    s_waitcnt lgkmcnt(0)
    v_readfirstlane_b32 s28, v6
    s_cmp_gt_u32 s29, 0x400000
    s_cbranch_scc1 L_lgPcr
    s_cmp_ge_u32 s28, 1
    s_cbranch_scc1 L_lgPcr
    s_sleep 1
    s_branch L_lwPcr
L_lgPcr:
L_pdonePc:
    s_lshl_b32 s74, s6, 2
    s_add_u32 s74, s74, s3
    s_lshl_b32 s28, s6, 13
    s_lshl_b32 s29, s3, 7
    s_add_u32 s28, s28, s29
    s_add_u32 s28, s28, 35717120
    s_xor_b32 s29, s28, 128
    v_lshlrev_b32 v4, 11, v2
    v_lshl_add_u32 v4, v1, 3, v4
    buffer_load_dwordx2 v[132:133], v4, s[16:19], s28 offen offset:0 sc1
    buffer_load_dwordx2 v[134:135], v4, s[16:19], s28 offen offset:512 sc1
    buffer_load_dwordx2 v[136:137], v4, s[16:19], s28 offen offset:1024 sc1
    buffer_load_dwordx2 v[138:139], v4, s[16:19], s28 offen offset:1536 sc1
    buffer_load_dwordx2 v[148:149], v4, s[16:19], s29 offen offset:0 sc1
    buffer_load_dwordx2 v[150:151], v4, s[16:19], s29 offen offset:512 sc1
    buffer_load_dwordx2 v[152:153], v4, s[16:19], s29 offen offset:1024 sc1
    buffer_load_dwordx2 v[154:155], v4, s[16:19], s29 offen offset:1536 sc1
    v_lshlrev_b32 v7, 4, v2
    v_add_u32 v7, 124928, v7
    ds_read_b128 v[36:39], v7 offset:0
    ds_read_b128 v[88:91], v7 offset:1024
    ds_read_b128 v[40:43], v7 offset:64
    ds_read_b128 v[92:95], v7 offset:1088
    ds_read_b128 v[44:47], v7 offset:128
    ds_read_b128 v[96:99], v7 offset:1152
    ds_read_b128 v[48:51], v7 offset:192
    ds_read_b128 v[100:103], v7 offset:1216
    ds_read_b128 v[52:55], v7 offset:256
    ds_read_b128 v[104:107], v7 offset:1280
    ds_read_b128 v[56:59], v7 offset:320
    ds_read_b128 v[108:111], v7 offset:1344
    ds_read_b128 v[60:63], v7 offset:384
    ds_read_b128 v[112:115], v7 offset:1408
    ds_read_b128 v[64:67], v7 offset:448
    ds_read_b128 v[116:119], v7 offset:1472
    ds_read_b128 v[68:71], v7 offset:512
    ds_read_b128 v[120:123], v7 offset:1536
    s_lshl_b32 s29, s3, 11
    s_add_u32 s29, s29, 151552
    v_lshl_add_u32 v14, v1, 2, s29
    v_lshl_add_u32 v5, v2, 8, v14
    s_mul_i32 s28, s3, 4608
    s_add_u32 s75, s28, 106496
    v_mul_u32_u24 v6, 288, v1
    v_lshl_add_u32 v6, v2, 3, v6
    v_add_u32 v15, s75, v6
    v_mov_b32 v80, 0x3f803f80
    v_mov_b32 v81, 0x3f803f80
    v_mov_b32 v82, 0x3f803f80
    v_mov_b32 v83, 0x3f803f80
    v_mov_b32 v34, 0
    v_mov_b32 v35, 0
    s_mov_b32 s71, 0xffff0000
    s_waitcnt lgkmcnt(0)
    v_pk_add_f32 v[36:37], v[36:37], v[88:89]
    v_pk_add_f32 v[38:39], v[38:39], v[90:91]
    v_pk_add_f32 v[40:41], v[40:41], v[92:93]
    v_pk_add_f32 v[42:43], v[42:43], v[94:95]
    v_pk_add_f32 v[44:45], v[44:45], v[96:97]
    v_pk_add_f32 v[46:47], v[46:47], v[98:99]
    v_pk_add_f32 v[48:49], v[48:49], v[100:101]
    v_pk_add_f32 v[50:51], v[50:51], v[102:103]
    v_pk_add_f32 v[52:53], v[52:53], v[104:105]
    v_pk_add_f32 v[54:55], v[54:55], v[106:107]
    v_pk_add_f32 v[56:57], v[56:57], v[108:109]
    v_pk_add_f32 v[58:59], v[58:59], v[110:111]
    v_pk_add_f32 v[60:61], v[60:61], v[112:113]
    v_pk_add_f32 v[62:63], v[62:63], v[114:115]
    v_pk_add_f32 v[64:65], v[64:65], v[116:117]
    v_pk_add_f32 v[66:67], v[66:67], v[118:119]
    v_pk_add_f32 v[68:69], v[68:69], v[120:121]
    v_pk_add_f32 v[70:71], v[70:71], v[122:123]
    s_barrier
    ds_read_b128 v[124:127], v85
    ds_read_b128 v[128:131], v86
    ds_read_b128 v[88:91], v84 offset:0
    ds_read_b128 v[92:95], v84 offset:2048
    ds_read_b128 v[96:99], v84 offset:4096
    ds_read_b128 v[100:103], v84 offset:6144
    ds_read_b128 v[104:107], v84 offset:8192
    ds_read_b128 v[108:111], v84 offset:10240
    ds_read_b128 v[112:115], v84 offset:12288
    ds_read_b128 v[116:119], v84 offset:14336
    ds_read_b128 v[120:123], v84 offset:16384
    ds_read_b64 v[16:17], v15 offset:0
    ds_read_b64 v[18:19], v15 offset:32
    ds_read_b64 v[20:21], v15 offset:64
    ds_read_b64 v[22:23], v15 offset:96
    ds_read_b64 v[24:25], v15 offset:128
    ds_read_b64 v[26:27], v15 offset:160
    ds_read_b64 v[28:29], v15 offset:192
    ds_read_b64 v[30:31], v15 offset:224
    ds_read_b64 v[32:33], v15 offset:256
    s_waitcnt vmcnt(0)
    v_max3_f32 v164, v132, v134, v136
    v_max3_f32 v165, v148, v150, v152
    v_max_f32 v164, v164, v138
    v_max_f32 v165, v165, v154
    v_mov_b32 v166, v164
    v_mov_b32 v167, v165
    s_nop 1
    v_permlane16_swap_b32 v164, v166
    v_permlane16_swap_b32 v165, v167
    v_max_f32 v164, v164, v166
    v_max_f32 v165, v165, v167
    v_mov_b32 v166, v164
    v_mov_b32 v167, v165
    s_nop 1
    v_permlane32_swap_b32 v164, v166
    v_permlane32_swap_b32 v165, v167
    v_max_f32 v164, v164, v166
    v_max_f32 v165, v165, v167
    v_sub_f32 v132, v164, v132
    v_sub_f32 v134, v164, v134
    v_sub_f32 v136, v164, v136
    v_sub_f32 v138, v164, v138
    v_sub_f32 v148, v165, v148
    v_sub_f32 v150, v165, v150
    v_sub_f32 v152, v165, v152
    v_sub_f32 v154, v165, v154
    v_exp_f32 v140, -v132
    v_exp_f32 v141, -v134
    v_exp_f32 v142, -v136
    v_exp_f32 v143, -v138
    v_cvt_u32_f32 v132, v132
    v_cvt_u32_f32 v134, v134
    v_cvt_u32_f32 v136, v136
    v_cvt_u32_f32 v138, v138
    v_cvt_u32_f32 v148, v148
    v_cvt_u32_f32 v150, v150
    v_cvt_u32_f32 v152, v152
    v_cvt_u32_f32 v154, v154
    v_min_u32 v132, 0xff, v132
    v_min_u32 v134, 0xff, v134
    v_min_u32 v136, 0xff, v136
    v_min_u32 v138, 0xff, v138
    v_min_u32 v148, 0xff, v148
    v_min_u32 v150, 0xff, v150
    v_min_u32 v152, 0xff, v152
    v_min_u32 v154, 0xff, v154
    v_mul_u32_u24 v132, 0x800080, v132
    ds_write_b32 v5, v132 offset:0
    v_mul_u32_u24 v134, 0x800080, v134
    ds_write_b32 v5, v134 offset:64
    v_mul_u32_u24 v136, 0x800080, v136
    ds_write_b32 v5, v136 offset:128
    v_mul_u32_u24 v138, 0x800080, v138
    ds_write_b32 v5, v138 offset:192
    v_mul_u32_u24 v148, 0x800080, v148
    ds_write_b32 v5, v148 offset:1024
    v_mul_u32_u24 v150, 0x800080, v150
    ds_write_b32 v5, v150 offset:1088
    v_mul_u32_u24 v152, 0x800080, v152
    ds_write_b32 v5, v152 offset:1152
    v_mul_u32_u24 v154, 0x800080, v154
    ds_write_b32 v5, v154 offset:1216
    v_mul_f32 v6, v140, v133
    v_fmac_f32 v6, v141, v135
    v_fmac_f32 v6, v142, v137
    v_fmac_f32 v6, v143, v139
    v_mov_b32 v7, v6
    s_nop 1
    v_permlane16_swap_b32 v6, v7
    v_add_f32 v6, v6, v7
    v_mov_b32 v7, v6
    s_nop 1
    v_permlane32_swap_b32 v6, v7
    v_add_f32 v6, v6, v7
    v_rcp_f32 v8, v6
    s_nop 0
    v_pk_mul_f32 v[36:37], v[36:37], v[8:9] op_sel_hi:[1,0]
    v_pk_mul_f32 v[38:39], v[38:39], v[8:9] op_sel_hi:[1,0]
    v_pk_mul_f32 v[40:41], v[40:41], v[8:9] op_sel_hi:[1,0]
    v_pk_mul_f32 v[42:43], v[42:43], v[8:9] op_sel_hi:[1,0]
    v_pk_mul_f32 v[44:45], v[44:45], v[8:9] op_sel_hi:[1,0]
    v_pk_mul_f32 v[46:47], v[46:47], v[8:9] op_sel_hi:[1,0]
    v_pk_mul_f32 v[48:49], v[48:49], v[8:9] op_sel_hi:[1,0]
    v_pk_mul_f32 v[50:51], v[50:51], v[8:9] op_sel_hi:[1,0]
    v_pk_mul_f32 v[52:53], v[52:53], v[8:9] op_sel_hi:[1,0]
    v_pk_mul_f32 v[54:55], v[54:55], v[8:9] op_sel_hi:[1,0]
    v_pk_mul_f32 v[56:57], v[56:57], v[8:9] op_sel_hi:[1,0]
    v_pk_mul_f32 v[58:59], v[58:59], v[8:9] op_sel_hi:[1,0]
    v_pk_mul_f32 v[60:61], v[60:61], v[8:9] op_sel_hi:[1,0]
    v_pk_mul_f32 v[62:63], v[62:63], v[8:9] op_sel_hi:[1,0]
    v_pk_mul_f32 v[64:65], v[64:65], v[8:9] op_sel_hi:[1,0]
    v_pk_mul_f32 v[66:67], v[66:67], v[8:9] op_sel_hi:[1,0]
    v_pk_mul_f32 v[68:69], v[68:69], v[8:9] op_sel_hi:[1,0]
    v_pk_mul_f32 v[70:71], v[70:71], v[8:9] op_sel_hi:[1,0]
    ds_read_b32 v10, v14 offset:0
    ds_read_b32 v11, v14 offset:1024
    s_add_u32 s66, s66, 1
    s_cmp_eq_u32 s66, 4
    s_cselect_b32 s68, 4294887424, s69
    s_cselect_b32 s66, 0, s66
    v_add_u32 v84, s68, v84
    v_add_u32 v85, s68, v85
    v_add_u32 v86, s68, v86
    v_add_u32 v14, 64, v14
L_jP_cloop:
    s_waitcnt lgkmcnt(0)
    s_barrier
    ds_read_b32 v12, v14 offset:0
    ds_read_b32 v13, v14 offset:1024
    v_pk_sub_u16 v124, v124, v10 clamp
    v_pk_sub_u16 v125, v125, v10 clamp
    v_pk_sub_u16 v126, v126, v10 clamp
    v_pk_sub_u16 v127, v127, v10 clamp
    v_pk_sub_u16 v128, v128, v11 clamp
    v_pk_sub_u16 v129, v129, v11 clamp
    v_pk_sub_u16 v130, v130, v11 clamp
    v_pk_sub_u16 v131, v131, v11 clamp
    s_nop 0
    v_mfma_f32_16x16x32_bf16 v[176:179], v[88:91], v[124:127], v[176:179]
    ds_read_b128 v[168:171], v85
    v_mfma_f32_16x16x32_bf16 v[212:215], v[88:91], v[128:131], v[212:215]
    ds_read_b128 v[172:175], v86
    v_mfma_f32_16x16x32_bf16 v[180:183], v[92:95], v[124:127], v[180:183]
    ds_read_b128 v[132:135], v84 offset:0
    v_mfma_f32_16x16x32_bf16 v[216:219], v[92:95], v[128:131], v[216:219]
    ds_read_b128 v[136:139], v84 offset:2048
    v_mfma_f32_16x16x32_bf16 v[184:187], v[96:99], v[124:127], v[184:187]
    ds_read_b128 v[140:143], v84 offset:4096
    v_mfma_f32_16x16x32_bf16 v[220:223], v[96:99], v[128:131], v[220:223]
    ds_read_b128 v[144:147], v84 offset:6144
    v_mfma_f32_16x16x32_bf16 v[188:191], v[100:103], v[124:127], v[188:191]
    ds_read_b128 v[148:151], v84 offset:8192
    v_mfma_f32_16x16x32_bf16 v[224:227], v[100:103], v[128:131], v[224:227]
    ds_read_b128 v[152:155], v84 offset:10240
    v_mfma_f32_16x16x32_bf16 v[192:195], v[104:107], v[124:127], v[192:195]
    ds_read_b128 v[156:159], v84 offset:12288
    v_mfma_f32_16x16x32_bf16 v[228:231], v[104:107], v[128:131], v[228:231]
    ds_read_b128 v[160:163], v84 offset:14336
    v_mfma_f32_16x16x32_bf16 v[196:199], v[108:111], v[124:127], v[196:199]
    ds_read_b128 v[164:167], v84 offset:16384
    v_mfma_f32_16x16x32_bf16 v[232:235], v[108:111], v[128:131], v[232:235]
    s_add_u32 s66, s66, 1
    s_cmp_eq_u32 s66, 4
    v_mfma_f32_16x16x32_bf16 v[200:203], v[112:115], v[124:127], v[200:203]
    s_cselect_b32 s68, 4294887424, s69
    s_cselect_b32 s66, 0, s66
    v_mfma_f32_16x16x32_bf16 v[236:239], v[112:115], v[128:131], v[236:239]
    v_add_u32 v84, s68, v84
    v_add_u32 v85, s68, v85
    v_mfma_f32_16x16x32_bf16 v[204:207], v[116:119], v[124:127], v[204:207]
    v_add_u32 v86, s68, v86
    v_add_u32 v14, 64, v14
    v_mfma_f32_16x16x32_bf16 v[240:243], v[116:119], v[128:131], v[240:243]
    s_add_u32 s67, s67, 2
    v_mfma_f32_16x16x32_bf16 v[208:211], v[120:123], v[124:127], v[208:211]
    s_cmp_eq_u32 s67, 16
    v_mfma_f32_16x16x32_bf16 v[244:247], v[120:123], v[128:131], v[244:247]
    s_waitcnt lgkmcnt(0)
    s_cbranch_scc1 L_jP_ctail
    s_barrier
    ds_read_b32 v10, v14 offset:0
    ds_read_b32 v11, v14 offset:1024
    v_pk_sub_u16 v168, v168, v12 clamp
    v_pk_sub_u16 v169, v169, v12 clamp
    v_pk_sub_u16 v170, v170, v12 clamp
    v_pk_sub_u16 v171, v171, v12 clamp
    v_pk_sub_u16 v172, v172, v13 clamp
    v_pk_sub_u16 v173, v173, v13 clamp
    v_pk_sub_u16 v174, v174, v13 clamp
    v_pk_sub_u16 v175, v175, v13 clamp
    s_nop 0
    v_mfma_f32_16x16x32_bf16 v[176:179], v[132:135], v[168:171], v[176:179]
    ds_read_b128 v[124:127], v85
    v_mfma_f32_16x16x32_bf16 v[212:215], v[132:135], v[172:175], v[212:215]
    ds_read_b128 v[128:131], v86
    v_mfma_f32_16x16x32_bf16 v[180:183], v[136:139], v[168:171], v[180:183]
    ds_read_b128 v[88:91], v84 offset:0
    v_mfma_f32_16x16x32_bf16 v[216:219], v[136:139], v[172:175], v[216:219]
    ds_read_b128 v[92:95], v84 offset:2048
    v_mfma_f32_16x16x32_bf16 v[184:187], v[140:143], v[168:171], v[184:187]
    ds_read_b128 v[96:99], v84 offset:4096
    v_mfma_f32_16x16x32_bf16 v[220:223], v[140:143], v[172:175], v[220:223]
    ds_read_b128 v[100:103], v84 offset:6144
    v_mfma_f32_16x16x32_bf16 v[188:191], v[144:147], v[168:171], v[188:191]
    ds_read_b128 v[104:107], v84 offset:8192
    v_mfma_f32_16x16x32_bf16 v[224:227], v[144:147], v[172:175], v[224:227]
    ds_read_b128 v[108:111], v84 offset:10240
    v_mfma_f32_16x16x32_bf16 v[192:195], v[148:151], v[168:171], v[192:195]
    ds_read_b128 v[112:115], v84 offset:12288
    v_mfma_f32_16x16x32_bf16 v[228:231], v[148:151], v[172:175], v[228:231]
    ds_read_b128 v[116:119], v84 offset:14336
    v_mfma_f32_16x16x32_bf16 v[196:199], v[152:155], v[168:171], v[196:199]
    ds_read_b128 v[120:123], v84 offset:16384
    v_mfma_f32_16x16x32_bf16 v[232:235], v[152:155], v[172:175], v[232:235]
    s_add_u32 s66, s66, 1
    s_cmp_eq_u32 s66, 4
    v_mfma_f32_16x16x32_bf16 v[200:203], v[156:159], v[168:171], v[200:203]
    s_cselect_b32 s68, 4294887424, s69
    s_cselect_b32 s66, 0, s66
    v_mfma_f32_16x16x32_bf16 v[236:239], v[156:159], v[172:175], v[236:239]
    v_add_u32 v84, s68, v84
    v_mfma_f32_16x16x32_bf16 v[204:207], v[160:163], v[168:171], v[204:207]
    v_add_u32 v85, s68, v85
    v_mfma_f32_16x16x32_bf16 v[240:243], v[160:163], v[172:175], v[240:243]
    v_add_u32 v86, s68, v86
    v_mfma_f32_16x16x32_bf16 v[208:211], v[164:167], v[168:171], v[208:211]
    v_add_u32 v14, 64, v14
    v_mfma_f32_16x16x32_bf16 v[244:247], v[164:167], v[172:175], v[244:247]
    s_branch L_jP_cloop
L_jP_ctail:
    v_pk_sub_u16 v172, v172, v13 clamp
    v_pk_sub_u16 v173, v173, v13 clamp
    v_pk_sub_u16 v174, v174, v13 clamp
    v_pk_sub_u16 v175, v175, v13 clamp
    v_pk_sub_u16 v168, v168, v12 clamp
    v_pk_sub_u16 v169, v169, v12 clamp
    v_pk_sub_u16 v170, v170, v12 clamp
    v_pk_sub_u16 v171, v171, v12 clamp
    s_nop 0
    v_mfma_f32_16x16x32_bf16 v[212:215], v[132:135], v[172:175], v[212:215]
    s_mul_i32 s28, s3, 9216
    v_lshl_add_u32 v4, v0, 4, s28
    v_mfma_f32_16x16x32_bf16 v[216:219], v[136:139], v[172:175], v[216:219]
    s_xor_b32 s28, s3, 1
    s_mul_i32 s28, s28, 9216
    v_mfma_f32_16x16x32_bf16 v[220:223], v[140:143], v[172:175], v[220:223]
    v_lshl_add_u32 v7, v0, 4, s28
    v_lshlrev_b32 v6, 3, v0
    v_mfma_f32_16x16x32_bf16 v[224:227], v[144:147], v[172:175], v[224:227]
    v_add_u32 v6, 126976, v6
    v_lshlrev_b32 v5, 2, v2
    v_mfma_f32_16x16x32_bf16 v[228:231], v[148:151], v[172:175], v[228:231]
    v_sub_u32 v5, v1, v5
    v_cmp_eq_u32 s[30:31], 0, v5
    v_mfma_f32_16x16x32_bf16 v[232:235], v[152:155], v[172:175], v[232:235]
    v_cmp_eq_u32 s[32:33], 1, v5
    v_cmp_eq_u32 s[34:35], 2, v5
    v_mfma_f32_16x16x32_bf16 v[236:239], v[156:159], v[172:175], v[236:239]
    v_cmp_eq_u32 vcc, 3, v5
    s_mul_i32 s76, s74, 24576
    v_mfma_f32_16x16x32_bf16 v[240:243], v[160:163], v[172:175], v[240:243]
    s_add_u32 s76, s76, 41943040
    s_lshl_b32 s77, s74, 7
    v_mfma_f32_16x16x32_bf16 v[244:247], v[164:167], v[172:175], v[244:247]
    s_add_u32 s77, s77, 48234496
    v_mfma_f32_16x16x32_bf16 v[176:179], v[132:135], v[168:171], v[176:179]
    ds_write_b128 v4, v[212:215] offset:0
    v_mfma_f32_16x16x32_bf16 v[180:183], v[136:139], v[168:171], v[180:183]
    ds_write_b128 v4, v[216:219] offset:1024
    v_mfma_f32_16x16x32_bf16 v[184:187], v[140:143], v[168:171], v[184:187]
    ds_write_b128 v4, v[220:223] offset:2048
    v_mfma_f32_16x16x32_bf16 v[188:191], v[144:147], v[168:171], v[188:191]
    ds_write_b128 v4, v[224:227] offset:3072
    v_mfma_f32_16x16x32_bf16 v[192:195], v[148:151], v[168:171], v[192:195]
    ds_write_b128 v4, v[228:231] offset:4096
    v_mfma_f32_16x16x32_bf16 v[196:199], v[152:155], v[168:171], v[196:199]
    ds_write_b128 v4, v[232:235] offset:5120
    v_mfma_f32_16x16x32_bf16 v[200:203], v[156:159], v[168:171], v[200:203]
    ds_write_b128 v4, v[236:239] offset:6144
    v_mfma_f32_16x16x32_bf16 v[204:207], v[160:163], v[168:171], v[204:207]
    ds_write_b128 v4, v[240:243] offset:7168
    v_mfma_f32_16x16x32_bf16 v[208:211], v[164:167], v[168:171], v[208:211]
    ds_write_b128 v4, v[244:247] offset:8192
    s_mul_i32 s28, s72, 3072
    s_add_u32 s28, s28, s76
    s_lshl_b32 s29, s72, 2
    s_waitcnt lgkmcnt(0)
    s_barrier
    ds_read_b128 v[212:215], v7 offset:0
    ds_read_b128 v[216:219], v7 offset:1024
    ds_read_b128 v[220:223], v7 offset:2048
    ds_read_b128 v[224:227], v7 offset:3072
    ds_read2st64_b64 v[88:91], v6 offset0:0 offset1:1
    ds_read2st64_b64 v[92:95], v6 offset0:9 offset1:10
    ds_read2st64_b64 v[96:99], v6 offset0:18 offset1:19
    ds_read2st64_b64 v[100:103], v6 offset0:27 offset1:28
    ds_read2st64_b64 v[104:107], v6 offset0:36 offset1:37
    ds_read_b128 v[228:231], v7 offset:4096
    ds_read_b128 v[232:235], v7 offset:5120
    s_waitcnt lgkmcnt(10)
    v_add_f32 v176, v176, v212
    v_add_f32 v177, v177, v213
    v_add_f32 v178, v178, v214
    v_add_f32 v179, v179, v215
    v_lshlrev_b32 v72, 16, v16
    v_and_b32 v73, s71, v16
    v_lshlrev_b32 v74, 16, v17
    v_and_b32 v75, s71, v17
    v_fmac_f32 v72, v176, v36
    v_fmac_f32 v73, v177, v37
    v_fmac_f32 v74, v178, v38
    v_fmac_f32 v75, v179, v39
    v_cvt_pk_bf16_f32 v16, v72, v73
    v_cvt_pk_bf16_f32 v17, v74, v75
    s_waitcnt lgkmcnt(9)
    v_add_f32 v180, v180, v216
    v_add_f32 v181, v181, v217
    v_add_f32 v182, v182, v218
    v_add_f32 v183, v183, v219
    v_lshlrev_b32 v76, 16, v18
    v_and_b32 v77, s71, v18
    v_lshlrev_b32 v78, 16, v19
    v_and_b32 v79, s71, v19
    v_fmac_f32 v76, v180, v40
    v_fmac_f32 v77, v181, v41
    v_fmac_f32 v78, v182, v42
    v_fmac_f32 v79, v183, v43
    v_cvt_pk_bf16_f32 v18, v76, v77
    v_cvt_pk_bf16_f32 v19, v78, v79
    ds_read2st64_b64 v[108:111], v6 offset0:2 offset1:3
    ds_read2st64_b64 v[112:115], v6 offset0:11 offset1:12
    ds_read2st64_b64 v[116:119], v6 offset0:20 offset1:21
    ds_read2st64_b64 v[120:123], v6 offset0:29 offset1:30
    ds_read2st64_b64 v[124:127], v6 offset0:38 offset1:39
    ds_read_b128 v[236:239], v7 offset:6144
    ds_read_b128 v[240:243], v7 offset:7168
    s_waitcnt lgkmcnt(15)
    v_add_f32 v184, v184, v220
    v_add_f32 v185, v185, v221
    v_mfma_f32_16x16x32_bf16 v[148:151], v[80:83], v[16:19], 0
    v_add_f32 v186, v186, v222
    v_add_f32 v187, v187, v223
    v_lshlrev_b32 v72, 16, v20
    v_mfma_f32_16x16x32_bf16 v[152:155], v[16:19], v[16:19], 0
    v_and_b32 v73, s71, v20
    v_lshlrev_b32 v74, 16, v21
    v_and_b32 v75, s71, v21
    s_waitcnt lgkmcnt(13)
    v_mfma_f32_16x16x32_bf16 v[128:131], v[88:91], v[16:19], 0
    v_fmac_f32 v72, v184, v44
    v_fmac_f32 v73, v185, v45
    v_fmac_f32 v74, v186, v46
    s_waitcnt lgkmcnt(12)
    v_mfma_f32_16x16x32_bf16 v[132:135], v[92:95], v[16:19], 0
    v_fmac_f32 v75, v187, v47
    v_cvt_pk_bf16_f32 v20, v72, v73
    v_cvt_pk_bf16_f32 v21, v74, v75
    s_waitcnt lgkmcnt(11)
    v_mfma_f32_16x16x32_bf16 v[136:139], v[96:99], v[16:19], 0
    v_add_f32 v188, v188, v224
    v_add_f32 v189, v189, v225
    v_add_f32 v190, v190, v226
    s_waitcnt lgkmcnt(10)
    v_mfma_f32_16x16x32_bf16 v[140:143], v[100:103], v[16:19], 0
    v_add_f32 v191, v191, v227
    v_lshlrev_b32 v76, 16, v22
    v_and_b32 v77, s71, v22
    s_waitcnt lgkmcnt(9)
    v_mfma_f32_16x16x32_bf16 v[144:147], v[104:107], v[16:19], 0
    v_lshlrev_b32 v78, 16, v23
    v_and_b32 v79, s71, v23
    v_fmac_f32 v76, v188, v48
    v_fmac_f32 v77, v189, v49
    v_fmac_f32 v78, v190, v50
    v_fmac_f32 v79, v191, v51
    v_cvt_pk_bf16_f32 v22, v76, v77
    v_cvt_pk_bf16_f32 v23, v78, v79
    ds_read2st64_b64 v[88:91], v6 offset0:4 offset1:5
    ds_read2st64_b64 v[92:95], v6 offset0:13 offset1:14
    ds_read2st64_b64 v[96:99], v6 offset0:22 offset1:23
    ds_read2st64_b64 v[100:103], v6 offset0:31 offset1:32
    ds_read2st64_b64 v[104:107], v6 offset0:40 offset1:41
    ds_read_b128 v[244:247], v7 offset:8192
    s_waitcnt lgkmcnt(14)
    v_add_f32 v192, v192, v228
    v_add_f32 v193, v193, v229
    v_mfma_f32_16x16x32_bf16 v[148:151], v[80:83], v[20:23], v[148:151]
    v_add_f32 v194, v194, v230
    v_add_f32 v195, v195, v231
    v_lshlrev_b32 v72, 16, v24
    v_mfma_f32_16x16x32_bf16 v[152:155], v[20:23], v[20:23], v[152:155]
    v_and_b32 v73, s71, v24
    v_lshlrev_b32 v74, 16, v25
    v_and_b32 v75, s71, v25
    s_waitcnt lgkmcnt(12)
    v_mfma_f32_16x16x32_bf16 v[128:131], v[108:111], v[20:23], v[128:131]
    v_fmac_f32 v72, v192, v52
    v_fmac_f32 v73, v193, v53
    v_fmac_f32 v74, v194, v54
    s_waitcnt lgkmcnt(11)
    v_mfma_f32_16x16x32_bf16 v[132:135], v[112:115], v[20:23], v[132:135]
    v_fmac_f32 v75, v195, v55
    v_cvt_pk_bf16_f32 v24, v72, v73
    v_cvt_pk_bf16_f32 v25, v74, v75
    s_waitcnt lgkmcnt(10)
    v_mfma_f32_16x16x32_bf16 v[136:139], v[116:119], v[20:23], v[136:139]
    v_add_f32 v196, v196, v232
    v_add_f32 v197, v197, v233
    v_add_f32 v198, v198, v234
    s_waitcnt lgkmcnt(9)
    v_mfma_f32_16x16x32_bf16 v[140:143], v[120:123], v[20:23], v[140:143]
    v_add_f32 v199, v199, v235
    v_lshlrev_b32 v76, 16, v26
    v_and_b32 v77, s71, v26
    s_waitcnt lgkmcnt(8)
    v_mfma_f32_16x16x32_bf16 v[144:147], v[124:127], v[20:23], v[144:147]
    v_lshlrev_b32 v78, 16, v27
    v_and_b32 v79, s71, v27
    v_fmac_f32 v76, v196, v56
    v_fmac_f32 v77, v197, v57
    v_fmac_f32 v78, v198, v58
    v_fmac_f32 v79, v199, v59
    v_cvt_pk_bf16_f32 v26, v76, v77
    v_cvt_pk_bf16_f32 v27, v78, v79
    ds_read2st64_b64 v[108:111], v6 offset0:6 offset1:7
    ds_read2st64_b64 v[112:115], v6 offset0:15 offset1:16
    ds_read2st64_b64 v[116:119], v6 offset0:24 offset1:25
    ds_read2st64_b64 v[120:123], v6 offset0:33 offset1:34
    ds_read2st64_b64 v[124:127], v6 offset0:42 offset1:43
    s_waitcnt lgkmcnt(12)
    v_add_f32 v200, v200, v236
    v_add_f32 v201, v201, v237
    v_mfma_f32_16x16x32_bf16 v[148:151], v[80:83], v[24:27], v[148:151]
    v_add_f32 v202, v202, v238
    v_add_f32 v203, v203, v239
    v_lshlrev_b32 v72, 16, v28
    v_mfma_f32_16x16x32_bf16 v[152:155], v[24:27], v[24:27], v[152:155]
    v_and_b32 v73, s71, v28
    v_lshlrev_b32 v74, 16, v29
    v_and_b32 v75, s71, v29
    s_waitcnt lgkmcnt(10)
    v_mfma_f32_16x16x32_bf16 v[128:131], v[88:91], v[24:27], v[128:131]
    v_fmac_f32 v72, v200, v60
    v_fmac_f32 v73, v201, v61
    v_fmac_f32 v74, v202, v62
    s_waitcnt lgkmcnt(9)
    v_mfma_f32_16x16x32_bf16 v[132:135], v[92:95], v[24:27], v[132:135]
    v_fmac_f32 v75, v203, v63
    v_cvt_pk_bf16_f32 v28, v72, v73
    v_cvt_pk_bf16_f32 v29, v74, v75
    s_waitcnt lgkmcnt(8)
    v_mfma_f32_16x16x32_bf16 v[136:139], v[96:99], v[24:27], v[136:139]
    v_add_f32 v204, v204, v240
    v_add_f32 v205, v205, v241
    v_add_f32 v206, v206, v242
    s_waitcnt lgkmcnt(7)
    v_mfma_f32_16x16x32_bf16 v[140:143], v[100:103], v[24:27], v[140:143]
    v_add_f32 v207, v207, v243
    v_lshlrev_b32 v76, 16, v30
    v_and_b32 v77, s71, v30
    s_waitcnt lgkmcnt(6)
    v_mfma_f32_16x16x32_bf16 v[144:147], v[104:107], v[24:27], v[144:147]
    v_lshlrev_b32 v78, 16, v31
    v_and_b32 v79, s71, v31
    v_fmac_f32 v76, v204, v64
    v_fmac_f32 v77, v205, v65
    v_fmac_f32 v78, v206, v66
    v_fmac_f32 v79, v207, v67
    v_cvt_pk_bf16_f32 v30, v76, v77
    v_cvt_pk_bf16_f32 v31, v78, v79
    ds_read_b64 v[88:89], v6 offset:4096
    ds_read_b64 v[92:93], v6 offset:8704
    ds_read_b64 v[96:97], v6 offset:13312
    ds_read_b64 v[100:101], v6 offset:17920
    ds_read_b64 v[104:105], v6 offset:22528
    s_waitcnt lgkmcnt(10)
    v_add_f32 v208, v208, v244
    v_add_f32 v209, v209, v245
    v_mfma_f32_16x16x32_bf16 v[148:151], v[80:83], v[28:31], v[148:151]
    v_add_f32 v210, v210, v246
    v_add_f32 v211, v211, v247
    v_lshlrev_b32 v72, 16, v32
    v_mfma_f32_16x16x32_bf16 v[152:155], v[28:31], v[28:31], v[152:155]
    v_and_b32 v73, s71, v32
    v_lshlrev_b32 v74, 16, v33
    v_and_b32 v75, s71, v33
    s_waitcnt lgkmcnt(9)
    v_mfma_f32_16x16x32_bf16 v[128:131], v[108:111], v[28:31], v[128:131]
    v_fmac_f32 v72, v208, v68
    v_fmac_f32 v73, v209, v69
    v_fmac_f32 v74, v210, v70
    s_waitcnt lgkmcnt(8)
    v_mfma_f32_16x16x32_bf16 v[132:135], v[112:115], v[28:31], v[132:135]
    v_fmac_f32 v75, v211, v71
    v_cvt_pk_bf16_f32 v32, v72, v73
    v_cvt_pk_bf16_f32 v33, v74, v75
    s_waitcnt lgkmcnt(7)
    v_mfma_f32_16x16x32_bf16 v[136:139], v[116:119], v[28:31], v[136:139]
    s_waitcnt lgkmcnt(6)
    v_mfma_f32_16x16x32_bf16 v[140:143], v[120:123], v[28:31], v[140:143]
    s_waitcnt lgkmcnt(5)
    v_mfma_f32_16x16x32_bf16 v[144:147], v[124:127], v[28:31], v[144:147]
    s_nop 1
    v_mfma_f32_16x16x32_bf16 v[148:151], v[80:83], v[32:35], v[148:151]
    v_mfma_f32_16x16x32_bf16 v[152:155], v[32:35], v[32:35], v[152:155]
    s_waitcnt lgkmcnt(4)
    v_mfma_f32_16x16x32_bf16 v[128:131], v[88:91], v[32:35], v[128:131]
    s_waitcnt lgkmcnt(3)
    v_mfma_f32_16x16x32_bf16 v[132:135], v[92:95], v[32:35], v[132:135]
    s_waitcnt lgkmcnt(2)
    v_mfma_f32_16x16x32_bf16 v[136:139], v[96:99], v[32:35], v[136:139]
    s_waitcnt lgkmcnt(1)
    v_mfma_f32_16x16x32_bf16 v[140:143], v[100:103], v[32:35], v[140:143]
    s_waitcnt lgkmcnt(0)
    v_mfma_f32_16x16x32_bf16 v[144:147], v[104:107], v[32:35], v[144:147]
    v_lshlrev_b32 v4, 4, v0
    v_mov_b32 v5, s29
    v_mov_b32 v6, 0x3f80
    v_mov_b32 v7, 0x3f800000
    v_mov_b32 v166, v148
    v_cndmask_b32 v167, 0, v152, s[30:31]
    v_cndmask_b32 v167, v167, v153, s[32:33]
    v_cndmask_b32 v167, v167, v154, s[34:35]
    v_cndmask_b32 v167, v167, v155, vcc
    v_cvt_pk_bf16_f32 v156, v128, v129
    v_cvt_pk_bf16_f32 v157, v130, v131
    v_cvt_pk_bf16_f32 v158, v132, v133
    v_cvt_pk_bf16_f32 v159, v134, v135
    buffer_store_dwordx4 v[156:159], v4, s[16:19], s28 offen offset:0 sc1
    v_cvt_pk_bf16_f32 v160, v136, v137
    v_cvt_pk_bf16_f32 v161, v138, v139
    v_cvt_pk_bf16_f32 v162, v140, v141
    v_cvt_pk_bf16_f32 v163, v142, v143
    buffer_store_dwordx4 v[160:163], v4, s[16:19], s28 offen offset:1024 sc1
    v_cvt_pk_bf16_f32 v164, v144, v145
    v_cvt_pk_bf16_f32 v165, v146, v147
    buffer_store_dwordx4 v[164:167], v4, s[16:19], s28 offen offset:2048 sc1
    s_barrier
    v_cndmask_b32 v168, 0, v6, s[30:31]
    v_cndmask_b32 v168, v168, v7, s[32:33]
    v_cndmask_b32 v169, 0, v6, s[34:35]
    v_cndmask_b32 v169, v169, v7, vcc
    v_mov_b32 v170, 0
    v_mov_b32 v171, 0
    v_mov_b32 v172, 0
    v_mov_b32 v173, 0
    v_mov_b32 v174, v168
    v_mov_b32 v175, v169
    s_mov_b32 s20, s54
    s_mov_b32 s21, s55
    s_mov_b32 s22, 4718592
    s_mov_b32 s23, 0x20000
    v_add_u32 v6, 0, v0
    v_mul_u32_u24 v7, 3641, v6
    v_lshrrev_b32 v7, 16, v7
    v_lshlrev_b32 v6, 4, v6
    v_add_u32 v88, s75, v6
    v_mul_u32_u24 v7, 2016, v7
    v_add_u32 v93, v7, v6
    v_add_u32 v6, 64, v0
    v_mul_u32_u24 v7, 3641, v6
    v_lshrrev_b32 v7, 16, v7
    v_lshlrev_b32 v6, 4, v6
    v_add_u32 v89, s75, v6
    v_mul_u32_u24 v7, 2016, v7
    v_add_u32 v94, v7, v6
    v_add_u32 v6, 128, v0
    v_mul_u32_u24 v7, 3641, v6
    v_lshrrev_b32 v7, 16, v7
    v_lshlrev_b32 v6, 4, v6
    v_add_u32 v90, s75, v6
    v_mul_u32_u24 v7, 2016, v7
    v_add_u32 v95, v7, v6
    v_add_u32 v6, 192, v0
    v_mul_u32_u24 v7, 3641, v6
    v_lshrrev_b32 v7, 16, v7
    v_lshlrev_b32 v6, 4, v6
    v_add_u32 v91, s75, v6
    v_mul_u32_u24 v7, 2016, v7
    v_add_u32 v96, v7, v6
    v_add_u32 v6, 256, v0
    v_min_u32 v6, 287, v6
    v_mul_u32_u24 v7, 3641, v6
    v_lshrrev_b32 v7, 16, v7
    v_lshlrev_b32 v6, 4, v6
    v_add_u32 v92, s75, v6
    v_mul_u32_u24 v7, 2016, v7
    v_add_u32 v97, v7, v6
    v_mov_b32 v120, v166
    v_mov_b32 v121, v167
    v_mov_b32 v7, 1
    s_mov_b64 exec, 1
    s_waitcnt vmcnt(0) lgkmcnt(0)
    buffer_store_dword v7, v5, s[16:19], s77 offen sc1
    s_mov_b64 exec, -1
    s_barrier
    v_lshlrev_b32 v6, 3, v0
    v_add_u32 v10, 53248, v6
    v_lshlrev_b32 v6, 4, v2
    v_add_u32 v6, 159808, v6
    ds_read_b128 v[100:103], v6 offset:0
    ds_read_b128 v[104:107], v6 offset:64
    ds_read_b128 v[108:111], v6 offset:128
    ds_read_b128 v[112:115], v6 offset:192
    ds_read_b128 v[116:119], v6 offset:256
    ds_read2st64_b64 v[36:39], v10 offset0:0 offset1:1
    ds_read2st64_b64 v[40:43], v10 offset0:2 offset1:3
    ds_read_b64 v[44:45], v10 offset:2048
    v_mov_b32 v46, 0
    v_mov_b32 v47, 0
    ds_read2st64_b64 v[48:51], v10 offset0:5 offset1:6
    ds_read2st64_b64 v[52:55], v10 offset0:7 offset1:8
    ds_read_b64 v[56:57], v10 offset:4608
    v_mov_b32 v58, 0
    v_mov_b32 v59, 0
    s_waitcnt lgkmcnt(6)
    v_and_b32 v5, 7, v0
    v_lshlrev_b32 v5, 2, v5
    s_mov_b32 s29, 0
L_jP_poll:
    buffer_load_dword v6, v5, s[16:19], s77 offen sc1
    s_add_u32 s29, s29, 1
    s_waitcnt vmcnt(0)
    v_cmp_eq_u32 vcc, 0, v6
    s_cmp_gt_u32 s29, 0x100000
    s_cbranch_scc1 L_jP_got
    s_cbranch_vccnz L_jP_poll
L_jP_got:
    s_add_u32 s28, s72, 1
    s_and_b32 s28, s28, 7
    s_mul_i32 s28, s28, 3072
    s_add_u32 s28, s28, s76
    buffer_load_dwordx4 v[176:179], v4, s[16:19], s28 offen offset:0 sc1
    buffer_load_dwordx4 v[180:183], v4, s[16:19], s28 offen offset:1024 sc1
    buffer_load_dwordx4 v[184:187], v4, s[16:19], s28 offen offset:2048 sc1
    s_add_u32 s28, s72, 2
    s_and_b32 s28, s28, 7
    s_mul_i32 s28, s28, 3072
    s_add_u32 s28, s28, s76
    buffer_load_dwordx4 v[188:191], v4, s[16:19], s28 offen offset:0 sc1
    buffer_load_dwordx4 v[192:195], v4, s[16:19], s28 offen offset:1024 sc1
    buffer_load_dwordx4 v[196:199], v4, s[16:19], s28 offen offset:2048 sc1
    s_add_u32 s28, s72, 3
    s_and_b32 s28, s28, 7
    s_mul_i32 s28, s28, 3072
    s_add_u32 s28, s28, s76
    buffer_load_dwordx4 v[200:203], v4, s[16:19], s28 offen offset:0 sc1
    buffer_load_dwordx4 v[204:207], v4, s[16:19], s28 offen offset:1024 sc1
    buffer_load_dwordx4 v[208:211], v4, s[16:19], s28 offen offset:2048 sc1
    s_add_u32 s28, s72, 4
    s_and_b32 s28, s28, 7
    s_mul_i32 s28, s28, 3072
    s_add_u32 s28, s28, s76
    buffer_load_dwordx4 v[212:215], v4, s[16:19], s28 offen offset:0 sc1
    buffer_load_dwordx4 v[216:219], v4, s[16:19], s28 offen offset:1024 sc1
    buffer_load_dwordx4 v[220:223], v4, s[16:19], s28 offen offset:2048 sc1
    s_add_u32 s28, s72, 5
    s_and_b32 s28, s28, 7
    s_mul_i32 s28, s28, 3072
    s_add_u32 s28, s28, s76
    buffer_load_dwordx4 v[224:227], v4, s[16:19], s28 offen offset:0 sc1
    buffer_load_dwordx4 v[228:231], v4, s[16:19], s28 offen offset:1024 sc1
    buffer_load_dwordx4 v[232:235], v4, s[16:19], s28 offen offset:2048 sc1
    s_add_u32 s28, s72, 6
    s_and_b32 s28, s28, 7
    s_mul_i32 s28, s28, 3072
    s_add_u32 s28, s28, s76
    buffer_load_dwordx4 v[236:239], v4, s[16:19], s28 offen offset:0 sc1
    buffer_load_dwordx4 v[240:243], v4, s[16:19], s28 offen offset:1024 sc1
    buffer_load_dwordx4 v[244:247], v4, s[16:19], s28 offen offset:2048 sc1
    s_add_u32 s28, s72, 7
    s_and_b32 s28, s28, 7
    s_mul_i32 s28, s28, 3072
    s_add_u32 s28, s28, s76
    buffer_load_dwordx4 v[60:63], v4, s[16:19], s28 offen offset:0 sc1
    buffer_load_dwordx4 v[64:67], v4, s[16:19], s28 offen offset:1024 sc1
    buffer_load_dwordx4 v[68:71], v4, s[16:19], s28 offen offset:2048 sc1
    s_waitcnt vmcnt(18)
    v_pk_add_f32 v[120:121], v[120:121], v[186:187]
    v_mov_b32 v186, 0
    v_mov_b32 v187, 0
    v_mfma_f32_16x16x32_bf16 v[128:131], v[168:171], v[176:179], v[128:131]
    v_mfma_f32_16x16x32_bf16 v[132:135], v[172:175], v[176:179], v[132:135]
    v_mfma_f32_16x16x32_bf16 v[136:139], v[168:171], v[180:183], v[136:139]
    v_mfma_f32_16x16x32_bf16 v[140:143], v[172:175], v[180:183], v[140:143]
    v_mfma_f32_16x16x32_bf16 v[144:147], v[168:171], v[184:187], v[144:147]
    s_waitcnt vmcnt(15)
    v_pk_add_f32 v[120:121], v[120:121], v[198:199]
    v_mov_b32 v198, 0
    v_mov_b32 v199, 0
    v_mfma_f32_16x16x32_bf16 v[128:131], v[168:171], v[188:191], v[128:131]
    v_mfma_f32_16x16x32_bf16 v[132:135], v[172:175], v[188:191], v[132:135]
    v_mfma_f32_16x16x32_bf16 v[136:139], v[168:171], v[192:195], v[136:139]
    v_mfma_f32_16x16x32_bf16 v[140:143], v[172:175], v[192:195], v[140:143]
    v_mfma_f32_16x16x32_bf16 v[144:147], v[168:171], v[196:199], v[144:147]
    ds_read2st64_b64 v[176:179], v10 offset0:10 offset1:11
    ds_read2st64_b64 v[180:183], v10 offset0:12 offset1:13
    ds_read_b64 v[184:185], v10 offset:7168
    s_waitcnt vmcnt(12)
    v_pk_add_f32 v[120:121], v[120:121], v[210:211]
    v_mov_b32 v210, 0
    v_mov_b32 v211, 0
    v_mfma_f32_16x16x32_bf16 v[128:131], v[168:171], v[200:203], v[128:131]
    v_mfma_f32_16x16x32_bf16 v[132:135], v[172:175], v[200:203], v[132:135]
    v_mfma_f32_16x16x32_bf16 v[136:139], v[168:171], v[204:207], v[136:139]
    v_mfma_f32_16x16x32_bf16 v[140:143], v[172:175], v[204:207], v[140:143]
    v_mfma_f32_16x16x32_bf16 v[144:147], v[168:171], v[208:211], v[144:147]
    ds_read2st64_b64 v[188:191], v10 offset0:15 offset1:16
    ds_read2st64_b64 v[192:195], v10 offset0:17 offset1:18
    ds_read_b64 v[196:197], v10 offset:9728
    s_waitcnt vmcnt(9)
    v_pk_add_f32 v[120:121], v[120:121], v[222:223]
    v_mov_b32 v222, 0
    v_mov_b32 v223, 0
    v_mfma_f32_16x16x32_bf16 v[128:131], v[168:171], v[212:215], v[128:131]
    v_mfma_f32_16x16x32_bf16 v[132:135], v[172:175], v[212:215], v[132:135]
    v_mfma_f32_16x16x32_bf16 v[136:139], v[168:171], v[216:219], v[136:139]
    v_mfma_f32_16x16x32_bf16 v[140:143], v[172:175], v[216:219], v[140:143]
    v_mfma_f32_16x16x32_bf16 v[144:147], v[168:171], v[220:223], v[144:147]
    ds_read2st64_b64 v[200:203], v10 offset0:20 offset1:21
    ds_read2st64_b64 v[204:207], v10 offset0:22 offset1:23
    ds_read_b64 v[208:209], v10 offset:12288
    s_waitcnt vmcnt(6)
    v_pk_add_f32 v[120:121], v[120:121], v[234:235]
    v_mov_b32 v234, 0
    v_mov_b32 v235, 0
    v_mfma_f32_16x16x32_bf16 v[128:131], v[168:171], v[224:227], v[128:131]
    v_mfma_f32_16x16x32_bf16 v[132:135], v[172:175], v[224:227], v[132:135]
    v_mfma_f32_16x16x32_bf16 v[136:139], v[168:171], v[228:231], v[136:139]
    v_mfma_f32_16x16x32_bf16 v[140:143], v[172:175], v[228:231], v[140:143]
    v_mfma_f32_16x16x32_bf16 v[144:147], v[168:171], v[232:235], v[144:147]
    s_waitcnt vmcnt(3)
    v_pk_add_f32 v[120:121], v[120:121], v[246:247]
    v_mov_b32 v246, 0
    v_mov_b32 v247, 0
    v_mfma_f32_16x16x32_bf16 v[128:131], v[168:171], v[236:239], v[128:131]
    v_mfma_f32_16x16x32_bf16 v[132:135], v[172:175], v[236:239], v[132:135]
    v_mfma_f32_16x16x32_bf16 v[136:139], v[168:171], v[240:243], v[136:139]
    v_mfma_f32_16x16x32_bf16 v[140:143], v[172:175], v[240:243], v[140:143]
    v_mfma_f32_16x16x32_bf16 v[144:147], v[168:171], v[244:247], v[144:147]
    s_waitcnt vmcnt(0)
    v_pk_add_f32 v[120:121], v[120:121], v[70:71]
    v_mov_b32 v70, 0
    v_mov_b32 v71, 0
    v_mfma_f32_16x16x32_bf16 v[128:131], v[168:171], v[60:63], v[128:131]
    v_mfma_f32_16x16x32_bf16 v[132:135], v[172:175], v[60:63], v[132:135]
    v_mfma_f32_16x16x32_bf16 v[136:139], v[168:171], v[64:67], v[136:139]
    v_mfma_f32_16x16x32_bf16 v[140:143], v[172:175], v[64:67], v[140:143]
    v_mfma_f32_16x16x32_bf16 v[144:147], v[168:171], v[68:71], v[144:147]
    v_mov_b32 v122, v121
    s_nop 1
    v_permlane16_swap_b32 v121, v122
    v_add_f32 v121, v121, v122
    v_mov_b32 v122, v121
    s_nop 1
    v_permlane32_swap_b32 v121, v122
    v_add_f32 v121, v121, v122
    v_mul_f32 v120, 0.0008680555555555555, v120
    v_mov_b32 v122, 0x3727c5ac
    v_fmac_f32 v122, 0.0008680555555555555, v121
    v_fma_f32 v122, -v120, v120, v122
    v_max_f32 v122, 0x3727c5ac, v122
    v_rsq_f32 v122, v122
    v_pk_fma_f32 v[128:129], v[100:101], v[120:121], v[128:129] op_sel_hi:[1,0,1] neg_lo:[1,0,0] neg_hi:[1,0,0]
    v_pk_fma_f32 v[130:131], v[102:103], v[120:121], v[130:131] op_sel_hi:[1,0,1] neg_lo:[1,0,0] neg_hi:[1,0,0]
    v_pk_fma_f32 v[132:133], v[104:105], v[120:121], v[132:133] op_sel_hi:[1,0,1] neg_lo:[1,0,0] neg_hi:[1,0,0]
    v_pk_fma_f32 v[134:135], v[106:107], v[120:121], v[134:135] op_sel_hi:[1,0,1] neg_lo:[1,0,0] neg_hi:[1,0,0]
    v_pk_fma_f32 v[136:137], v[108:109], v[120:121], v[136:137] op_sel_hi:[1,0,1] neg_lo:[1,0,0] neg_hi:[1,0,0]
    v_pk_fma_f32 v[138:139], v[110:111], v[120:121], v[138:139] op_sel_hi:[1,0,1] neg_lo:[1,0,0] neg_hi:[1,0,0]
    v_pk_fma_f32 v[140:141], v[112:113], v[120:121], v[140:141] op_sel_hi:[1,0,1] neg_lo:[1,0,0] neg_hi:[1,0,0]
    v_pk_fma_f32 v[142:143], v[114:115], v[120:121], v[142:143] op_sel_hi:[1,0,1] neg_lo:[1,0,0] neg_hi:[1,0,0]
    v_pk_fma_f32 v[144:145], v[116:117], v[120:121], v[144:145] op_sel_hi:[1,0,1] neg_lo:[1,0,0] neg_hi:[1,0,0]
    v_pk_fma_f32 v[146:147], v[118:119], v[120:121], v[146:147] op_sel_hi:[1,0,1] neg_lo:[1,0,0] neg_hi:[1,0,0]
    v_mul_f32 v122, 0.042505810274866225, v122
    s_mov_b32 s30, 0
    s_mov_b32 s31, 0xffff0000
    v_mov_b32 v5, 0xff800000
    v_cndmask_b32 v145, v145, v5, s[30:31]
    v_cndmask_b32 v146, v146, v5, s[30:31]
    v_cndmask_b32 v147, v147, v5, s[30:31]
    v_max3_f32 v120, v128, v129, v130
    v_max3_f32 v120, v120, v131, v132
    v_max3_f32 v120, v120, v133, v134
    v_max3_f32 v120, v120, v135, v136
    v_max3_f32 v120, v120, v137, v138
    v_max3_f32 v120, v120, v139, v140
    v_max3_f32 v120, v120, v141, v142
    v_max3_f32 v120, v120, v143, v144
    v_max3_f32 v120, v120, v145, v146
    v_max_f32 v120, v120, v147
    v_mov_b32 v121, v120
    s_nop 1
    v_permlane16_swap_b32 v120, v121
    v_max_f32 v120, v120, v121
    v_mov_b32 v121, v120
    s_nop 1
    v_permlane32_swap_b32 v120, v121
    v_max_f32 v120, v120, v121
    ds_read2st64_b64 v[212:215], v10 offset0:25 offset1:26
    ds_read2st64_b64 v[216:219], v10 offset0:27 offset1:28
    ds_read_b64 v[220:221], v10 offset:14848
    ds_read2st64_b64 v[224:227], v10 offset0:30 offset1:31
    ds_read2st64_b64 v[228:231], v10 offset0:32 offset1:33
    ds_read_b64 v[232:233], v10 offset:17408
    v_mul_f32 v120, v120, v122
    v_pk_fma_f32 v[128:129], v[128:129], v[122:123], v[120:121] op_sel_hi:[1,0,0] neg_lo:[0,0,1] neg_hi:[0,0,1]
    v_pk_fma_f32 v[130:131], v[130:131], v[122:123], v[120:121] op_sel_hi:[1,0,0] neg_lo:[0,0,1] neg_hi:[0,0,1]
    v_pk_fma_f32 v[132:133], v[132:133], v[122:123], v[120:121] op_sel_hi:[1,0,0] neg_lo:[0,0,1] neg_hi:[0,0,1]
    v_pk_fma_f32 v[134:135], v[134:135], v[122:123], v[120:121] op_sel_hi:[1,0,0] neg_lo:[0,0,1] neg_hi:[0,0,1]
    v_pk_fma_f32 v[136:137], v[136:137], v[122:123], v[120:121] op_sel_hi:[1,0,0] neg_lo:[0,0,1] neg_hi:[0,0,1]
    v_pk_fma_f32 v[138:139], v[138:139], v[122:123], v[120:121] op_sel_hi:[1,0,0] neg_lo:[0,0,1] neg_hi:[0,0,1]
    v_pk_fma_f32 v[140:141], v[140:141], v[122:123], v[120:121] op_sel_hi:[1,0,0] neg_lo:[0,0,1] neg_hi:[0,0,1]
    v_pk_fma_f32 v[142:143], v[142:143], v[122:123], v[120:121] op_sel_hi:[1,0,0] neg_lo:[0,0,1] neg_hi:[0,0,1]
    v_pk_fma_f32 v[144:145], v[144:145], v[122:123], v[120:121] op_sel_hi:[1,0,0] neg_lo:[0,0,1] neg_hi:[0,0,1]
    v_pk_fma_f32 v[146:147], v[146:147], v[122:123], v[120:121] op_sel_hi:[1,0,0] neg_lo:[0,0,1] neg_hi:[0,0,1]
    v_exp_f32 v128, v128
    v_exp_f32 v129, v129
    v_exp_f32 v130, v130
    v_exp_f32 v131, v131
    v_exp_f32 v132, v132
    v_exp_f32 v133, v133
    v_exp_f32 v134, v134
    v_exp_f32 v135, v135
    v_exp_f32 v136, v136
    v_exp_f32 v137, v137
    v_exp_f32 v138, v138
    v_exp_f32 v139, v139
    v_exp_f32 v140, v140
    v_exp_f32 v141, v141
    v_exp_f32 v142, v142
    v_exp_f32 v143, v143
    v_exp_f32 v144, v144
    v_exp_f32 v145, v145
    v_exp_f32 v146, v146
    v_exp_f32 v147, v147
    v_mov_b32 v166, 0
    v_mov_b32 v167, 0
    v_cvt_pk_bf16_f32 v156, v128, v129
    v_cvt_pk_bf16_f32 v157, v130, v131
    v_cvt_pk_bf16_f32 v158, v132, v133
    v_cvt_pk_bf16_f32 v159, v134, v135
    v_cvt_pk_bf16_f32 v160, v136, v137
    v_cvt_pk_bf16_f32 v161, v138, v139
    v_cvt_pk_bf16_f32 v162, v140, v141
    v_cvt_pk_bf16_f32 v163, v142, v143
    v_cvt_pk_bf16_f32 v164, v144, v145
    v_cvt_pk_bf16_f32 v165, v146, v147
    ds_read2st64_b64 v[236:239], v10 offset0:35 offset1:36
    ds_read2st64_b64 v[240:243], v10 offset0:37 offset1:38
    ds_read_b64 v[244:245], v10 offset:19968
    ds_read2st64_b64 v[60:63], v10 offset0:40 offset1:41
    ds_read2st64_b64 v[64:67], v10 offset0:42 offset1:43
    ds_read_b64 v[68:69], v10 offset:22528
    v_mfma_f32_16x16x32_bf16 v[124:127], v[80:83], v[156:159], 0
    v_mfma_f32_16x16x32_bf16 v[124:127], v[80:83], v[160:163], v[124:127]
    v_mfma_f32_16x16x32_bf16 v[124:127], v[80:83], v[164:167], v[124:127]
    s_mul_i32 s28, s74, 36864
    s_mul_i32 s29, s72, 288
    s_add_u32 s28, s28, s29
    s_waitcnt lgkmcnt(15)
    v_mfma_f32_16x16x32_bf16 v[128:131], v[36:39], v[156:159], 0
    v_mfma_f32_16x16x32_bf16 v[128:131], v[40:43], v[160:163], v[128:131]
    v_mfma_f32_16x16x32_bf16 v[128:131], v[44:47], v[164:167], v[128:131]
    v_mfma_f32_16x16x32_bf16 v[132:135], v[48:51], v[156:159], 0
    v_mfma_f32_16x16x32_bf16 v[132:135], v[52:55], v[160:163], v[132:135]
    v_mfma_f32_16x16x32_bf16 v[132:135], v[56:59], v[164:167], v[132:135]
    v_mfma_f32_16x16x32_bf16 v[136:139], v[176:179], v[156:159], 0
    v_mfma_f32_16x16x32_bf16 v[136:139], v[180:183], v[160:163], v[136:139]
    v_mfma_f32_16x16x32_bf16 v[136:139], v[184:187], v[164:167], v[136:139]
    v_rcp_f32 v120, v124
    v_mfma_f32_16x16x32_bf16 v[140:143], v[188:191], v[156:159], 0
    v_lshlrev_b32 v72, 16, v16
    v_and_b32 v73, s71, v16
    v_lshlrev_b32 v74, 16, v17
    v_and_b32 v75, s71, v17
    v_mfma_f32_16x16x32_bf16 v[140:143], v[192:195], v[160:163], v[140:143]
    v_fmac_f32 v72, v128, v120
    v_fmac_f32 v73, v129, v120
    v_fmac_f32 v74, v130, v120
    v_fmac_f32 v75, v131, v120
    v_mfma_f32_16x16x32_bf16 v[140:143], v[196:199], v[164:167], v[140:143]
    v_cvt_pk_bf16_f32 v16, v72, v73
    v_cvt_pk_bf16_f32 v17, v74, v75
    ds_write_b64 v15, v[16:17] offset:0
    s_waitcnt lgkmcnt(15)
    v_mfma_f32_16x16x32_bf16 v[144:147], v[200:203], v[156:159], 0
    v_lshlrev_b32 v76, 16, v18
    v_and_b32 v77, s71, v18
    v_lshlrev_b32 v78, 16, v19
    v_and_b32 v79, s71, v19
    s_waitcnt lgkmcnt(14)
    v_mfma_f32_16x16x32_bf16 v[144:147], v[204:207], v[160:163], v[144:147]
    v_fmac_f32 v76, v132, v120
    v_fmac_f32 v77, v133, v120
    v_fmac_f32 v78, v134, v120
    v_fmac_f32 v79, v135, v120
    s_waitcnt lgkmcnt(13)
    v_mfma_f32_16x16x32_bf16 v[144:147], v[208:211], v[164:167], v[144:147]
    v_cvt_pk_bf16_f32 v18, v76, v77
    v_cvt_pk_bf16_f32 v19, v78, v79
    ds_write_b64 v15, v[18:19] offset:32
    s_waitcnt lgkmcnt(13)
    v_mfma_f32_16x16x32_bf16 v[100:103], v[212:215], v[156:159], 0
    v_lshlrev_b32 v72, 16, v20
    v_and_b32 v73, s71, v20
    v_lshlrev_b32 v74, 16, v21
    v_and_b32 v75, s71, v21
    s_waitcnt lgkmcnt(12)
    v_mfma_f32_16x16x32_bf16 v[100:103], v[216:219], v[160:163], v[100:103]
    v_fmac_f32 v72, v136, v120
    v_fmac_f32 v73, v137, v120
    v_fmac_f32 v74, v138, v120
    v_fmac_f32 v75, v139, v120
    s_waitcnt lgkmcnt(11)
    v_mfma_f32_16x16x32_bf16 v[100:103], v[220:223], v[164:167], v[100:103]
    v_cvt_pk_bf16_f32 v20, v72, v73
    v_cvt_pk_bf16_f32 v21, v74, v75
    ds_write_b64 v15, v[20:21] offset:64
    s_waitcnt lgkmcnt(11)
    v_mfma_f32_16x16x32_bf16 v[104:107], v[224:227], v[156:159], 0
    v_lshlrev_b32 v76, 16, v22
    v_and_b32 v77, s71, v22
    v_lshlrev_b32 v78, 16, v23
    v_and_b32 v79, s71, v23
    s_waitcnt lgkmcnt(10)
    v_mfma_f32_16x16x32_bf16 v[104:107], v[228:231], v[160:163], v[104:107]
    v_fmac_f32 v76, v140, v120
    v_fmac_f32 v77, v141, v120
    v_fmac_f32 v78, v142, v120
    v_fmac_f32 v79, v143, v120
    s_waitcnt lgkmcnt(9)
    v_mfma_f32_16x16x32_bf16 v[104:107], v[232:235], v[164:167], v[104:107]
    v_cvt_pk_bf16_f32 v22, v76, v77
    v_cvt_pk_bf16_f32 v23, v78, v79
    ds_write_b64 v15, v[22:23] offset:96
    s_waitcnt lgkmcnt(9)
    v_mfma_f32_16x16x32_bf16 v[108:111], v[236:239], v[156:159], 0
    v_lshlrev_b32 v72, 16, v24
    v_and_b32 v73, s71, v24
    v_lshlrev_b32 v74, 16, v25
    v_and_b32 v75, s71, v25
    s_waitcnt lgkmcnt(8)
    v_mfma_f32_16x16x32_bf16 v[108:111], v[240:243], v[160:163], v[108:111]
    v_fmac_f32 v72, v144, v120
    v_fmac_f32 v73, v145, v120
    v_fmac_f32 v74, v146, v120
    v_fmac_f32 v75, v147, v120
    s_waitcnt lgkmcnt(7)
    v_mfma_f32_16x16x32_bf16 v[108:111], v[244:247], v[164:167], v[108:111]
    v_cvt_pk_bf16_f32 v24, v72, v73
    v_cvt_pk_bf16_f32 v25, v74, v75
    ds_write_b64 v15, v[24:25] offset:128
    s_waitcnt lgkmcnt(7)
    v_mfma_f32_16x16x32_bf16 v[112:115], v[60:63], v[156:159], 0
    v_lshlrev_b32 v76, 16, v26
    v_and_b32 v77, s71, v26
    v_lshlrev_b32 v78, 16, v27
    v_and_b32 v79, s71, v27
    s_waitcnt lgkmcnt(6)
    v_mfma_f32_16x16x32_bf16 v[112:115], v[64:67], v[160:163], v[112:115]
    v_fmac_f32 v76, v100, v120
    v_fmac_f32 v77, v101, v120
    v_fmac_f32 v78, v102, v120
    v_fmac_f32 v79, v103, v120
    s_waitcnt lgkmcnt(5)
    v_mfma_f32_16x16x32_bf16 v[112:115], v[68:71], v[164:167], v[112:115]
    v_cvt_pk_bf16_f32 v26, v76, v77
    v_cvt_pk_bf16_f32 v27, v78, v79
    ds_write_b64 v15, v[26:27] offset:160
    v_lshlrev_b32 v72, 16, v28
    v_and_b32 v73, s71, v28
    v_lshlrev_b32 v74, 16, v29
    v_and_b32 v75, s71, v29
    v_fmac_f32 v72, v104, v120
    v_fmac_f32 v73, v105, v120
    v_fmac_f32 v74, v106, v120
    v_fmac_f32 v75, v107, v120
    v_cvt_pk_bf16_f32 v28, v72, v73
    v_cvt_pk_bf16_f32 v29, v74, v75
    ds_write_b64 v15, v[28:29] offset:192
    v_lshlrev_b32 v76, 16, v30
    v_and_b32 v77, s71, v30
    v_lshlrev_b32 v78, 16, v31
    v_and_b32 v79, s71, v31
    v_fmac_f32 v76, v108, v120
    v_fmac_f32 v77, v109, v120
    v_fmac_f32 v78, v110, v120
    v_fmac_f32 v79, v111, v120
    v_cvt_pk_bf16_f32 v30, v76, v77
    v_cvt_pk_bf16_f32 v31, v78, v79
    ds_write_b64 v15, v[30:31] offset:224
    v_lshlrev_b32 v72, 16, v32
    v_and_b32 v73, s71, v32
    v_lshlrev_b32 v74, 16, v33
    v_and_b32 v75, s71, v33
    v_fmac_f32 v72, v112, v120
    v_fmac_f32 v73, v113, v120
    v_fmac_f32 v74, v114, v120
    v_fmac_f32 v75, v115, v120
    v_cvt_pk_bf16_f32 v32, v72, v73
    v_cvt_pk_bf16_f32 v33, v74, v75
    ds_write_b64 v15, v[32:33] offset:256
    s_waitcnt lgkmcnt(0)
    ds_read_b128 v[176:179], v88
    ds_read_b128 v[180:183], v89
    ds_read_b128 v[184:187], v90
    ds_read_b128 v[188:191], v91
    ds_read_b128 v[192:195], v92
    s_waitcnt lgkmcnt(4)
    buffer_store_dwordx4 v[176:179], v93, s[20:23], s28 offen sc1
    s_waitcnt lgkmcnt(3)
    buffer_store_dwordx4 v[180:183], v94, s[20:23], s28 offen sc1
    s_waitcnt lgkmcnt(2)
    buffer_store_dwordx4 v[184:187], v95, s[20:23], s28 offen sc1
    s_waitcnt lgkmcnt(1)
    buffer_store_dwordx4 v[188:191], v96, s[20:23], s28 offen sc1
    s_waitcnt lgkmcnt(0)
    s_mov_b32 exec_hi, 0
    buffer_store_dwordx4 v[192:195], v97, s[20:23], s28 offen sc1
    s_endpgm
L_jP_ld:
    s_sub_u32 s60, s3, 4
    s_mul_i32 s28, s5, 18432
    s_mul_i32 s29, s60, 9216
    s_add_u32 s28, s28, s29
    s_add_u32 s28, s28, 23068672
    v_lshl_add_u32 v8, v0, 4, s28
    s_mov_b32 s61, s29
    v_add_u32 v9, 4096, v8
    v_add_u32 v10, 8192, v8
    s_mul_i32 s28, s6, 8192
    s_mul_i32 s29, s60, 4096
    s_add_u32 s28, s28, s29
    s_add_u32 s28, s28, 28311552
    v_lshl_add_u32 v11, v0, 4, s28
    s_add_u32 s62, s29, 18432
    s_mov_b32 s63, 0
    s_mov_b32 s64, 0
    s_mov_b32 s66, 0
    s_mov_b32 s67, 0
    s_mov_b32 s69, 26624
    s_waitcnt lgkmcnt(0)
    s_mov_b32 s16, s58
    s_mov_b32 s17, s59
    s_mov_b32 s18, 50331648
    s_mov_b32 s19, 0x20000
    s_mov_b32 s20, s36
    s_mov_b32 s21, s37
    s_mov_b32 s22, 4718592
    s_mov_b32 s23, 0x20000
    s_mul_i32 s28, s60, 576
    v_add_u32 v4, s28, v0
    s_mul_i32 s29, s6, 147456
    s_mul_i32 s30, s72, 288
    s_add_u32 s29, s29, s30
    s_mul_i32 s30, s60, 9216
    s_add_u32 s30, s30, 106496
    v_add_u32 v5, 0, v4
    v_mul_u32_u24 v6, 3641, v5
    v_lshrrev_b32 v6, 16, v6
    v_mul_u32_u24 v6, 2016, v6
    s_add_u32 m0, s30, 0
    v_lshl_add_u32 v6, v5, 4, v6
    buffer_load_dwordx4 v6, s[20:23], s29 offen lds
    v_add_u32 v5, 64, v4
    v_mul_u32_u24 v6, 3641, v5
    v_lshrrev_b32 v6, 16, v6
    v_mul_u32_u24 v6, 2016, v6
    s_add_u32 m0, s30, 1024
    v_lshl_add_u32 v6, v5, 4, v6
    buffer_load_dwordx4 v6, s[20:23], s29 offen lds
    v_add_u32 v5, 128, v4
    v_mul_u32_u24 v6, 3641, v5
    v_lshrrev_b32 v6, 16, v6
    v_mul_u32_u24 v6, 2016, v6
    s_add_u32 m0, s30, 2048
    v_lshl_add_u32 v6, v5, 4, v6
    buffer_load_dwordx4 v6, s[20:23], s29 offen lds
    v_add_u32 v5, 192, v4
    v_mul_u32_u24 v6, 3641, v5
    v_lshrrev_b32 v6, 16, v6
    v_mul_u32_u24 v6, 2016, v6
    s_add_u32 m0, s30, 3072
    v_lshl_add_u32 v6, v5, 4, v6
    buffer_load_dwordx4 v6, s[20:23], s29 offen lds
    v_add_u32 v5, 256, v4
    v_mul_u32_u24 v6, 3641, v5
    v_lshrrev_b32 v6, 16, v6
    v_mul_u32_u24 v6, 2016, v6
    s_add_u32 m0, s30, 4096
    v_lshl_add_u32 v6, v5, 4, v6
    buffer_load_dwordx4 v6, s[20:23], s29 offen lds
    v_add_u32 v5, 320, v4
    v_mul_u32_u24 v6, 3641, v5
    v_lshrrev_b32 v6, 16, v6
    v_mul_u32_u24 v6, 2016, v6
    s_add_u32 m0, s30, 5120
    v_lshl_add_u32 v6, v5, 4, v6
    buffer_load_dwordx4 v6, s[20:23], s29 offen lds
    v_add_u32 v5, 384, v4
    v_mul_u32_u24 v6, 3641, v5
    v_lshrrev_b32 v6, 16, v6
    v_mul_u32_u24 v6, 2016, v6
    s_add_u32 m0, s30, 6144
    v_lshl_add_u32 v6, v5, 4, v6
    buffer_load_dwordx4 v6, s[20:23], s29 offen lds
    v_add_u32 v5, 448, v4
    v_mul_u32_u24 v6, 3641, v5
    v_lshrrev_b32 v6, 16, v6
    v_mul_u32_u24 v6, 2016, v6
    s_add_u32 m0, s30, 7168
    v_lshl_add_u32 v6, v5, 4, v6
    buffer_load_dwordx4 v6, s[20:23], s29 offen lds
    v_add_u32 v5, 512, v4
    v_mul_u32_u24 v6, 3641, v5
    v_lshrrev_b32 v6, 16, v6
    v_mul_u32_u24 v6, 2016, v6
    s_add_u32 m0, s30, 8192
    v_lshl_add_u32 v6, v5, 4, v6
    buffer_load_dwordx4 v6, s[20:23], s29 offen lds
    v_lshlrev_b32 v4, 4, v0
    s_mul_i32 s28, s73, 13824
    s_mul_i32 s29, s72, 576
    s_add_u32 s28, s28, s29
    s_add_u32 s28, s28, 35136512
    s_cmp_lg_u32 s60, 0
    s_cbranch_scc1 L_jP_ng
    s_mov_b32 s24, s56
    s_mov_b32 s25, s57
    s_mov_b32 s26, 256
    s_mov_b32 s27, 0x20000
    v_mov_b32 v5, 64
    s_mov_b32 s29, 0
L_g_poll:
    buffer_load_dword v6, v5, s[24:27], 0 offen sc1
    s_add_u32 s29, s29, 1
    s_waitcnt vmcnt(0)
    v_cmp_gt_u32 vcc, 36, v6
    s_cmp_gt_u32 s29, 0x40000
    s_cbranch_scc1 L_g_got
    s_cbranch_vccnz L_g_poll
L_g_got:
    s_mov_b32 m0, 124928
    s_add_u32 s29, s28, 26624
    buffer_load_dwordx4 v4, s[16:19], s28 offen sc1 lds
    buffer_load_dwordx4 v4, s[16:19], s29 offen offset:1024 sc1 lds
L_jP_ng:
    v_min_u32 v5, 26, v0
    s_lshl_b32 s28, s73, 8
    s_add_u32 s28, s28, 28032
    v_lshl_add_u32 v5, v5, 2, s28
    v_lshlrev_b32 v5, 0, v5
    s_mov_b32 s28, 48234496
    s_mov_b32 s29, 0
L_wv_poll:
    buffer_load_dword v6, v5, s[16:19], s28 offen sc1
    s_add_u32 s29, s29, 1
    s_waitcnt vmcnt(0)
    v_cmp_eq_u32 vcc, 0, v6
    s_cmp_gt_u32 s29, 0x40000
    s_cbranch_scc1 L_wv_got
    s_cbranch_vccz L_wv_got
    s_sleep 8
    s_branch L_wv_poll
L_wv_got:
    s_mul_i32 s28, s73, 184320
    s_mul_i32 s29, s72, 4608
    s_add_u32 s28, s28, s29
    s_add_u32 s28, s28, 33554432
    v_lshrrev_b32 v5, 5, v0
    s_mul_i32 s29, s60, 24
    v_add_u32 v5, s29, v5
    v_and_b32 v7, 31, v0
    v_lshlrev_b32 v7, 4, v7
    s_mul_i32 s30, s60, 12288
    s_add_u32 s30, s30, 126976
    v_add_u32 v4, 0, v5
    v_min_u32 v4, 44, v4
    v_mul_u32_u24 v6, 57, v4
    v_lshrrev_b32 v6, 9, v6
    v_mul_u32_u24 v6, 63, v6
    v_add_u32 v6, v6, v4
    v_lshl_add_u32 v6, v6, 9, v7
    s_add_u32 m0, s30, 0
    s_nop 0
    buffer_load_dwordx4 v6, s[16:19], s28 offen sc1 lds
    v_add_u32 v4, 2, v5
    v_min_u32 v4, 44, v4
    v_mul_u32_u24 v6, 57, v4
    v_lshrrev_b32 v6, 9, v6
    v_mul_u32_u24 v6, 63, v6
    v_add_u32 v6, v6, v4
    v_lshl_add_u32 v6, v6, 9, v7
    s_add_u32 m0, s30, 1024
    s_nop 0
    buffer_load_dwordx4 v6, s[16:19], s28 offen sc1 lds
    v_add_u32 v4, 4, v5
    v_min_u32 v4, 44, v4
    v_mul_u32_u24 v6, 57, v4
    v_lshrrev_b32 v6, 9, v6
    v_mul_u32_u24 v6, 63, v6
    v_add_u32 v6, v6, v4
    v_lshl_add_u32 v6, v6, 9, v7
    s_add_u32 m0, s30, 2048
    s_nop 0
    buffer_load_dwordx4 v6, s[16:19], s28 offen sc1 lds
    v_add_u32 v4, 6, v5
    v_min_u32 v4, 44, v4
    v_mul_u32_u24 v6, 57, v4
    v_lshrrev_b32 v6, 9, v6
    v_mul_u32_u24 v6, 63, v6
    v_add_u32 v6, v6, v4
    v_lshl_add_u32 v6, v6, 9, v7
    s_add_u32 m0, s30, 3072
    s_nop 0
    buffer_load_dwordx4 v6, s[16:19], s28 offen sc1 lds
    v_add_u32 v4, 8, v5
    v_min_u32 v4, 44, v4
    v_mul_u32_u24 v6, 57, v4
    v_lshrrev_b32 v6, 9, v6
    v_mul_u32_u24 v6, 63, v6
    v_add_u32 v6, v6, v4
    v_lshl_add_u32 v6, v6, 9, v7
    s_add_u32 m0, s30, 4096
    s_nop 0
    buffer_load_dwordx4 v6, s[16:19], s28 offen sc1 lds
    v_add_u32 v4, 10, v5
    v_min_u32 v4, 44, v4
    v_mul_u32_u24 v6, 57, v4
    v_lshrrev_b32 v6, 9, v6
    v_mul_u32_u24 v6, 63, v6
    v_add_u32 v6, v6, v4
    v_lshl_add_u32 v6, v6, 9, v7
    s_add_u32 m0, s30, 5120
    s_nop 0
    buffer_load_dwordx4 v6, s[16:19], s28 offen sc1 lds
    v_add_u32 v4, 12, v5
    v_min_u32 v4, 44, v4
    v_mul_u32_u24 v6, 57, v4
    v_lshrrev_b32 v6, 9, v6
    v_mul_u32_u24 v6, 63, v6
    v_add_u32 v6, v6, v4
    v_lshl_add_u32 v6, v6, 9, v7
    s_add_u32 m0, s30, 6144
    s_nop 0
    buffer_load_dwordx4 v6, s[16:19], s28 offen sc1 lds
    v_add_u32 v4, 14, v5
    v_min_u32 v4, 44, v4
    v_mul_u32_u24 v6, 57, v4
    v_lshrrev_b32 v6, 9, v6
    v_mul_u32_u24 v6, 63, v6
    v_add_u32 v6, v6, v4
    v_lshl_add_u32 v6, v6, 9, v7
    s_add_u32 m0, s30, 7168
    s_nop 0
    buffer_load_dwordx4 v6, s[16:19], s28 offen sc1 lds
    v_add_u32 v4, 16, v5
    v_min_u32 v4, 44, v4
    v_mul_u32_u24 v6, 57, v4
    v_lshrrev_b32 v6, 9, v6
    v_mul_u32_u24 v6, 63, v6
    v_add_u32 v6, v6, v4
    v_lshl_add_u32 v6, v6, 9, v7
    s_add_u32 m0, s30, 8192
    s_nop 0
    buffer_load_dwordx4 v6, s[16:19], s28 offen sc1 lds
    v_add_u32 v4, 18, v5
    v_min_u32 v4, 44, v4
    v_mul_u32_u24 v6, 57, v4
    v_lshrrev_b32 v6, 9, v6
    v_mul_u32_u24 v6, 63, v6
    v_add_u32 v6, v6, v4
    v_lshl_add_u32 v6, v6, 9, v7
    s_add_u32 m0, s30, 9216
    s_nop 0
    buffer_load_dwordx4 v6, s[16:19], s28 offen sc1 lds
    v_add_u32 v4, 20, v5
    v_min_u32 v4, 44, v4
    v_mul_u32_u24 v6, 57, v4
    v_lshrrev_b32 v6, 9, v6
    v_mul_u32_u24 v6, 63, v6
    v_add_u32 v6, v6, v4
    v_lshl_add_u32 v6, v6, 9, v7
    s_add_u32 m0, s30, 10240
    s_nop 0
    buffer_load_dwordx4 v6, s[16:19], s28 offen sc1 lds
    v_add_u32 v4, 22, v5
    v_min_u32 v4, 44, v4
    v_mul_u32_u24 v6, 57, v4
    v_lshrrev_b32 v6, 9, v6
    v_mul_u32_u24 v6, 63, v6
    v_add_u32 v6, v6, v4
    v_lshl_add_u32 v6, v6, 9, v7
    s_add_u32 m0, s30, 11264
    s_nop 0
    buffer_load_dwordx4 v6, s[16:19], s28 offen sc1 lds
    v_lshlrev_b32 v5, 9, v2
    v_lshl_add_u32 v5, v1, 4, v5
    s_mul_i32 s28, s73, 10240
    s_add_u32 s28, s28, 36175872
    s_lshl_b32 s29, s60, 11
    s_add_u32 s29, s29, s28
    s_add_u32 s30, s29, 4096
    s_add_u32 s28, s28, 8192
    buffer_load_dwordx4 v[16:19], v5, s[16:19], s29 offen sc1
    buffer_load_dwordx4 v[24:27], v5, s[16:19], s30 offen sc1
    buffer_load_dwordx4 v[32:35], v5, s[16:19], s28 offen sc1
    s_add_u32 s28, s100, 0
    v_mov_b32 v4, s28
    s_mov_b32 s29, 0
L_lwoP:
    ds_read_b32 v6, v4
    s_add_u32 s29, s29, 1
    s_waitcnt lgkmcnt(0)
    v_readfirstlane_b32 s28, v6
    s_cmp_gt_u32 s29, 0x400000
    s_cbranch_scc1 L_lgoP
    s_cmp_ge_u32 s28, 16
    s_cbranch_scc1 L_lgoP
    s_sleep 1
    s_branch L_lwoP
L_lgoP:
    s_cmp_lg_u32 s3, 4
    s_cbranch_scc1 L_pwPl
    v_and_b32 v5, 7, v0
    s_lshr_b32 s28, s6, 1
    s_lshl_b32 s28, s28, 7
    s_add_u32 s28, s28, 19968
    s_lshl_b32 s29, s5, 7
    s_add_u32 s29, s29, 22016
    v_lshl_add_u32 v6, v5, 2, s29
    v_lshl_add_u32 v5, v5, 2, s28
    v_cmp_lt_u32 vcc, 7, v0
    v_min_u32 v7, 42, v0
    s_lshl_b32 s28, s73, 8
    s_add_u32 s28, s28, 27968
    v_cndmask_b32 v5, v5, v6, vcc
    v_cmp_lt_u32 vcc, 15, v0
    v_lshl_add_u32 v6, v7, 2, s28
    s_nop 0
    v_cndmask_b32 v5, v5, v6, vcc
    v_lshlrev_b32 v5, 0, v5
    s_mov_b32 s28, 48234496
    s_mov_b32 s29, 0
L_pollPl:
    buffer_load_dword v6, v5, s[16:19], s28 offen sc1
    s_add_u32 s29, s29, 1
    s_waitcnt vmcnt(0)
    v_cmp_eq_u32 vcc, 0, v6
    s_cmp_gt_u32 s29, 0x40000
    s_cbranch_scc1 L_pgotPl
    s_cbranch_vccz L_pgotPl
    s_sleep 4
    s_branch L_pollPl
L_pgotPl:
    s_add_u32 s28, s100, 4
    v_mov_b32 v4, s28
    v_mov_b32 v6, 1
    ds_write_b32 v4, v6
    s_branch L_pdonePl
L_pwPl:
    s_add_u32 s28, s100, 4
    v_mov_b32 v4, s28
    s_mov_b32 s29, 0
L_lwPlr:
    ds_read_b32 v6, v4
    s_add_u32 s29, s29, 1
    s_waitcnt lgkmcnt(0)
    v_readfirstlane_b32 s28, v6
    s_cmp_gt_u32 s29, 0x400000
    s_cbranch_scc1 L_lgPlr
    s_cmp_ge_u32 s28, 1
    s_cbranch_scc1 L_lgPlr
    s_sleep 1
    s_branch L_lwPlr
L_lgPlr:
L_pdonePl:
    s_mov_b32 s70, 0
    s_mov_b32 s71, 2
L_jP_lloop:
    s_add_u32 m0, s61, 0
    s_nop 0
    buffer_load_dwordx4 v8, s[16:19], s63 offen offset:0 sc1 lds
    buffer_load_dwordx4 v8, s[16:19], s63 offen offset:1024 sc1 lds
    buffer_load_dwordx4 v8, s[16:19], s63 offen offset:2048 sc1 lds
    buffer_load_dwordx4 v8, s[16:19], s63 offen offset:3072 sc1 lds
    s_add_u32 m0, s61, 4096
    s_nop 0
    buffer_load_dwordx4 v9, s[16:19], s63 offen offset:0 sc1 lds
    buffer_load_dwordx4 v9, s[16:19], s63 offen offset:1024 sc1 lds
    buffer_load_dwordx4 v9, s[16:19], s63 offen offset:2048 sc1 lds
    buffer_load_dwordx4 v9, s[16:19], s63 offen offset:3072 sc1 lds
    s_add_u32 m0, s61, 8192
    s_nop 0
    buffer_load_dwordx4 v10, s[16:19], s63 offen offset:0 sc1 lds
    s_add_u32 m0, s62, 0
    s_nop 0
    buffer_load_dwordx4 v11, s[16:19], s64 offen offset:0 sc1 lds
    buffer_load_dwordx4 v11, s[16:19], s64 offen offset:1024 sc1 lds
    buffer_load_dwordx4 v11, s[16:19], s64 offen offset:2048 sc1 lds
    buffer_load_dwordx4 v11, s[16:19], s64 offen offset:3072 sc1 lds
    s_add_u32 s63, s63, 294912
    s_add_u32 s64, s64, 262144
    s_add_u32 s66, s66, 1
    s_cmp_eq_u32 s66, 4
    s_cselect_b32 s68, 4294887424, s69
    s_cselect_b32 s66, 0, s66
    s_add_u32 s61, s61, s68
    s_add_u32 s62, s62, s68
    s_add_u32 s67, s67, 1
    s_cmp_eq_u32 s67, 16
    s_cbranch_scc1 L_jP_ltail
    s_cmp_lt_u32 s67, s71
    s_cbranch_scc1 L_jP_lloop
    s_cmp_lg_u32 s70, 0
    s_cbranch_scc1 L_jP_r0
    s_waitcnt vmcnt(13)
    s_add_u32 s71, s71, 1
L_jP_r0:
    s_waitcnt vmcnt(26)
    s_barrier
    s_add_u32 s70, s70, 1
    s_add_u32 s71, s71, 1
    s_branch L_jP_lloop
L_jP_ltail:
    s_waitcnt vmcnt(26)
    s_barrier
    s_waitcnt vmcnt(13)
    s_barrier
    s_waitcnt vmcnt(0)
    s_barrier
    s_waitcnt vmcnt(0)
    s_barrier
    s_barrier
    s_mul_i32 s28, s72, 46080
    s_mul_i32 s29, s73, 2560
    s_add_u32 s28, s28, s29
    s_add_u32 s28, s28, 34603008
    v_lshrrev_b32 v5, 5, v0
    s_mul_i32 s29, s60, 24
    v_add_u32 v5, s29, v5
    v_and_b32 v7, 31, v0
    v_lshlrev_b32 v7, 4, v7
    s_mul_i32 s30, s60, 12288
    s_add_u32 s30, s30, 53248
    v_add_u32 v4, 0, v5
    v_min_u32 v4, 44, v4
    v_mul_u32_u24 v6, 205, v4
    v_lshrrev_b32 v6, 10, v6
    v_mul_u32_u24 v6, 5, v6
    v_add_u32 v6, v6, v4
    v_lshl_add_u32 v6, v6, 9, v7
    s_add_u32 m0, s30, 0
    s_nop 0
    buffer_load_dwordx4 v6, s[16:19], s28 offen sc1 lds
    v_add_u32 v4, 2, v5
    v_min_u32 v4, 44, v4
    v_mul_u32_u24 v6, 205, v4
    v_lshrrev_b32 v6, 10, v6
    v_mul_u32_u24 v6, 5, v6
    v_add_u32 v6, v6, v4
    v_lshl_add_u32 v6, v6, 9, v7
    s_add_u32 m0, s30, 1024
    s_nop 0
    buffer_load_dwordx4 v6, s[16:19], s28 offen sc1 lds
    v_add_u32 v4, 4, v5
    v_min_u32 v4, 44, v4
    v_mul_u32_u24 v6, 205, v4
    v_lshrrev_b32 v6, 10, v6
    v_mul_u32_u24 v6, 5, v6
    v_add_u32 v6, v6, v4
    v_lshl_add_u32 v6, v6, 9, v7
    s_add_u32 m0, s30, 2048
    s_nop 0
    buffer_load_dwordx4 v6, s[16:19], s28 offen sc1 lds
    v_add_u32 v4, 6, v5
    v_min_u32 v4, 44, v4
    v_mul_u32_u24 v6, 205, v4
    v_lshrrev_b32 v6, 10, v6
    v_mul_u32_u24 v6, 5, v6
    v_add_u32 v6, v6, v4
    v_lshl_add_u32 v6, v6, 9, v7
    s_add_u32 m0, s30, 3072
    s_nop 0
    buffer_load_dwordx4 v6, s[16:19], s28 offen sc1 lds
    v_add_u32 v4, 8, v5
    v_min_u32 v4, 44, v4
    v_mul_u32_u24 v6, 205, v4
    v_lshrrev_b32 v6, 10, v6
    v_mul_u32_u24 v6, 5, v6
    v_add_u32 v6, v6, v4
    v_lshl_add_u32 v6, v6, 9, v7
    s_add_u32 m0, s30, 4096
    s_nop 0
    buffer_load_dwordx4 v6, s[16:19], s28 offen sc1 lds
    v_add_u32 v4, 10, v5
    v_min_u32 v4, 44, v4
    v_mul_u32_u24 v6, 205, v4
    v_lshrrev_b32 v6, 10, v6
    v_mul_u32_u24 v6, 5, v6
    v_add_u32 v6, v6, v4
    v_lshl_add_u32 v6, v6, 9, v7
    s_add_u32 m0, s30, 5120
    s_nop 0
    buffer_load_dwordx4 v6, s[16:19], s28 offen sc1 lds
    v_add_u32 v4, 12, v5
    v_min_u32 v4, 44, v4
    v_mul_u32_u24 v6, 205, v4
    v_lshrrev_b32 v6, 10, v6
    v_mul_u32_u24 v6, 5, v6
    v_add_u32 v6, v6, v4
    v_lshl_add_u32 v6, v6, 9, v7
    s_add_u32 m0, s30, 6144
    s_nop 0
    buffer_load_dwordx4 v6, s[16:19], s28 offen sc1 lds
    v_add_u32 v4, 14, v5
    v_min_u32 v4, 44, v4
    v_mul_u32_u24 v6, 205, v4
    v_lshrrev_b32 v6, 10, v6
    v_mul_u32_u24 v6, 5, v6
    v_add_u32 v6, v6, v4
    v_lshl_add_u32 v6, v6, 9, v7
    s_add_u32 m0, s30, 7168
    s_nop 0
    buffer_load_dwordx4 v6, s[16:19], s28 offen sc1 lds
    v_add_u32 v4, 16, v5
    v_min_u32 v4, 44, v4
    v_mul_u32_u24 v6, 205, v4
    v_lshrrev_b32 v6, 10, v6
    v_mul_u32_u24 v6, 5, v6
    v_add_u32 v6, v6, v4
    v_lshl_add_u32 v6, v6, 9, v7
    s_add_u32 m0, s30, 8192
    s_nop 0
    buffer_load_dwordx4 v6, s[16:19], s28 offen sc1 lds
    v_add_u32 v4, 18, v5
    v_min_u32 v4, 44, v4
    v_mul_u32_u24 v6, 205, v4
    v_lshrrev_b32 v6, 10, v6
    v_mul_u32_u24 v6, 5, v6
    v_add_u32 v6, v6, v4
    v_lshl_add_u32 v6, v6, 9, v7
    s_add_u32 m0, s30, 9216
    s_nop 0
    buffer_load_dwordx4 v6, s[16:19], s28 offen sc1 lds
    v_add_u32 v4, 20, v5
    v_min_u32 v4, 44, v4
    v_mul_u32_u24 v6, 205, v4
    v_lshrrev_b32 v6, 10, v6
    v_mul_u32_u24 v6, 5, v6
    v_add_u32 v6, v6, v4
    v_lshl_add_u32 v6, v6, 9, v7
    s_add_u32 m0, s30, 10240
    s_nop 0
    buffer_load_dwordx4 v6, s[16:19], s28 offen sc1 lds
    v_add_u32 v4, 22, v5
    v_min_u32 v4, 44, v4
    v_mul_u32_u24 v6, 205, v4
    v_lshrrev_b32 v6, 10, v6
    v_mul_u32_u24 v6, 5, v6
    v_add_u32 v6, v6, v4
    v_lshl_add_u32 v6, v6, 9, v7
    s_add_u32 m0, s30, 11264
    s_nop 0
    buffer_load_dwordx4 v6, s[16:19], s28 offen sc1 lds
    v_cmp_gt_u32 vcc, 9, v1
    s_nop 1
    v_cndmask_b32 v16, 0, v16, vcc
    v_cndmask_b32 v17, 0, v17, vcc
    v_cndmask_b32 v18, 0, v18, vcc
    v_cndmask_b32 v19, 0, v19, vcc
    v_cndmask_b32 v24, 0, v24, vcc
    v_cndmask_b32 v25, 0, v25, vcc
    v_cndmask_b32 v26, 0, v26, vcc
    v_cndmask_b32 v27, 0, v27, vcc
    v_cndmask_b32 v32, 0, v32, vcc
    v_cndmask_b32 v33, 0, v33, vcc
    v_cndmask_b32 v34, 0, v34, vcc
    v_cndmask_b32 v35, 0, v35, vcc
    v_add_f32_dpp v16, v16, v16 row_ror:1 row_mask:0xf bank_mask:0xf
    v_add_f32_dpp v17, v17, v17 row_ror:1 row_mask:0xf bank_mask:0xf
    v_add_f32_dpp v18, v18, v18 row_ror:1 row_mask:0xf bank_mask:0xf
    v_add_f32_dpp v19, v19, v19 row_ror:1 row_mask:0xf bank_mask:0xf
    v_add_f32_dpp v24, v24, v24 row_ror:1 row_mask:0xf bank_mask:0xf
    v_add_f32_dpp v25, v25, v25 row_ror:1 row_mask:0xf bank_mask:0xf
    v_add_f32_dpp v26, v26, v26 row_ror:1 row_mask:0xf bank_mask:0xf
    v_add_f32_dpp v27, v27, v27 row_ror:1 row_mask:0xf bank_mask:0xf
    v_add_f32_dpp v32, v32, v32 row_ror:1 row_mask:0xf bank_mask:0xf
    v_add_f32_dpp v33, v33, v33 row_ror:1 row_mask:0xf bank_mask:0xf
    v_add_f32_dpp v34, v34, v34 row_ror:1 row_mask:0xf bank_mask:0xf
    v_add_f32_dpp v35, v35, v35 row_ror:1 row_mask:0xf bank_mask:0xf
    v_add_f32_dpp v16, v16, v16 row_ror:2 row_mask:0xf bank_mask:0xf
    v_add_f32_dpp v17, v17, v17 row_ror:2 row_mask:0xf bank_mask:0xf
    v_add_f32_dpp v18, v18, v18 row_ror:2 row_mask:0xf bank_mask:0xf
    v_add_f32_dpp v19, v19, v19 row_ror:2 row_mask:0xf bank_mask:0xf
    v_add_f32_dpp v24, v24, v24 row_ror:2 row_mask:0xf bank_mask:0xf
    v_add_f32_dpp v25, v25, v25 row_ror:2 row_mask:0xf bank_mask:0xf
    v_add_f32_dpp v26, v26, v26 row_ror:2 row_mask:0xf bank_mask:0xf
    v_add_f32_dpp v27, v27, v27 row_ror:2 row_mask:0xf bank_mask:0xf
    v_add_f32_dpp v32, v32, v32 row_ror:2 row_mask:0xf bank_mask:0xf
    v_add_f32_dpp v33, v33, v33 row_ror:2 row_mask:0xf bank_mask:0xf
    v_add_f32_dpp v34, v34, v34 row_ror:2 row_mask:0xf bank_mask:0xf
    v_add_f32_dpp v35, v35, v35 row_ror:2 row_mask:0xf bank_mask:0xf
    v_add_f32_dpp v16, v16, v16 row_ror:4 row_mask:0xf bank_mask:0xf
    v_add_f32_dpp v17, v17, v17 row_ror:4 row_mask:0xf bank_mask:0xf
    v_add_f32_dpp v18, v18, v18 row_ror:4 row_mask:0xf bank_mask:0xf
    v_add_f32_dpp v19, v19, v19 row_ror:4 row_mask:0xf bank_mask:0xf
    v_add_f32_dpp v24, v24, v24 row_ror:4 row_mask:0xf bank_mask:0xf
    v_add_f32_dpp v25, v25, v25 row_ror:4 row_mask:0xf bank_mask:0xf
    v_add_f32_dpp v26, v26, v26 row_ror:4 row_mask:0xf bank_mask:0xf
    v_add_f32_dpp v27, v27, v27 row_ror:4 row_mask:0xf bank_mask:0xf
    v_add_f32_dpp v32, v32, v32 row_ror:4 row_mask:0xf bank_mask:0xf
    v_add_f32_dpp v33, v33, v33 row_ror:4 row_mask:0xf bank_mask:0xf
    v_add_f32_dpp v34, v34, v34 row_ror:4 row_mask:0xf bank_mask:0xf
    v_add_f32_dpp v35, v35, v35 row_ror:4 row_mask:0xf bank_mask:0xf
    v_add_f32_dpp v16, v16, v16 row_ror:8 row_mask:0xf bank_mask:0xf
    v_add_f32_dpp v17, v17, v17 row_ror:8 row_mask:0xf bank_mask:0xf
    v_add_f32_dpp v18, v18, v18 row_ror:8 row_mask:0xf bank_mask:0xf
    v_add_f32_dpp v19, v19, v19 row_ror:8 row_mask:0xf bank_mask:0xf
    v_add_f32_dpp v24, v24, v24 row_ror:8 row_mask:0xf bank_mask:0xf
    v_add_f32_dpp v25, v25, v25 row_ror:8 row_mask:0xf bank_mask:0xf
    v_add_f32_dpp v26, v26, v26 row_ror:8 row_mask:0xf bank_mask:0xf
    v_add_f32_dpp v27, v27, v27 row_ror:8 row_mask:0xf bank_mask:0xf
    v_add_f32_dpp v32, v32, v32 row_ror:8 row_mask:0xf bank_mask:0xf
    v_add_f32_dpp v33, v33, v33 row_ror:8 row_mask:0xf bank_mask:0xf
    v_add_f32_dpp v34, v34, v34 row_ror:8 row_mask:0xf bank_mask:0xf
    v_add_f32_dpp v35, v35, v35 row_ror:8 row_mask:0xf bank_mask:0xf
    v_lshlrev_b32 v5, 4, v2
    v_add_u32 v5, 159808, v5
    s_lshl_b32 s28, s60, 6
    v_add_u32 v6, s28, v5
    ds_write_b128 v6, v[16:19]
    ds_write_b128 v6, v[24:27] offset:128
    ds_write_b128 v5, v[32:35] offset:256
    s_waitcnt vmcnt(0) lgkmcnt(0)
L_jP_end:
    s_endpgm
.p2align 4
L_tab8:
    .long 0x00000002, 0x00010306, 0x00000008, 0x00000008, 0x00000202, 0x00020706, 0x00000008, 0x00000008
    .long 0x00000402, 0x00000706, 0x00000008, 0x00000008, 0x00040002, 0x00010b06, 0x00000008, 0x00000008
    .long 0x00040202, 0x00030b06, 0x00000008, 0x00000008, 0x00040402, 0x00000f06, 0x00000008, 0x00000008
    .long 0x02000007, 0x00000004, 0x00040706, 0x00000008, 0x02001407, 0x00090004, 0x00020f06, 0x00000008
    .long 0x00000102, 0x00010206, 0x00000008, 0x00000008, 0x00000302, 0x00020606, 0x00000008, 0x00000008
    .long 0x00000502, 0x00000606, 0x00000008, 0x00000008, 0x00040102, 0x00010a06, 0x00000008, 0x00000008
    .long 0x00040302, 0x00030a06, 0x00000008, 0x00000008, 0x00040502, 0x00000e06, 0x00000008, 0x00000008
    .long 0x02000207, 0x09000104, 0x00040606, 0x00000008, 0x02001607, 0x09090104, 0x00020e06, 0x00000008
    .long 0x00010002, 0x00010106, 0x00000008, 0x00000008, 0x00010202, 0x00020506, 0x00000008, 0x00000008
    .long 0x00010402, 0x00000506, 0x00000008, 0x00000008, 0x00050002, 0x00010906, 0x00000008, 0x00000008
    .long 0x00050202, 0x00030906, 0x00000008, 0x00000008, 0x00050402, 0x00000d06, 0x00000008, 0x00000008
    .long 0x02000407, 0x00010004, 0x00040506, 0x00000008, 0x02001807, 0x000a0004, 0x00020d06, 0x00000008
    .long 0x00010102, 0x00010006, 0x00000008, 0x00000008, 0x00010302, 0x00020406, 0x00000008, 0x00000008
    .long 0x00010502, 0x00000406, 0x00000008, 0x00000008, 0x00050102, 0x00010806, 0x00000008, 0x00000008
    .long 0x00050302, 0x00030806, 0x00000008, 0x00000008, 0x00050502, 0x00000c06, 0x00000008, 0x00000008
    .long 0x02000607, 0x09010104, 0x00040406, 0x00000008, 0x02001a07, 0x090a0104, 0x00020c06, 0x00000008
    .long 0x00020002, 0x00000306, 0x00000008, 0x00000008, 0x00020202, 0x00030706, 0x00000008, 0x00000008
    .long 0x00020402, 0x00010706, 0x00000008, 0x00000008, 0x00060002, 0x00000b06, 0x00000008, 0x00000008
    .long 0x00060202, 0x00020b06, 0x00000008, 0x00000008, 0x00060402, 0x00010f06, 0x00000008, 0x00000008
    .long 0x02000807, 0x00020004, 0x00050706, 0x00000008, 0x02001c07, 0x000b0004, 0x00030f06, 0x00000008
    .long 0x00020102, 0x00000206, 0x00000008, 0x00000008, 0x00020302, 0x00030606, 0x00000008, 0x00000008
    .long 0x00020502, 0x00010606, 0x00000008, 0x00000008, 0x00060102, 0x00000a06, 0x00000008, 0x00000008
    .long 0x00060302, 0x00020a06, 0x00000008, 0x00000008, 0x00060502, 0x00010e06, 0x00000008, 0x00000008
    .long 0x02000a07, 0x09020104, 0x00050606, 0x00000008, 0x02001e07, 0x090b0104, 0x00030e06, 0x00000008
    .long 0x00030002, 0x00000106, 0x00000008, 0x00000008, 0x00030202, 0x00030506, 0x00000008, 0x00000008
    .long 0x00030402, 0x00010506, 0x00000008, 0x00000008, 0x00070002, 0x00000906, 0x00000008, 0x00000008
    .long 0x00070202, 0x00020906, 0x00000008, 0x00000008, 0x00070402, 0x00010d06, 0x00000008, 0x00000008
    .long 0x02000c07, 0x00030004, 0x00050506, 0x00000008, 0x02002007, 0x000c0004, 0x00030d06, 0x00000008
    .long 0x00030102, 0x00000006, 0x00000008, 0x00000008, 0x00030302, 0x00030406, 0x00000008, 0x00000008
    .long 0x00030502, 0x00010406, 0x00000008, 0x00000008, 0x00070102, 0x00000806, 0x00000008, 0x00000008
    .long 0x00070302, 0x00020806, 0x00000008, 0x00000008, 0x00070502, 0x00010c06, 0x00000008, 0x00000008
    .long 0x02000e07, 0x09030104, 0x00050406, 0x00000008, 0x02002207, 0x090c0104, 0x00030c06, 0x00000008
    .long 0x00000000, 0x00000005, 0x00000008, 0x00000008, 0x00000300, 0x00030005, 0x00000008, 0x00000008
    .long 0x00000600, 0x00060005, 0x00000008, 0x00000008, 0x00080000, 0x00080805, 0x00000008, 0x00000008
    .long 0x00080300, 0x000b0805, 0x00000008, 0x00000008, 0x00080600, 0x000e0805, 0x00000008, 0x00000008
    .long 0x02001007, 0x00040004, 0x00060706, 0x00000008, 0x02002407, 0x00040f06, 0x00000008, 0x00000008
    .long 0x00000100, 0x00010005, 0x00000008, 0x00000008, 0x00000400, 0x00040005, 0x00000008, 0x00000008
    .long 0x00000700, 0x00070005, 0x00000008, 0x00000008, 0x00080100, 0x00090805, 0x00000008, 0x00000008
    .long 0x00080400, 0x000c0805, 0x00000008, 0x00000008, 0x00080700, 0x000f0805, 0x00000008, 0x00000008
    .long 0x02001207, 0x09040104, 0x00060606, 0x00000008, 0x00080401, 0x00040e06, 0x00000008, 0x00000008
    .long 0x00000200, 0x00020005, 0x00000008, 0x00000008, 0x00000500, 0x00050005, 0x00000008, 0x00000008
    .long 0x00000800, 0x00070006, 0x00000008, 0x00000008, 0x00080200, 0x000a0805, 0x00000008, 0x00000008
    .long 0x00080500, 0x000d0805, 0x00000008, 0x00000008, 0x00080800, 0x00070806, 0x00000008, 0x00000008
    .long 0x00080001, 0x00060506, 0x00000008, 0x00000008, 0x00080501, 0x00040d06, 0x00000008, 0x00000008
    .long 0x00010000, 0x00000105, 0x00000008, 0x00000008, 0x00010300, 0x00030105, 0x00000008, 0x00000008
    .long 0x00010600, 0x00060105, 0x00000008, 0x00000008, 0x00090000, 0x00080905, 0x00000008, 0x00000008
    .long 0x00090300, 0x000b0905, 0x00000008, 0x00000008, 0x00090600, 0x000e0905, 0x00000008, 0x00000008
    .long 0x00080101, 0x00060406, 0x00000008, 0x00000008, 0x00080601, 0x00040c06, 0x00000008, 0x00000008
    .long 0x00010100, 0x00010105, 0x00000008, 0x00000008, 0x00010400, 0x00040105, 0x00000008, 0x00000008
    .long 0x00010700, 0x00070105, 0x00000008, 0x00000008, 0x00090100, 0x00090905, 0x00000008, 0x00000008
    .long 0x00090400, 0x000c0905, 0x00000008, 0x00000008, 0x00090700, 0x000f0905, 0x00000008, 0x00000008
    .long 0x00080201, 0x00060306, 0x00000008, 0x00000008, 0x00080701, 0x00050f06, 0x00000008, 0x00000008
    .long 0x00010200, 0x00020105, 0x00000008, 0x00000008, 0x00010500, 0x00050105, 0x00000008, 0x00000008
    .long 0x00010800, 0x00070106, 0x00000008, 0x00000008, 0x00090200, 0x000a0905, 0x00000008, 0x00000008
    .long 0x00090500, 0x000d0905, 0x00000008, 0x00000008, 0x00090800, 0x00070906, 0x00000008, 0x00000008
    .long 0x00080301, 0x00060206, 0x00000008, 0x00000008, 0x00080801, 0x00050e06, 0x00000008, 0x00000008
    .long 0x00020000, 0x00000205, 0x00000008, 0x00000008, 0x00020300, 0x00030205, 0x00000008, 0x00000008
    .long 0x00020600, 0x00060205, 0x00000008, 0x00000008, 0x000a0000, 0x00080a05, 0x00000008, 0x00000008
    .long 0x000a0300, 0x000b0a05, 0x00000008, 0x00000008, 0x000a0600, 0x000e0a05, 0x00000008, 0x00000008
    .long 0x00000003, 0x00060106, 0x00000008, 0x00000008, 0x00000503, 0x00050d06, 0x00000008, 0x00000008
    .long 0x00020100, 0x00010205, 0x00000008, 0x00000008, 0x00020400, 0x00040205, 0x00000008, 0x00000008
    .long 0x00020700, 0x00070205, 0x00000008, 0x00000008, 0x000a0100, 0x00090a05, 0x00000008, 0x00000008
    .long 0x000a0400, 0x000c0a05, 0x00000008, 0x00000008, 0x000a0700, 0x000f0a05, 0x00000008, 0x00000008
    .long 0x09010003, 0x00060006, 0x00000008, 0x00000008, 0x09010503, 0x00050c06, 0x00000008, 0x00000008
    .long 0x00020200, 0x00020205, 0x00000008, 0x00000008, 0x00020500, 0x00050205, 0x00000008, 0x00000008
    .long 0x00020800, 0x00070206, 0x00000008, 0x00000008, 0x000a0200, 0x000a0a05, 0x00000008, 0x00000008
    .long 0x000a0500, 0x000d0a05, 0x00000008, 0x00000008, 0x000a0800, 0x00070a06, 0x00000008, 0x00000008
    .long 0x00000103, 0x00050306, 0x00000008, 0x00000008, 0x00000603, 0x00060f06, 0x00000008, 0x00000008
    .long 0x00030000, 0x00000305, 0x00000008, 0x00000008, 0x00030300, 0x00030305, 0x00000008, 0x00000008
    .long 0x00030600, 0x00060305, 0x00000008, 0x00000008, 0x000b0000, 0x00080b05, 0x00000008, 0x00000008
    .long 0x000b0300, 0x000b0b05, 0x00000008, 0x00000008, 0x000b0600, 0x000e0b05, 0x00000008, 0x00000008
    .long 0x09010103, 0x00050206, 0x00000008, 0x00000008, 0x09010603, 0x00060e06, 0x00000008, 0x00000008
    .long 0x00030100, 0x00010305, 0x00000008, 0x00000008, 0x00030400, 0x00040305, 0x00000008, 0x00000008
    .long 0x00030700, 0x00070305, 0x00000008, 0x00000008, 0x000b0100, 0x00090b05, 0x00000008, 0x00000008
    .long 0x000b0400, 0x000c0b05, 0x00000008, 0x00000008, 0x000b0700, 0x000f0b05, 0x00000008, 0x00000008
    .long 0x00000203, 0x00050106, 0x00000008, 0x00000008, 0x00000703, 0x00060d06, 0x00000008, 0x00000008
    .long 0x00030200, 0x00020305, 0x00000008, 0x00000008, 0x00030500, 0x00050305, 0x00000008, 0x00000008
    .long 0x00030800, 0x00070306, 0x00000008, 0x00000008, 0x000b0200, 0x000a0b05, 0x00000008, 0x00000008
    .long 0x000b0500, 0x000d0b05, 0x00000008, 0x00000008, 0x000b0800, 0x00070b06, 0x00000008, 0x00000008
    .long 0x09010203, 0x00050006, 0x00000008, 0x00000008, 0x09010703, 0x00060c06, 0x00000008, 0x00000008
    .long 0x00040000, 0x00000405, 0x00000008, 0x00000008, 0x00040300, 0x00030405, 0x00000008, 0x00000008
    .long 0x00040600, 0x00060405, 0x00000008, 0x00000008, 0x000c0000, 0x00080c05, 0x00000008, 0x00000008
    .long 0x000c0300, 0x000b0c05, 0x00000008, 0x00000008, 0x000c0600, 0x000e0c05, 0x00000008, 0x00000008
    .long 0x00000303, 0x00040306, 0x00000008, 0x00000008, 0x00000803, 0x00060b06, 0x00000008, 0x00000008
    .long 0x00040100, 0x00010405, 0x00000008, 0x00000008, 0x00040400, 0x00040405, 0x00000008, 0x00000008
    .long 0x00040700, 0x00070405, 0x00000008, 0x00000008, 0x000c0100, 0x00090c05, 0x00000008, 0x00000008
    .long 0x000c0400, 0x000c0c05, 0x00000008, 0x00000008, 0x000c0700, 0x000f0c05, 0x00000008, 0x00000008
    .long 0x09010303, 0x00040206, 0x00000008, 0x00000008, 0x09010803, 0x00060a06, 0x00000008, 0x00000008
    .long 0x00040200, 0x00020405, 0x00000008, 0x00000008, 0x00040500, 0x00050405, 0x00000008, 0x00000008
    .long 0x00040800, 0x00070406, 0x00000008, 0x00000008, 0x000c0200, 0x000a0c05, 0x00000008, 0x00000008
    .long 0x000c0500, 0x000d0c05, 0x00000008, 0x00000008, 0x000c0800, 0x00070c06, 0x00000008, 0x00000008
    .long 0x00000403, 0x00040106, 0x00000008, 0x00000008, 0x000d0004, 0x00060906, 0x00000008, 0x00000008
    .long 0x00050000, 0x00000505, 0x00000008, 0x00000008, 0x00050300, 0x00030505, 0x00000008, 0x00000008
    .long 0x00050600, 0x00060505, 0x00000008, 0x00000008, 0x000d0000, 0x00080d05, 0x00000008, 0x00000008
    .long 0x000d0300, 0x000b0d05, 0x00000008, 0x00000008, 0x000d0600, 0x000e0d05, 0x00000008, 0x00000008
    .long 0x09010403, 0x00040006, 0x00000008, 0x00000008, 0x090d0104, 0x00060806, 0x00000008, 0x00000008
    .long 0x00050100, 0x00010505, 0x00000008, 0x00000008, 0x00050400, 0x00040505, 0x00000008, 0x00000008
    .long 0x00050700, 0x00070505, 0x00000008, 0x00000008, 0x000d0100, 0x00090d05, 0x00000008, 0x00000008
    .long 0x000d0400, 0x000c0d05, 0x00000008, 0x00000008, 0x000d0700, 0x000f0d05, 0x00000008, 0x00000008
    .long 0x00050004, 0x00030306, 0x00000008, 0x00000008, 0x000e0004, 0x00050b06, 0x00000008, 0x00000008
    .long 0x00050200, 0x00020505, 0x00000008, 0x00000008, 0x00050500, 0x00050505, 0x00000008, 0x00000008
    .long 0x00050800, 0x00070506, 0x00000008, 0x00000008, 0x000d0200, 0x000a0d05, 0x00000008, 0x00000008
    .long 0x000d0500, 0x000d0d05, 0x00000008, 0x00000008, 0x000d0800, 0x00070d06, 0x00000008, 0x00000008
    .long 0x09050104, 0x00030206, 0x00000008, 0x00000008, 0x090e0104, 0x00050a06, 0x00000008, 0x00000008
    .long 0x00060000, 0x00000605, 0x00000008, 0x00000008, 0x00060300, 0x00030605, 0x00000008, 0x00000008
    .long 0x00060600, 0x00060605, 0x00000008, 0x00000008, 0x000e0000, 0x00080e05, 0x00000008, 0x00000008
    .long 0x000e0300, 0x000b0e05, 0x00000008, 0x00000008, 0x000e0600, 0x000e0e05, 0x00000008, 0x00000008
    .long 0x00060004, 0x00030106, 0x00000008, 0x00000008, 0x000f0004, 0x00050906, 0x00000008, 0x00000008
    .long 0x00060100, 0x00010605, 0x00000008, 0x00000008, 0x00060400, 0x00040605, 0x00000008, 0x00000008
    .long 0x00060700, 0x00070605, 0x00000008, 0x00000008, 0x000e0100, 0x00090e05, 0x00000008, 0x00000008
    .long 0x000e0400, 0x000c0e05, 0x00000008, 0x00000008, 0x000e0700, 0x000f0e05, 0x00000008, 0x00000008
    .long 0x09060104, 0x00030006, 0x00000008, 0x00000008, 0x090f0104, 0x00050806, 0x00000008, 0x00000008
    .long 0x00060200, 0x00020605, 0x00000008, 0x00000008, 0x00060500, 0x00050605, 0x00000008, 0x00000008
    .long 0x00060800, 0x00070606, 0x00000008, 0x00000008, 0x000e0200, 0x000a0e05, 0x00000008, 0x00000008
    .long 0x000e0500, 0x000d0e05, 0x00000008, 0x00000008, 0x000e0800, 0x00070e06, 0x00000008, 0x00000008
    .long 0x00070004, 0x00020306, 0x00000008, 0x00000008, 0x00100004, 0x00040b06, 0x00000008, 0x00000008
    .long 0x00070000, 0x00000705, 0x00000008, 0x00000008, 0x00070300, 0x00030705, 0x00000008, 0x00000008
    .long 0x00070600, 0x00060705, 0x00000008, 0x00000008, 0x000f0000, 0x00080f05, 0x00000008, 0x00000008
    .long 0x000f0300, 0x000b0f05, 0x00000008, 0x00000008, 0x000f0600, 0x000e0f05, 0x00000008, 0x00000008
    .long 0x09070104, 0x00020206, 0x00000008, 0x00000008, 0x09100104, 0x00040a06, 0x00000008, 0x00000008
    .long 0x00070100, 0x00010705, 0x00000008, 0x00000008, 0x00070400, 0x00040705, 0x00000008, 0x00000008
    .long 0x00070700, 0x00070705, 0x00000008, 0x00000008, 0x000f0100, 0x00090f05, 0x00000008, 0x00000008
    .long 0x000f0400, 0x000c0f05, 0x00000008, 0x00000008, 0x000f0700, 0x000f0f05, 0x00000008, 0x00000008
    .long 0x00080004, 0x00020106, 0x00000008, 0x00000008, 0x00110004, 0x00040906, 0x00000008, 0x00000008
    .long 0x00070200, 0x00020705, 0x00000008, 0x00000008, 0x00070500, 0x00050705, 0x00000008, 0x00000008
    .long 0x00070800, 0x00070706, 0x00000008, 0x00000008, 0x000f0200, 0x000a0f05, 0x00000008, 0x00000008
    .long 0x000f0500, 0x000d0f05, 0x00000008, 0x00000008, 0x000f0800, 0x00070f06, 0x00000008, 0x00000008
    .long 0x09080104, 0x00020006, 0x00000008, 0x00000008, 0x09110104, 0x00040806, 0x00000008, 0x00000008
L_code_end0:
.section .rodata,"a"
.p2align 6
L_kd_start:
.p2align 6
.amdhsa_kernel standalone__pixart__diffusion_kernel
  .amdhsa_next_free_vgpr 248
  .amdhsa_next_free_sgpr 102
  .amdhsa_accum_offset 248
  .amdhsa_group_segment_fixed_size 0
  .amdhsa_kernarg_size 96
  .amdhsa_user_sgpr_count 2
  .amdhsa_user_sgpr_kernarg_segment_ptr 1
  .amdhsa_system_sgpr_workgroup_id_x 1
.end_amdhsa_kernel
```
